```python
import torch

def _softmax(x, axis=-1):
    return torch.softmax(x, dim=axis)
def _gelu(x):
    return torch.nn.functional.gelu(x, approximate="tanh")
def _silu(x):
    return torch.nn.functional.silu(x)
def _sigmoid(x):
    return torch.sigmoid(x)
def _layernorm(x, axis=-1, eps=1e-5):
    m = x.mean(dim=axis, keepdim=True)
    v = x.var(dim=axis, keepdim=True, unbiased=False)
    return (x - m) / torch.sqrt(v + eps)
def _scatter_add(tgt, idx, src, axis=0):
    return tgt.clone().index_add_(axis, idx, src)
def _segment_sum(src, seg, n):
    out = torch.zeros((n,) + src.shape[1:], dtype=src.dtype)
    return out.index_add_(0, seg, src)
def _pad(x, pw):
    flat = tuple(v for pair in reversed(pw) for v in pair)
    return torch.nn.functional.pad(x, flat)

kernel_name = 'concat_heads__linear_attn_block__linear_kernel_hedgehog__prompt'

def setup_inputs():

    _w = (lambda a: (lambda t: t.to(torch.bfloat16) if t.is_floating_point() else t)(torch.as_tensor(a)))
    def _A_setup():
        B, S, D = 1, 2048, 576
        return {
            "x": _w((lambda *s: torch.randn(*s, dtype=torch.bfloat16) * 0.05)(B, S, D)),
            "wqkv": _w((lambda *s: torch.randn(*s, dtype=torch.bfloat16) * 0.8)(D, 3 * D)),
            "wo": _w((lambda *s: torch.randn(*s, dtype=torch.bfloat16) * 0.2)(D, D)),
        }
    _A_in = _A_setup()

    def _B_setup():
        B, S, D, H = 1, 2048, 576, 32
        Dh = D // H
        return {
            "x": _w((lambda *s: torch.randn(*s, dtype=torch.bfloat16) * 0.4)(B, S, D)),
            "wqkv": _w((lambda *s: torch.randn(*s, dtype=torch.bfloat16) * 0.4)(D, 3 * D)),
            "w_phi": _w((lambda *s: torch.randn(*s, dtype=torch.bfloat16) * 0.4)(H, Dh, Dh) * (Dh ** -0.5)),
            "wo": _w((lambda *s: torch.randn(*s, dtype=torch.bfloat16) * 0.05)(D, D)),
        }
    _B_in = _B_setup()

    return {
        "A_x": _A_in["x"],
        "A_wqkv": _A_in["wqkv"],
        "A_wo": _A_in["wo"],
        "B_x": _B_in["x"],
        "B_wqkv": _B_in["wqkv"],
        "B_w_phi": _B_in["w_phi"],
        "B_wo": _B_in["wo"],
    }

def reference(A_x, A_wqkv, A_wo, B_x, B_wqkv, B_w_phi, B_wo):
    def _A_ref(x, wqkv, wo):
        B, S, D = x.shape
        H = 32; Dh = D // H
        qkv = (lambda x, *d: x.permute(*d))((x @ wqkv).reshape(B, S, 3, H, Dh), 2, 0, 3, 1, 4)
        q, k, v = qkv[0], qkv[1], qkv[2]
        phi = lambda t: torch.where(t > 0, t + 1, torch.exp(t)) + 1e-6
        pq, pk = phi(q), phi(k)
        kv = torch.einsum("bhsd,bhse->bhde", pk, v)
        z = torch.einsum("bhsd->bhd", pk)
        num = torch.einsum("bhqd,bhde->bhqe", pq, kv)
        den = torch.einsum("bhqd,bhd->bhq", pq, z)[..., None] + 1e-6
        o = num / den
        return (lambda x, *d: x.permute(*d))(o, 0, 2, 1, 3).reshape(B, S, D) @ wo

    def _B_ref(x, wqkv, w_phi, wo):
        B, S, D = x.shape
        H = 32; Dh = D // H
        qkv = (lambda x, *d: x.permute(*d))((x @ wqkv).reshape(B, S, 3, H, Dh), 2, 0, 3, 1, 4)
        q, k, v = qkv[0], qkv[1], qkv[2]
        pq = torch.einsum("bhsd,hdf->bhsf", q, w_phi)
        pk = torch.einsum("bhsd,hdf->bhsf", k, w_phi)
        phi_q = torch.concatenate([_softmax(pq, axis=-1), _softmax(-pq, axis=-1)], axis=-1)
        phi_k = torch.concatenate([_softmax(pk, axis=-1), _softmax(-pk, axis=-1)], axis=-1)
        kv = torch.einsum("bhsf,bhsd->bhfd", phi_k, v)
        z  = torch.einsum("bhsf->bhf", phi_k)
        num = torch.einsum("bhqf,bhfd->bhqd", phi_q, kv)
        den = torch.einsum("bhqf,bhf->bhq", phi_q, z)[..., None] + 1e-6
        o = num / den
        return (lambda x, *d: x.permute(*d))(o, 0, 2, 1, 3).reshape(B, S, D) @ wo

    a = _A_ref(A_x, A_wqkv, A_wo)
    b = _B_ref(B_x, B_wqkv, B_w_phi, B_wo)
    return torch.concatenate([a, b], axis=-1)
```

```asm
; @launch grid=(256,1,1) block=(512,1,1) lds=163840
.amdgcn_target "amdgcn-amd-amdhsa--gfx950"
.text
.globl concat_heads__linear_attn_block__linear_kernel_hedgehog__prompt_kernel
.p2align 8
.type concat_heads__linear_attn_block__linear_kernel_hedgehog__prompt_kernel,@function
concat_heads__linear_attn_block__linear_kernel_hedgehog__prompt_kernel:
  s_bfe_u32 s4, s2, 0x10002
  v_readfirstlane_b32 s7, v0
  s_mul_i32 s3, s4, 24
  s_load_dwordx4 s[36:39], s[0:1], s3
  s_cmpk_ge_u32 s2, 256
  s_cbranch_scc1 L_end
  s_lshr_b32 s7, s7, 6
  s_lshr_b32 s13, s2, 3
  s_lshr_b32 s14, s2, 6
  s_and_b32 s5, s2, 3
  s_lshl2_add_u32 s5, s5, s14
  s_and_b32 s6, s13, 7
  s_and_b32 s8, s7, 3
  v_and_b32 v0, 63, v0
  s_cmp_ge_u32 s7, 4
  s_cbranch_scc1 L_tr
  s_setprio 2
  v_lshrrev_b32 v40, 3, v0
  s_add_u32 s12, s14, s6
  s_lshl_b32 s12, s12, 1
  v_xor_b32 v41, v0, v40
  s_lshr_b32 s12, 1198372, s12
  s_and_b32 s12, s12, 3
  v_mul_u32_u24 v1, 64, v40
  s_lshl2_add_u32 s10, s5, s8
  s_mul_i32 s49, s10, 36864
  v_add_lshl_u32 v1, v41, v1, 4
  s_lshl_b32 s14, s12, 7
  s_add_u32 s10, s49, s14
  s_lshl_b32 s64, s8, 12
  s_add_u32 m0, s64, 104448
  s_movk_i32 s15, 0x2000
  s_add_u32 s13, s10, s15
  s_waitcnt lgkmcnt(0)
  s_mov_b64 s[40:41], s[38:39]
  s_mov_b32 s38, 2359296
  s_mov_b32 s39, 0x20000
  buffer_load_dwordx4 v1, s[36:39], s10 offen lds
  buffer_load_dwordx4 v1, s[36:39], s13 offen offset:1024 lds
  s_add_u32 s13, s13, s15
  buffer_load_dwordx4 v1, s[36:39], s13 offen offset:2048 lds
  s_add_u32 s13, s13, s15
  buffer_load_dwordx4 v1, s[36:39], s13 offen offset:3072 lds
L_x0:
  v_mul_u32_u24 v40, 7282, v0
  v_lshlrev_b32 v18, 4, v0
  s_movk_i32 s69, 1584
  s_movk_i32 s15, -576
  s_movk_i32 s3, 1728
  s_and_b32 s11, s8, 2
  s_and_b32 s14, s8, 1
  s_lshl2_add_u32 s11, s11, s14
  s_mul_i32 s11, s11, 13824
L_tr:
  s_load_dwordx16 s[16:31], s[0:1], 0
  s_load_dwordx4 s[32:35], s[0:1], 64
  s_cmp_ge_u32 s7, 4
  s_cbranch_scc1 L_C
  s_add_u32 s14, s6, 8
  s_mulk_i32 s14, 144
  s_add_u32 s50, s11, s14
  s_mul_i32 s14, s12, 221184
  s_add_u32 s11, s50, s14
  s_mul_i32 s65, s8, 4608
  s_addk_i32 s65, 0x4000
  s_mov_b32 s42, 1990656
  s_mov_b32 s43, 0x20000
  v_lshrrev_b32 v41, 16, v40
  v_mad_u32_u24 v42, v41, s69, v18
  v_and_b32 v43, 1, v41
  v_mad_i32_i24 v42, v43, s15, v42
  v_and_b32 v43, 24, v41
  v_mad_u32_u24 v2, v43, s3, v42
  s_add_u32 m0, s65, 104448
  s_nop 0
  buffer_load_dwordx4 v2, s[40:43], s11 offen offset:0 lds
  v_add_u32 v40, 466048, v40
  v_lshrrev_b32 v41, 16, v40
  v_mad_u32_u24 v42, v41, s69, v18
  v_and_b32 v43, 1, v41
  v_mad_i32_i24 v42, v43, s15, v42
  v_and_b32 v43, 24, v41
  v_mad_u32_u24 v3, v43, s3, v42
  buffer_load_dwordx4 v3, s[40:43], s11 offen offset:1024 lds
  v_add_u32 v40, 466048, v40
  v_lshrrev_b32 v41, 16, v40
  v_mad_u32_u24 v42, v41, s69, v18
  v_and_b32 v43, 1, v41
  v_mad_i32_i24 v42, v43, s15, v42
  v_and_b32 v43, 24, v41
  v_mad_u32_u24 v4, v43, s3, v42
  buffer_load_dwordx4 v4, s[40:43], s11 offen offset:2048 lds
  v_add_u32 v40, 466048, v40
  v_lshrrev_b32 v41, 16, v40
  v_mad_u32_u24 v42, v41, s69, v18
  v_and_b32 v43, 1, v41
  v_mad_i32_i24 v42, v43, s15, v42
  v_and_b32 v43, 24, v41
  v_mad_u32_u24 v5, v43, s3, v42
  buffer_load_dwordx4 v5, s[40:43], s11 offen offset:3072 lds
  v_add_u32 v40, 466048, v40
  v_lshrrev_b32 v41, 16, v40
  v_mad_u32_u24 v42, v41, s69, v18
  v_and_b32 v43, 1, v41
  v_mad_i32_i24 v42, v43, s15, v42
  v_and_b32 v43, 24, v41
  v_mad_u32_u24 v6, v43, s3, v42
  v_add_u32 v6, 4096, v6
  s_mov_b32 s48, 1484022291
  s_cmp_eq_u32 s12, 1
  s_cselect_b32 s48, 2253860930, s48
  s_cmp_eq_u32 s12, 2
  s_cselect_b32 s48, 1736656144, s48
  s_add_u32 m0, s65, 108544
  s_mov_b32 exec_hi, 0
  buffer_load_dwordx4 v6, s[40:43], s11 offen lds
  s_mov_b32 exec_hi, -1
  s_bfe_u32 s14, s48, 262144
  s_mul_i32 s15, s14, 128
  s_add_u32 s10, s49, s15
  s_mul_i32 s15, s14, 221184
  s_add_u32 s11, s50, s15
  s_mov_b32 s9, s12
  s_cmp_eq_u32 s4, 0
  s_waitcnt lgkmcnt(0)
  s_cselect_b32 s44, s20, s28
  s_cselect_b32 s45, s21, s29
  s_cmp_eq_u32 s4, 0
  s_cbranch_scc0 L_HB
  s_branch L_HA
L_C:
  s_setprio 1
  s_getpc_b64 s[72:73]
L_pc:
  s_cmp_eq_u32 s4, 0
  s_cselect_b32 s14, L_CA-L_CB, 0
  s_add_u32 s14, s14, L_CB-L_pc
  s_lshl_b32 s15, s13, 2
  s_add_u32 s15, s15, s8
  s_lshl_b32 s15, s15, 1
  v_and_b32 v1, 1, v0
  v_add_u32 v1, s15, v1
  v_lshl_add_u32 v1, v1, 7, s14
  v_min_u32 v1, L_end-L_pc, v1
  global_load_dword v15, v1, s[72:73]
  s_cmp_eq_u32 s4, 0
  s_cbranch_scc1 L_CA0
  s_waitcnt lgkmcnt(0)
  s_branch L_CB
L_CA0:
  s_lshl_b32 s14, s5, 3
  s_add_u32 s14, s14, s6
  s_lshl_b32 s14, s14, 2
  s_add_u32 s14, s14, s8
  s_mul_i32 s15, s14, 24
  v_add_u32 v41, s15, v0
  s_mov_b32 s15, 174763
  v_mul_lo_u32 v40, v41, s15
  v_lshrrev_b32 v40, 20, v40
  v_mul_u32_u24 v40, 384, v40
  v_lshl_add_u32 v248, v41, 7, v40
  s_mul_i32 s15, s14, 14
  v_add_u32 v41, s15, v0
  s_mov_b32 s15, 58255
  v_mul_lo_u32 v40, v41, s15
  v_lshrrev_b32 v40, 20, v40
  v_mul_u32_u24 v40, 1152, v40
  v_lshl_add_u32 v249, v41, 7, v40
  s_mul_i32 s15, s14, 11
  v_add_u32 v41, s15, v0
  s_mov_b32 s15, 116509
  v_mul_lo_u32 v40, v41, s15
  v_lshrrev_b32 v40, 20, v40
  v_mul_u32_u24 v40, 2304, v40
  v_lshl_add_u32 v250, v41, 7, v40
  s_mul_i32 s15, s14, 11
  v_add_u32 v41, s15, v0
  v_lshlrev_b32 v251, 7, v41
  s_mul_i32 s15, s14, 11
  v_add_u32 v41, s15, v0
  s_mov_b32 s15, 116509
  v_mul_lo_u32 v40, v41, s15
  v_lshrrev_b32 v40, 20, v40
  v_mul_u32_u24 v40, 2304, v40
  v_lshl_add_u32 v252, v41, 7, v40
  s_mul_i32 s15, s14, 11
  v_add_u32 v41, s15, v0
  v_lshlrev_b32 v253, 7, v41
  s_mov_b32 s59, 0x20000
  s_waitcnt lgkmcnt(0)
  s_mov_b64 s[56:57], s[22:23]
  s_mov_b32 s58, 2359296
  s_mov_b32 s15, 384
  s_mov_b32 exec_lo, 16777215
  s_mov_b32 exec_hi, 0
  buffer_load_dword v248, v248, s[56:59], s15 offen
  s_mov_b64 s[56:57], s[24:25]
  s_mov_b32 s58, 1990656
  s_mov_b32 s15, 664704
  s_mov_b32 exec_lo, 16383
  s_mov_b32 exec_hi, 0
  buffer_load_dword v249, v249, s[56:59], s15 offen
  s_mov_b64 s[36:37], s[24:25]
  s_mov_b64 s[38:39], s[28:29]
  s_mov_b64 s[40:41], s[18:19]
  s_mov_b64 s[42:43], s[20:21]
  s_mov_b64 exec, -1
  s_branch L_CA
L_CB:
  s_mov_b32 s48, s30
  s_mov_b32 s49, s31
  s_mov_b32 s50, 4718592
  s_mov_b32 s51, 0x20000
  v_lshlrev_b32 v14, 4, v0
  s_mov_b32 s52, s34
  s_mov_b32 s53, s35
  s_mov_b32 s54, 0x2000000
  s_mov_b32 s55, 0x20000
  s_mov_b32 s60, s32
  s_mov_b32 s61, s33
  s_mov_b32 s62, 256
  s_mov_b32 s63, 0x20000
  s_lshl_b32 s14, s4, 3
  s_add_u32 s14, s14, s6
  s_mul_i32 s26, s14, 90112
  s_mul_i32 s27, s5, 5632
  s_add_u32 s27, s27, s26
  s_lshl2_add_u32 s13, s5, s8
  s_mul_i32 s28, s13, 73728
  s_mul_i32 s13, s4, 1152
  s_add_u32 s28, s28, s13
  s_mov_b64 s[70:71], 0xffff
  s_mov_b32 s76, 1069066811
  s_mov_b32 s77, 1069066811
  s_mov_b32 s78, 897988541
  s_lshl_b32 s29, s6, 7
  s_add_u32 s29, s29, s28
  s_mul_i32 s30, s6, 4608
  s_add_u32 s30, s30, s28
  s_add_u32 s30, s30, 1024
  s_mov_b32 s31, 0
  v_mov_b32 v44, -1
  v_mov_b32 v45, -1
  v_mov_b32 v46, -1
  v_mov_b32 v47, -1
  s_lshl_b32 s13, s8, 10
  s_add_u32 s13, s13, s27
  buffer_store_dwordx4 v[44:47], v14, s[52:55], s13 offen sc1
  s_lshl_b32 s13, s8, 9
  s_add_u32 s13, s13, s27
  s_add_u32 s13, s13, 4096
  s_cmp_le_u32 s8, 2
  s_cselect_b32 s13, s13, 1073741824
  s_mov_b32 exec_hi, 0
  buffer_store_dwordx4 v[44:47], v14, s[52:55], s13 offen sc1
  s_mov_b64 exec, -1
  s_setprio 1
  s_mov_b32 s32, -1
  s_mov_b32 s33, 0
  v_lshrrev_b32 v60, 4, v0
  v_and_b32 v61, 15, v0
  s_lshl_b32 s13, s8, 12
  s_add_u32 s13, s13, 104448
  v_and_b32 v48, 7, v61
  v_xor_b32 v48, v48, v60
  v_lshlrev_b32 v48, 4, v48
  v_lshl_add_u32 v48, v61, 7, v48
  v_add_u32 v1, s13, v48
  v_xor_b32 v2, 64, v1
  v_lshrrev_b32 v49, 2, v0
  v_mul_u32_u24 v48, 288, v49
  v_add_u32 v48, 120832, v48
  v_and_b32 v50, 3, v0
  v_lshl_add_u32 v3, v50, 3, v48
  v_mul_u32_u24 v51, 72, v50
  v_add3_u32 v4, v48, v51, 64
  s_mul_i32 s13, s8, 14080
  s_add_u32 s13, s13, 82944
  v_mul_u32_u24 v48, 440, v61
  v_add_u32 v48, s13, v48
  v_lshl_add_u32 v5, v60, 3, v48
  v_mul_u32_u24 v51, 72, v60
  v_add_u32 v6, v48, v51
  s_mul_i32 s3, s8, 14080
  s_add_u32 s3, s3, 82944
  v_mul_u32_u24 v48, 440, v61
  v_mul_u32_u24 v49, 36, v60
  v_add3_u32 v48, v48, v49, s3
  v_and_b32 v49, 1, v60
  v_lshl_add_u32 v7, v49, 2, v48
  v_lshlrev_b32 v49, 5, v49
  v_sub_u32 v48, v48, v49
  v_add_u32 v8, 32, v48
  v_and_b32 v48, 1, v0
  v_mul_u32_u24 v48, 2880, v48
  v_add_u32 v48, 148480, v48
  v_bfe_u32 v49, v0, 1, 1
  v_mul_u32_u24 v49, 18, v49
  v_lshrrev_b32 v50, 2, v0
  v_mov_b32 v51, 154240
  v_add_u32 v52, 0, v50
  v_sub_u32 v53, v52, v49
  v_cmp_gt_u32 s[72:73], 18, v53
  v_mul_u32_u24 v52, 40, v52
  v_add_u32 v52, v52, v48
  v_cndmask_b32 v9, v51, v52, s[72:73]
  v_add_u32 v52, 16, v50
  v_sub_u32 v53, v52, v49
  v_cmp_gt_u32 s[72:73], 18, v53
  v_mul_u32_u24 v52, 40, v52
  v_add_u32 v52, v52, v48
  v_cndmask_b32 v10, v51, v52, s[72:73]
  v_add_u32 v52, 32, v50
  v_sub_u32 v53, v52, v49
  v_cmp_gt_u32 s[72:73], 18, v53
  v_mul_u32_u24 v52, 40, v52
  v_add_u32 v52, v52, v48
  v_cndmask_b32 v11, v51, v52, s[72:73]
  v_lshrrev_b32 v48, 3, v61
  v_and_b32 v49, 4, v61
  v_and_b32 v50, 3, v61
  v_lshl_add_u32 v51, v49, 1, v50
  v_add_u32 v52, 14, v50
  v_cmp_gt_u32 s[16:17], 2, v50
  v_and_b32 v49, 1, v60
  v_lshl_add_u32 v50, v48, 1, v49
  v_cndmask_b32 v52, v52, 18, s[16:17]
  v_mul_u32_u24 v50, 608, v50
  v_add_u32 v50, 157440, v50
  v_lshl_add_u32 v112, v51, 4, v50
  v_lshl_add_u32 v113, v52, 4, v50
  v_mul_u32_u24 v50, 152, v48
  v_lshl_add_u32 v50, v49, 2, v50
  v_add_u32 v50, 162304, v50
  v_lshl_add_u32 v114, v51, 3, v50
  v_lshl_add_u32 v115, v52, 3, v50
  v_lshrrev_b32 v49, 1, v60
  v_cmp_eq_u32 s[16:17], v49, v48
  v_mov_b32 v116, 0
  v_mov_b32 v117, 0
  s_lshl_b32 s3, s8, 11
  s_add_u32 s3, s3, 139264
  v_add_u32 v12, s3, v14
  s_lshl_b32 s3, s8, 8
  s_add_u32 s3, s3, 147456
  v_lshl_add_u32 v13, v61, 4, s3
  s_mov_b32 s34, 0xffff0000
  s_mov_b32 s35, 0
  v_mul_u32_u24 v118, 144, v61
  v_lshl_add_u32 v118, v60, 3, v118
  s_lshl_b32 s11, s5, 2
  s_add_u32 s11, s11, s8
  s_mul_i32 s11, s11, 73728
  s_mul_i32 s14, s6, 144
  s_add_u32 s11, s11, s14
  s_add_u32 s11, s11, 1152
  s_mul_i32 s10, s8, 4608
  s_add_u32 s10, s10, 61440
  s_lshl_b32 s66, s8, 12
  s_add_u32 s66, s66, 28672
  v_add_u32 v48, 0, v0
  v_mul_u32_u24 v49, 7282, v48
  v_lshrrev_b32 v49, 16, v49
  v_mul_u32_u24 v49, 2160, v49
  v_lshl_add_u32 v119, v48, 4, v49
  v_add_u32 v48, 64, v0
  v_mul_u32_u24 v49, 7282, v48
  v_lshrrev_b32 v49, 16, v49
  v_mul_u32_u24 v49, 2160, v49
  v_lshl_add_u32 v120, v48, 4, v49
  v_add_u32 v48, 128, v0
  v_mul_u32_u24 v49, 7282, v48
  v_lshrrev_b32 v49, 16, v49
  v_mul_u32_u24 v49, 2160, v49
  v_lshl_add_u32 v121, v48, 4, v49
  v_add_u32 v48, 192, v0
  v_mul_u32_u24 v49, 7282, v48
  v_lshrrev_b32 v49, 16, v49
  v_mul_u32_u24 v49, 2160, v49
  v_lshl_add_u32 v122, v48, 4, v49
  v_add_u32 v48, 256, v0
  v_mul_u32_u24 v49, 7282, v48
  v_lshrrev_b32 v49, 16, v49
  v_mul_u32_u24 v49, 2160, v49
  v_lshl_add_u32 v123, v48, 4, v49
  s_lshl_b32 s67, s8, 2
  s_add_u32 s67, s67, 163808
  v_mov_b32 v49, s67
  v_mov_b32 v50, 0
  ds_write_b32 v49, v50
  v_add_u32 v48, 154368, v14
  ds_write_b128 v48, v[112:115] offset:0
  ds_write_b128 v48, v[116:119] offset:1024
  ds_write_b128 v48, v[120:123] offset:2048
  s_waitcnt lgkmcnt(0)
  s_barrier
  ds_read_b64_tr_b16 v[16:17], v3 offset:72
  ds_read_b64_tr_b16 v[18:19], v3 offset:4680
  ds_read_b128 v[112:115], v1 offset:0
  ds_read_b64_tr_b16 v[20:21], v3 offset:104
  ds_read_b64_tr_b16 v[22:23], v3 offset:4712
  ds_read_b128 v[116:119], v1 offset:2048
  ds_read_b64_tr_b16 v[24:25], v4 offset:0
  ds_read_b64_tr_b16 v[26:27], v4 offset:4608
  ds_read_b64_tr_b16 v[28:29], v3 offset:0
  ds_read_b64_tr_b16 v[30:31], v3 offset:4608
  ds_read_b64_tr_b16 v[32:33], v3 offset:32
  ds_read_b64_tr_b16 v[34:35], v3 offset:4640
  s_waitcnt lgkmcnt(9)
  v_mfma_f32_16x16x32_bf16 v[56:59], v[16:19], v[112:115], 0
  ds_read_b64_tr_b16 v[36:37], v3 offset:144
  s_waitcnt lgkmcnt(7)
  v_mfma_f32_16x16x32_bf16 v[60:63], v[16:19], v[116:119], 0
  ds_read_b64_tr_b16 v[38:39], v3 offset:4752
  v_mfma_f32_16x16x32_bf16 v[64:67], v[20:23], v[112:115], 0
  ds_read_b64_tr_b16 v[16:17], v3 offset:176
  v_mfma_f32_16x16x32_bf16 v[68:71], v[20:23], v[116:119], 0
  ds_read_b64_tr_b16 v[18:19], v3 offset:4784
  s_waitcnt lgkmcnt(6)
  v_mfma_f32_16x16x32_bf16 v[104:107], v[24:27], v[112:115], 0
  ds_read_b64_tr_b16 v[20:21], v3 offset:216
  v_mfma_f32_16x16x32_bf16 v[108:111], v[24:27], v[116:119], 0
  ds_read_b64_tr_b16 v[22:23], v3 offset:4824
  v_mfma_f32_16x16x32_bf16 v[40:43], v[28:31], v[112:115], 0
  ds_read_b64_tr_b16 v[24:25], v3 offset:248
  v_mfma_f32_16x16x32_bf16 v[44:47], v[28:31], v[116:119], 0
  ds_read_b64_tr_b16 v[26:27], v3 offset:4856
  s_waitcnt lgkmcnt(6)
  v_mfma_f32_16x16x32_bf16 v[48:51], v[32:35], v[112:115], 0
  ds_read_b64_tr_b16 v[28:29], v3 offset:9288
  v_mfma_f32_16x16x32_bf16 v[52:55], v[32:35], v[116:119], 0
  ds_read_b64_tr_b16 v[30:31], v3 offset:13896
  ds_read_b128 v[120:123], v2 offset:0
  v_mfma_f32_16x16x32_bf16 v[72:75], v[36:39], v[112:115], 0
  ds_read_b64_tr_b16 v[32:33], v3 offset:9320
  v_mfma_f32_16x16x32_bf16 v[76:79], v[36:39], v[116:119], 0
  ds_read_b64_tr_b16 v[34:35], v3 offset:13928
  ds_read_b128 v[124:127], v2 offset:2048
  s_waitcnt lgkmcnt(8)
  v_mfma_f32_16x16x32_bf16 v[80:83], v[16:19], v[112:115], 0
  ds_read_b64_tr_b16 v[36:37], v4 offset:9216
  v_mfma_f32_16x16x32_bf16 v[84:87], v[16:19], v[116:119], 0
  ds_read_b64_tr_b16 v[38:39], v4 offset:13824
  v_mfma_f32_16x16x32_bf16 v[88:91], v[20:23], v[112:115], 0
  ds_read_b64_tr_b16 v[16:17], v3 offset:9216
  v_mfma_f32_16x16x32_bf16 v[92:95], v[20:23], v[116:119], 0
  ds_read_b64_tr_b16 v[18:19], v3 offset:13824
  s_waitcnt lgkmcnt(8)
  v_mfma_f32_16x16x32_bf16 v[96:99], v[24:27], v[112:115], 0
  ds_read_b64_tr_b16 v[20:21], v3 offset:9248
  v_mfma_f32_16x16x32_bf16 v[100:103], v[24:27], v[116:119], 0
  ds_read_b64_tr_b16 v[22:23], v3 offset:13856
  s_waitcnt lgkmcnt(9)
  v_mfma_f32_16x16x32_bf16 v[56:59], v[28:31], v[120:123], v[56:59]
  ds_read_b64_tr_b16 v[24:25], v3 offset:9360
  s_waitcnt lgkmcnt(7)
  v_mfma_f32_16x16x32_bf16 v[60:63], v[28:31], v[124:127], v[60:63]
  ds_read_b64_tr_b16 v[26:27], v3 offset:13968
  s_waitcnt lgkmcnt(6)
  v_mfma_f32_16x16x32_bf16 v[64:67], v[32:35], v[120:123], v[64:67]
  ds_read_b64_tr_b16 v[28:29], v3 offset:9392
  v_mfma_f32_16x16x32_bf16 v[68:71], v[32:35], v[124:127], v[68:71]
  ds_read_b64_tr_b16 v[30:31], v3 offset:14000
  v_mfma_f32_16x16x32_bf16 v[104:107], v[36:39], v[120:123], v[104:107]
  ds_read_b64_tr_b16 v[32:33], v3 offset:9432
  v_mfma_f32_16x16x32_bf16 v[108:111], v[36:39], v[124:127], v[108:111]
  ds_read_b64_tr_b16 v[34:35], v3 offset:14040
  s_waitcnt lgkmcnt(6)
  v_mfma_f32_16x16x32_bf16 v[40:43], v[16:19], v[120:123], v[40:43]
  ds_read_b64_tr_b16 v[36:37], v3 offset:9464
  v_mfma_f32_16x16x32_bf16 v[44:47], v[16:19], v[124:127], v[44:47]
  ds_read_b64_tr_b16 v[38:39], v3 offset:14072
  v_mfma_f32_16x16x32_bf16 v[48:51], v[20:23], v[120:123], v[48:51]
  v_add_u32 v1, 4294862848, v1
  v_add_u32 v2, 4294862848, v2
  v_add_u32 v3, 4294862848, v3
  v_add_u32 v4, 4294862848, v4
  s_waitcnt vmcnt(0)
  s_barrier
  s_getreg_b32 s15, hwreg(HW_REG_XCC_ID, 0, 4)
  s_or_b32 s15, s15, 0x80
  s_and_b32 s14, s6, 3
  s_lshl_b32 s14, s14, 3
  s_lshl_b32 s15, s15, s14
  v_mov_b32 v15, s15
  s_lshl_b32 s13, s5, 3
  s_and_b32 s14, s6, 4
  s_add_u32 s13, s13, s14
  s_cmp_eq_u32 s8, 0
  s_cselect_b32 s13, s13, 0x1000
  s_mov_b64 exec, 1
  buffer_atomic_or v15, v14, s[60:63], s13 offen offset:128 sc1
  s_mov_b64 exec, -1
  s_setprio 1
  ds_read_b64_tr_b16 v[16:17], v3 offset:72
  v_mfma_f32_16x16x32_bf16 v[52:55], v[20:23], v[124:127], v[52:55]
  ds_read_b64_tr_b16 v[18:19], v3 offset:4680
  ds_read_b128 v[128:131], v1 offset:0
  s_waitcnt lgkmcnt(7)
  v_mfma_f32_16x16x32_bf16 v[72:75], v[24:27], v[120:123], v[72:75]
  ds_read_b64_tr_b16 v[20:21], v3 offset:104
  v_mfma_f32_16x16x32_bf16 v[76:79], v[24:27], v[124:127], v[76:79]
  ds_read_b64_tr_b16 v[22:23], v3 offset:4712
  ds_read_b128 v[132:135], v1 offset:2048
  v_mfma_f32_16x16x32_bf16 v[80:83], v[28:31], v[120:123], v[80:83]
  ds_read_b64_tr_b16 v[24:25], v4 offset:0
  v_mfma_f32_16x16x32_bf16 v[84:87], v[28:31], v[124:127], v[84:87]
  ds_read_b64_tr_b16 v[26:27], v4 offset:4608
  s_waitcnt lgkmcnt(8)
  v_mfma_f32_16x16x32_bf16 v[88:91], v[32:35], v[120:123], v[88:91]
  ds_read_b64_tr_b16 v[28:29], v3 offset:0
  v_mfma_f32_16x16x32_bf16 v[92:95], v[32:35], v[124:127], v[92:95]
  ds_read_b64_tr_b16 v[30:31], v3 offset:4608
  v_mfma_f32_16x16x32_bf16 v[96:99], v[36:39], v[120:123], v[96:99]
  ds_read_b64_tr_b16 v[32:33], v3 offset:32
  v_mfma_f32_16x16x32_bf16 v[100:103], v[36:39], v[124:127], v[100:103]
  ds_read_b64_tr_b16 v[34:35], v3 offset:4640
  s_waitcnt lgkmcnt(7)
  v_mfma_f32_16x16x32_bf16 v[56:59], v[16:19], v[128:131], v[56:59]
  ds_read_b64_tr_b16 v[36:37], v3 offset:144
  s_waitcnt lgkmcnt(7)
  v_mfma_f32_16x16x32_bf16 v[60:63], v[16:19], v[132:135], v[60:63]
  ds_read_b64_tr_b16 v[38:39], v3 offset:4752
  v_mfma_f32_16x16x32_bf16 v[64:67], v[20:23], v[128:131], v[64:67]
  ds_read_b64_tr_b16 v[16:17], v3 offset:176
  v_mfma_f32_16x16x32_bf16 v[68:71], v[20:23], v[132:135], v[68:71]
  ds_read_b64_tr_b16 v[18:19], v3 offset:4784
  s_waitcnt lgkmcnt(6)
  v_mfma_f32_16x16x32_bf16 v[104:107], v[24:27], v[128:131], v[104:107]
  ds_read_b64_tr_b16 v[20:21], v3 offset:216
  v_mfma_f32_16x16x32_bf16 v[108:111], v[24:27], v[132:135], v[108:111]
  ds_read_b64_tr_b16 v[22:23], v3 offset:4824
  v_mfma_f32_16x16x32_bf16 v[40:43], v[28:31], v[128:131], v[40:43]
  ds_read_b64_tr_b16 v[24:25], v3 offset:248
  v_mfma_f32_16x16x32_bf16 v[44:47], v[28:31], v[132:135], v[44:47]
  ds_read_b64_tr_b16 v[26:27], v3 offset:4856
  s_waitcnt lgkmcnt(6)
  v_mfma_f32_16x16x32_bf16 v[48:51], v[32:35], v[128:131], v[48:51]
  ds_read_b64_tr_b16 v[28:29], v3 offset:9288
  v_mfma_f32_16x16x32_bf16 v[52:55], v[32:35], v[132:135], v[52:55]
  ds_read_b64_tr_b16 v[30:31], v3 offset:13896
  ds_read_b128 v[136:139], v2 offset:0
  v_mfma_f32_16x16x32_bf16 v[72:75], v[36:39], v[128:131], v[72:75]
  ds_read_b64_tr_b16 v[32:33], v3 offset:9320
  v_mfma_f32_16x16x32_bf16 v[76:79], v[36:39], v[132:135], v[76:79]
  ds_read_b64_tr_b16 v[34:35], v3 offset:13928
  ds_read_b128 v[140:143], v2 offset:2048
  s_waitcnt lgkmcnt(8)
  v_mfma_f32_16x16x32_bf16 v[80:83], v[16:19], v[128:131], v[80:83]
  ds_read_b64_tr_b16 v[36:37], v4 offset:9216
  v_mfma_f32_16x16x32_bf16 v[84:87], v[16:19], v[132:135], v[84:87]
  ds_read_b64_tr_b16 v[38:39], v4 offset:13824
  v_mfma_f32_16x16x32_bf16 v[88:91], v[20:23], v[128:131], v[88:91]
  ds_read_b64_tr_b16 v[16:17], v3 offset:9216
  v_mfma_f32_16x16x32_bf16 v[92:95], v[20:23], v[132:135], v[92:95]
  ds_read_b64_tr_b16 v[18:19], v3 offset:13824
  s_waitcnt lgkmcnt(8)
  v_mfma_f32_16x16x32_bf16 v[96:99], v[24:27], v[128:131], v[96:99]
  ds_read_b64_tr_b16 v[20:21], v3 offset:9248
  v_mfma_f32_16x16x32_bf16 v[100:103], v[24:27], v[132:135], v[100:103]
  ds_read_b64_tr_b16 v[22:23], v3 offset:13856
  s_waitcnt lgkmcnt(9)
  v_mfma_f32_16x16x32_bf16 v[56:59], v[28:31], v[136:139], v[56:59]
  ds_read_b64_tr_b16 v[24:25], v3 offset:9360
  s_waitcnt lgkmcnt(7)
  v_mfma_f32_16x16x32_bf16 v[60:63], v[28:31], v[140:143], v[60:63]
  ds_read_b64_tr_b16 v[26:27], v3 offset:13968
  s_waitcnt lgkmcnt(6)
  v_mfma_f32_16x16x32_bf16 v[64:67], v[32:35], v[136:139], v[64:67]
  ds_read_b64_tr_b16 v[28:29], v3 offset:9392
  v_mfma_f32_16x16x32_bf16 v[68:71], v[32:35], v[140:143], v[68:71]
  ds_read_b64_tr_b16 v[30:31], v3 offset:14000
  v_mfma_f32_16x16x32_bf16 v[104:107], v[36:39], v[136:139], v[104:107]
  ds_read_b64_tr_b16 v[32:33], v3 offset:9432
  v_mfma_f32_16x16x32_bf16 v[108:111], v[36:39], v[140:143], v[108:111]
  ds_read_b64_tr_b16 v[34:35], v3 offset:14040
  s_waitcnt lgkmcnt(6)
  v_mfma_f32_16x16x32_bf16 v[40:43], v[16:19], v[136:139], v[40:43]
  ds_read_b64_tr_b16 v[36:37], v3 offset:9464
  v_mfma_f32_16x16x32_bf16 v[44:47], v[16:19], v[140:143], v[44:47]
  ds_read_b64_tr_b16 v[38:39], v3 offset:14072
  v_mfma_f32_16x16x32_bf16 v[48:51], v[20:23], v[136:139], v[48:51]
  v_add_u32 v1, 34816, v1
  v_add_u32 v2, 34816, v2
  v_add_u32 v3, 34816, v3
  v_add_u32 v4, 34816, v4
  s_barrier
  ds_read_b64_tr_b16 v[16:17], v3 offset:72
  v_mfma_f32_16x16x32_bf16 v[52:55], v[20:23], v[140:143], v[52:55]
  ds_read_b64_tr_b16 v[18:19], v3 offset:4680
  ds_read_b128 v[144:147], v1 offset:0
  s_waitcnt lgkmcnt(7)
  v_mfma_f32_16x16x32_bf16 v[72:75], v[24:27], v[136:139], v[72:75]
  ds_read_b64_tr_b16 v[20:21], v3 offset:104
  v_mfma_f32_16x16x32_bf16 v[76:79], v[24:27], v[140:143], v[76:79]
  ds_read_b64_tr_b16 v[22:23], v3 offset:4712
  ds_read_b128 v[148:151], v1 offset:2048
  v_mfma_f32_16x16x32_bf16 v[80:83], v[28:31], v[136:139], v[80:83]
  ds_read_b64_tr_b16 v[24:25], v4 offset:0
  v_mfma_f32_16x16x32_bf16 v[84:87], v[28:31], v[140:143], v[84:87]
  ds_read_b64_tr_b16 v[26:27], v4 offset:4608
  s_waitcnt lgkmcnt(8)
  v_mfma_f32_16x16x32_bf16 v[88:91], v[32:35], v[136:139], v[88:91]
  ds_read_b64_tr_b16 v[28:29], v3 offset:0
  v_mfma_f32_16x16x32_bf16 v[92:95], v[32:35], v[140:143], v[92:95]
  ds_read_b64_tr_b16 v[30:31], v3 offset:4608
  v_mfma_f32_16x16x32_bf16 v[96:99], v[36:39], v[136:139], v[96:99]
  ds_read_b64_tr_b16 v[32:33], v3 offset:32
  v_mfma_f32_16x16x32_bf16 v[100:103], v[36:39], v[140:143], v[100:103]
  ds_read_b64_tr_b16 v[34:35], v3 offset:4640
  s_waitcnt lgkmcnt(7)
  v_mfma_f32_16x16x32_bf16 v[56:59], v[16:19], v[144:147], v[56:59]
  ds_read_b64_tr_b16 v[36:37], v3 offset:144
  s_waitcnt lgkmcnt(7)
  v_mfma_f32_16x16x32_bf16 v[60:63], v[16:19], v[148:151], v[60:63]
  ds_read_b64_tr_b16 v[38:39], v3 offset:4752
  v_mfma_f32_16x16x32_bf16 v[64:67], v[20:23], v[144:147], v[64:67]
  ds_read_b64_tr_b16 v[16:17], v3 offset:176
  v_mfma_f32_16x16x32_bf16 v[68:71], v[20:23], v[148:151], v[68:71]
  ds_read_b64_tr_b16 v[18:19], v3 offset:4784
  s_waitcnt lgkmcnt(6)
  v_mfma_f32_16x16x32_bf16 v[104:107], v[24:27], v[144:147], v[104:107]
  ds_read_b64_tr_b16 v[20:21], v3 offset:216
  v_mfma_f32_16x16x32_bf16 v[108:111], v[24:27], v[148:151], v[108:111]
  ds_read_b64_tr_b16 v[22:23], v3 offset:4824
  v_mfma_f32_16x16x32_bf16 v[40:43], v[28:31], v[144:147], v[40:43]
  ds_read_b64_tr_b16 v[24:25], v3 offset:248
  v_mfma_f32_16x16x32_bf16 v[44:47], v[28:31], v[148:151], v[44:47]
  ds_read_b64_tr_b16 v[26:27], v3 offset:4856
  s_waitcnt lgkmcnt(6)
  v_mfma_f32_16x16x32_bf16 v[48:51], v[32:35], v[144:147], v[48:51]
  ds_read_b64_tr_b16 v[28:29], v3 offset:9288
  v_mfma_f32_16x16x32_bf16 v[52:55], v[32:35], v[148:151], v[52:55]
  ds_read_b64_tr_b16 v[30:31], v3 offset:13896
  ds_read_b128 v[152:155], v2 offset:0
  v_mfma_f32_16x16x32_bf16 v[72:75], v[36:39], v[144:147], v[72:75]
  ds_read_b64_tr_b16 v[32:33], v3 offset:9320
  v_mfma_f32_16x16x32_bf16 v[76:79], v[36:39], v[148:151], v[76:79]
  ds_read_b64_tr_b16 v[34:35], v3 offset:13928
  ds_read_b128 v[156:159], v2 offset:2048
  s_waitcnt lgkmcnt(8)
  v_mfma_f32_16x16x32_bf16 v[80:83], v[16:19], v[144:147], v[80:83]
  ds_read_b64_tr_b16 v[36:37], v4 offset:9216
  v_mfma_f32_16x16x32_bf16 v[84:87], v[16:19], v[148:151], v[84:87]
  ds_read_b64_tr_b16 v[38:39], v4 offset:13824
  v_mfma_f32_16x16x32_bf16 v[88:91], v[20:23], v[144:147], v[88:91]
  ds_read_b64_tr_b16 v[16:17], v3 offset:9216
  v_mfma_f32_16x16x32_bf16 v[92:95], v[20:23], v[148:151], v[92:95]
  ds_read_b64_tr_b16 v[18:19], v3 offset:13824
  s_waitcnt lgkmcnt(8)
  v_mfma_f32_16x16x32_bf16 v[96:99], v[24:27], v[144:147], v[96:99]
  ds_read_b64_tr_b16 v[20:21], v3 offset:9248
  v_mfma_f32_16x16x32_bf16 v[100:103], v[24:27], v[148:151], v[100:103]
  ds_read_b64_tr_b16 v[22:23], v3 offset:13856
  s_waitcnt lgkmcnt(9)
  v_mfma_f32_16x16x32_bf16 v[56:59], v[28:31], v[152:155], v[56:59]
  ds_read_b64_tr_b16 v[24:25], v3 offset:9360
  s_waitcnt lgkmcnt(7)
  v_mfma_f32_16x16x32_bf16 v[60:63], v[28:31], v[156:159], v[60:63]
  ds_read_b64_tr_b16 v[26:27], v3 offset:13968
  s_waitcnt lgkmcnt(6)
  v_mfma_f32_16x16x32_bf16 v[64:67], v[32:35], v[152:155], v[64:67]
  ds_read_b64_tr_b16 v[28:29], v3 offset:9392
  v_mfma_f32_16x16x32_bf16 v[68:71], v[32:35], v[156:159], v[68:71]
  ds_read_b64_tr_b16 v[30:31], v3 offset:14000
  v_mfma_f32_16x16x32_bf16 v[104:107], v[36:39], v[152:155], v[104:107]
  ds_read_b64_tr_b16 v[32:33], v3 offset:9432
  v_mfma_f32_16x16x32_bf16 v[108:111], v[36:39], v[156:159], v[108:111]
  ds_read_b64_tr_b16 v[34:35], v3 offset:14040
  s_waitcnt lgkmcnt(6)
  v_mfma_f32_16x16x32_bf16 v[40:43], v[16:19], v[152:155], v[40:43]
  ds_read_b64_tr_b16 v[36:37], v3 offset:9464
  v_mfma_f32_16x16x32_bf16 v[44:47], v[16:19], v[156:159], v[44:47]
  ds_read_b64_tr_b16 v[38:39], v3 offset:14072
  v_mfma_f32_16x16x32_bf16 v[48:51], v[20:23], v[152:155], v[48:51]
  v_add_u32 v1, 34816, v1
  v_add_u32 v2, 34816, v2
  v_add_u32 v3, 34816, v3
  v_add_u32 v4, 34816, v4
  s_barrier
  ds_read_b64_tr_b16 v[16:17], v3 offset:72
  v_mfma_f32_16x16x32_bf16 v[52:55], v[20:23], v[156:159], v[52:55]
  ds_read_b64_tr_b16 v[18:19], v3 offset:4680
  ds_read_b128 v[160:163], v1 offset:0
  s_waitcnt lgkmcnt(7)
  v_mfma_f32_16x16x32_bf16 v[72:75], v[24:27], v[152:155], v[72:75]
  ds_read_b64_tr_b16 v[20:21], v3 offset:104
  v_mfma_f32_16x16x32_bf16 v[76:79], v[24:27], v[156:159], v[76:79]
  ds_read_b64_tr_b16 v[22:23], v3 offset:4712
  ds_read_b128 v[164:167], v1 offset:2048
  v_mfma_f32_16x16x32_bf16 v[80:83], v[28:31], v[152:155], v[80:83]
  ds_read_b64_tr_b16 v[24:25], v4 offset:0
  v_mfma_f32_16x16x32_bf16 v[84:87], v[28:31], v[156:159], v[84:87]
  ds_read_b64_tr_b16 v[26:27], v4 offset:4608
  s_waitcnt lgkmcnt(8)
  v_mfma_f32_16x16x32_bf16 v[88:91], v[32:35], v[152:155], v[88:91]
  ds_read_b64_tr_b16 v[28:29], v3 offset:0
  v_mfma_f32_16x16x32_bf16 v[92:95], v[32:35], v[156:159], v[92:95]
  ds_read_b64_tr_b16 v[30:31], v3 offset:4608
  v_mfma_f32_16x16x32_bf16 v[96:99], v[36:39], v[152:155], v[96:99]
  ds_read_b64_tr_b16 v[32:33], v3 offset:32
  v_mfma_f32_16x16x32_bf16 v[100:103], v[36:39], v[156:159], v[100:103]
  ds_read_b64_tr_b16 v[34:35], v3 offset:4640
  s_waitcnt lgkmcnt(7)
  v_mfma_f32_16x16x32_bf16 v[56:59], v[16:19], v[160:163], v[56:59]
  ds_read_b64_tr_b16 v[36:37], v3 offset:144
  s_waitcnt lgkmcnt(7)
  v_mfma_f32_16x16x32_bf16 v[60:63], v[16:19], v[164:167], v[60:63]
  ds_read_b64_tr_b16 v[38:39], v3 offset:4752
  v_mfma_f32_16x16x32_bf16 v[64:67], v[20:23], v[160:163], v[64:67]
  ds_read_b64_tr_b16 v[16:17], v3 offset:176
  v_mfma_f32_16x16x32_bf16 v[68:71], v[20:23], v[164:167], v[68:71]
  ds_read_b64_tr_b16 v[18:19], v3 offset:4784
  s_waitcnt lgkmcnt(6)
  v_mfma_f32_16x16x32_bf16 v[104:107], v[24:27], v[160:163], v[104:107]
  ds_read_b64_tr_b16 v[20:21], v3 offset:216
  v_mfma_f32_16x16x32_bf16 v[108:111], v[24:27], v[164:167], v[108:111]
  ds_read_b64_tr_b16 v[22:23], v3 offset:4824
  v_mfma_f32_16x16x32_bf16 v[40:43], v[28:31], v[160:163], v[40:43]
  ds_read_b64_tr_b16 v[24:25], v3 offset:248
  v_mfma_f32_16x16x32_bf16 v[44:47], v[28:31], v[164:167], v[44:47]
  ds_read_b64_tr_b16 v[26:27], v3 offset:4856
  s_waitcnt lgkmcnt(6)
  v_mfma_f32_16x16x32_bf16 v[48:51], v[32:35], v[160:163], v[48:51]
  ds_read_b64_tr_b16 v[28:29], v3 offset:9288
  v_mfma_f32_16x16x32_bf16 v[52:55], v[32:35], v[164:167], v[52:55]
  ds_read_b64_tr_b16 v[30:31], v3 offset:13896
  ds_read_b128 v[168:171], v2 offset:0
  v_mfma_f32_16x16x32_bf16 v[72:75], v[36:39], v[160:163], v[72:75]
  ds_read_b64_tr_b16 v[32:33], v3 offset:9320
  v_mfma_f32_16x16x32_bf16 v[76:79], v[36:39], v[164:167], v[76:79]
  ds_read_b64_tr_b16 v[34:35], v3 offset:13928
  ds_read_b128 v[172:175], v2 offset:2048
  s_waitcnt lgkmcnt(8)
  v_mfma_f32_16x16x32_bf16 v[80:83], v[16:19], v[160:163], v[80:83]
  ds_read_b64_tr_b16 v[36:37], v4 offset:9216
  v_mfma_f32_16x16x32_bf16 v[84:87], v[16:19], v[164:167], v[84:87]
  ds_read_b64_tr_b16 v[38:39], v4 offset:13824
  v_mfma_f32_16x16x32_bf16 v[88:91], v[20:23], v[160:163], v[88:91]
  ds_read_b64_tr_b16 v[16:17], v3 offset:9216
  v_mfma_f32_16x16x32_bf16 v[92:95], v[20:23], v[164:167], v[92:95]
  ds_read_b64_tr_b16 v[18:19], v3 offset:13824
  s_waitcnt lgkmcnt(8)
  v_mfma_f32_16x16x32_bf16 v[96:99], v[24:27], v[160:163], v[96:99]
  ds_read_b64_tr_b16 v[20:21], v3 offset:9248
  v_mfma_f32_16x16x32_bf16 v[100:103], v[24:27], v[164:167], v[100:103]
  ds_read_b64_tr_b16 v[22:23], v3 offset:13856
  s_waitcnt lgkmcnt(9)
  v_mfma_f32_16x16x32_bf16 v[56:59], v[28:31], v[168:171], v[56:59]
  ds_read_b64_tr_b16 v[24:25], v3 offset:9360
  s_waitcnt lgkmcnt(7)
  v_mfma_f32_16x16x32_bf16 v[60:63], v[28:31], v[172:175], v[60:63]
  ds_read_b64_tr_b16 v[26:27], v3 offset:13968
  s_waitcnt lgkmcnt(6)
  v_mfma_f32_16x16x32_bf16 v[64:67], v[32:35], v[168:171], v[64:67]
  ds_read_b64_tr_b16 v[28:29], v3 offset:9392
  v_mfma_f32_16x16x32_bf16 v[68:71], v[32:35], v[172:175], v[68:71]
  ds_read_b64_tr_b16 v[30:31], v3 offset:14000
  v_mfma_f32_16x16x32_bf16 v[104:107], v[36:39], v[168:171], v[104:107]
  ds_read_b64_tr_b16 v[32:33], v3 offset:9432
  v_mfma_f32_16x16x32_bf16 v[108:111], v[36:39], v[172:175], v[108:111]
  ds_read_b64_tr_b16 v[34:35], v3 offset:14040
  s_waitcnt lgkmcnt(6)
  v_mfma_f32_16x16x32_bf16 v[40:43], v[16:19], v[168:171], v[40:43]
  ds_read_b64_tr_b16 v[36:37], v3 offset:9464
  v_mfma_f32_16x16x32_bf16 v[44:47], v[16:19], v[172:175], v[44:47]
  ds_read_b64_tr_b16 v[38:39], v3 offset:14072
  v_mfma_f32_16x16x32_bf16 v[48:51], v[20:23], v[168:171], v[48:51]
  v_add_u32 v1, 34816, v1
  v_add_u32 v2, 34816, v2
  v_add_u32 v3, 34816, v3
  v_add_u32 v4, 34816, v4
  s_barrier
  ds_read_b64_tr_b16 v[16:17], v3 offset:72
  v_mfma_f32_16x16x32_bf16 v[52:55], v[20:23], v[172:175], v[52:55]
  ds_read_b64_tr_b16 v[18:19], v3 offset:4680
  ds_read_b128 v[176:179], v1 offset:0
  s_waitcnt lgkmcnt(7)
  v_mfma_f32_16x16x32_bf16 v[72:75], v[24:27], v[168:171], v[72:75]
  ds_read_b64_tr_b16 v[20:21], v3 offset:104
  v_mfma_f32_16x16x32_bf16 v[76:79], v[24:27], v[172:175], v[76:79]
  ds_read_b64_tr_b16 v[22:23], v3 offset:4712
  ds_read_b128 v[180:183], v1 offset:2048
  v_mfma_f32_16x16x32_bf16 v[80:83], v[28:31], v[168:171], v[80:83]
  ds_read_b64_tr_b16 v[24:25], v4 offset:0
  v_mfma_f32_16x16x32_bf16 v[84:87], v[28:31], v[172:175], v[84:87]
  ds_read_b64_tr_b16 v[26:27], v4 offset:4608
  s_waitcnt lgkmcnt(8)
  v_mfma_f32_16x16x32_bf16 v[88:91], v[32:35], v[168:171], v[88:91]
  ds_read_b64_tr_b16 v[28:29], v3 offset:0
  v_mfma_f32_16x16x32_bf16 v[92:95], v[32:35], v[172:175], v[92:95]
  ds_read_b64_tr_b16 v[30:31], v3 offset:4608
  v_mfma_f32_16x16x32_bf16 v[96:99], v[36:39], v[168:171], v[96:99]
  ds_read_b64_tr_b16 v[32:33], v3 offset:32
  v_mfma_f32_16x16x32_bf16 v[100:103], v[36:39], v[172:175], v[100:103]
  ds_read_b64_tr_b16 v[34:35], v3 offset:4640
  s_waitcnt lgkmcnt(7)
  v_mfma_f32_16x16x32_bf16 v[56:59], v[16:19], v[176:179], v[56:59]
  ds_read_b64_tr_b16 v[36:37], v3 offset:144
  s_waitcnt lgkmcnt(7)
  v_mfma_f32_16x16x32_bf16 v[60:63], v[16:19], v[180:183], v[60:63]
  ds_read_b64_tr_b16 v[38:39], v3 offset:4752
  v_mfma_f32_16x16x32_bf16 v[64:67], v[20:23], v[176:179], v[64:67]
  ds_read_b64_tr_b16 v[16:17], v3 offset:176
  v_mfma_f32_16x16x32_bf16 v[68:71], v[20:23], v[180:183], v[68:71]
  ds_read_b64_tr_b16 v[18:19], v3 offset:4784
  s_waitcnt lgkmcnt(6)
  v_mfma_f32_16x16x32_bf16 v[104:107], v[24:27], v[176:179], v[104:107]
  ds_read_b64_tr_b16 v[20:21], v3 offset:216
  v_mfma_f32_16x16x32_bf16 v[108:111], v[24:27], v[180:183], v[108:111]
  ds_read_b64_tr_b16 v[22:23], v3 offset:4824
  v_mfma_f32_16x16x32_bf16 v[40:43], v[28:31], v[176:179], v[40:43]
  ds_read_b64_tr_b16 v[24:25], v3 offset:248
  v_mfma_f32_16x16x32_bf16 v[44:47], v[28:31], v[180:183], v[44:47]
  ds_read_b64_tr_b16 v[26:27], v3 offset:4856
  s_waitcnt lgkmcnt(6)
  v_mfma_f32_16x16x32_bf16 v[48:51], v[32:35], v[176:179], v[48:51]
  ds_read_b64_tr_b16 v[28:29], v3 offset:9288
  v_mfma_f32_16x16x32_bf16 v[52:55], v[32:35], v[180:183], v[52:55]
  ds_read_b64_tr_b16 v[30:31], v3 offset:13896
  ds_read_b128 v[184:187], v2 offset:0
  v_mfma_f32_16x16x32_bf16 v[72:75], v[36:39], v[176:179], v[72:75]
  ds_read_b64_tr_b16 v[32:33], v3 offset:9320
  v_mfma_f32_16x16x32_bf16 v[76:79], v[36:39], v[180:183], v[76:79]
  ds_read_b64_tr_b16 v[34:35], v3 offset:13928
  ds_read_b128 v[188:191], v2 offset:2048
  s_waitcnt lgkmcnt(8)
  v_mfma_f32_16x16x32_bf16 v[80:83], v[16:19], v[176:179], v[80:83]
  ds_read_b64_tr_b16 v[36:37], v4 offset:9216
  v_mfma_f32_16x16x32_bf16 v[84:87], v[16:19], v[180:183], v[84:87]
  ds_read_b64_tr_b16 v[38:39], v4 offset:13824
  v_mfma_f32_16x16x32_bf16 v[88:91], v[20:23], v[176:179], v[88:91]
  ds_read_b64_tr_b16 v[16:17], v3 offset:9216
  v_mfma_f32_16x16x32_bf16 v[92:95], v[20:23], v[180:183], v[92:95]
  ds_read_b64_tr_b16 v[18:19], v3 offset:13824
  s_waitcnt lgkmcnt(8)
  v_mfma_f32_16x16x32_bf16 v[96:99], v[24:27], v[176:179], v[96:99]
  ds_read_b64_tr_b16 v[20:21], v3 offset:9248
  v_mfma_f32_16x16x32_bf16 v[100:103], v[24:27], v[180:183], v[100:103]
  ds_read_b64_tr_b16 v[22:23], v3 offset:13856
  s_waitcnt lgkmcnt(9)
  v_mfma_f32_16x16x32_bf16 v[56:59], v[28:31], v[184:187], v[56:59]
  ds_read_b64_tr_b16 v[24:25], v3 offset:9360
  s_waitcnt lgkmcnt(7)
  v_mfma_f32_16x16x32_bf16 v[60:63], v[28:31], v[188:191], v[60:63]
  ds_read_b64_tr_b16 v[26:27], v3 offset:13968
  s_waitcnt lgkmcnt(6)
  v_mfma_f32_16x16x32_bf16 v[64:67], v[32:35], v[184:187], v[64:67]
  ds_read_b64_tr_b16 v[28:29], v3 offset:9392
  v_mfma_f32_16x16x32_bf16 v[68:71], v[32:35], v[188:191], v[68:71]
  ds_read_b64_tr_b16 v[30:31], v3 offset:14000
  v_mfma_f32_16x16x32_bf16 v[104:107], v[36:39], v[184:187], v[104:107]
  ds_read_b64_tr_b16 v[32:33], v3 offset:9432
  v_mfma_f32_16x16x32_bf16 v[108:111], v[36:39], v[188:191], v[108:111]
  ds_read_b64_tr_b16 v[34:35], v3 offset:14040
  s_waitcnt lgkmcnt(6)
  v_mfma_f32_16x16x32_bf16 v[40:43], v[16:19], v[184:187], v[40:43]
  ds_read_b64_tr_b16 v[36:37], v3 offset:9464
  v_mfma_f32_16x16x32_bf16 v[44:47], v[16:19], v[188:191], v[44:47]
  ds_read_b64_tr_b16 v[38:39], v3 offset:14072
  v_mfma_f32_16x16x32_bf16 v[48:51], v[20:23], v[184:187], v[48:51]
  v_add_u32 v1, 4294862848, v1
  v_add_u32 v2, 4294862848, v2
  v_add_u32 v3, 4294862848, v3
  v_add_u32 v4, 4294862848, v4
  s_barrier
  ds_read_b64_tr_b16 v[16:17], v3 offset:72
  v_mfma_f32_16x16x32_bf16 v[52:55], v[20:23], v[188:191], v[52:55]
  ds_read_b64_tr_b16 v[18:19], v3 offset:4680
  ds_read_b128 v[192:195], v1 offset:0
  s_waitcnt lgkmcnt(7)
  v_mfma_f32_16x16x32_bf16 v[72:75], v[24:27], v[184:187], v[72:75]
  ds_read_b64_tr_b16 v[20:21], v3 offset:104
  v_mfma_f32_16x16x32_bf16 v[76:79], v[24:27], v[188:191], v[76:79]
  ds_read_b64_tr_b16 v[22:23], v3 offset:4712
  ds_read_b128 v[196:199], v1 offset:2048
  v_mfma_f32_16x16x32_bf16 v[80:83], v[28:31], v[184:187], v[80:83]
  ds_read_b64_tr_b16 v[24:25], v4 offset:0
  v_mfma_f32_16x16x32_bf16 v[84:87], v[28:31], v[188:191], v[84:87]
  ds_read_b64_tr_b16 v[26:27], v4 offset:4608
  s_waitcnt lgkmcnt(8)
  v_mfma_f32_16x16x32_bf16 v[88:91], v[32:35], v[184:187], v[88:91]
  ds_read_b64_tr_b16 v[28:29], v3 offset:0
  v_mfma_f32_16x16x32_bf16 v[92:95], v[32:35], v[188:191], v[92:95]
  ds_read_b64_tr_b16 v[30:31], v3 offset:4608
  v_mfma_f32_16x16x32_bf16 v[96:99], v[36:39], v[184:187], v[96:99]
  ds_read_b64_tr_b16 v[32:33], v3 offset:32
  v_mfma_f32_16x16x32_bf16 v[100:103], v[36:39], v[188:191], v[100:103]
  ds_read_b64_tr_b16 v[34:35], v3 offset:4640
  s_waitcnt lgkmcnt(7)
  v_mfma_f32_16x16x32_bf16 v[56:59], v[16:19], v[192:195], v[56:59]
  ds_read_b64_tr_b16 v[36:37], v3 offset:144
  s_waitcnt lgkmcnt(7)
  v_mfma_f32_16x16x32_bf16 v[60:63], v[16:19], v[196:199], v[60:63]
  ds_read_b64_tr_b16 v[38:39], v3 offset:4752
  v_mfma_f32_16x16x32_bf16 v[64:67], v[20:23], v[192:195], v[64:67]
  ds_read_b64_tr_b16 v[16:17], v3 offset:176
  v_mfma_f32_16x16x32_bf16 v[68:71], v[20:23], v[196:199], v[68:71]
  ds_read_b64_tr_b16 v[18:19], v3 offset:4784
  s_waitcnt lgkmcnt(6)
  v_mfma_f32_16x16x32_bf16 v[104:107], v[24:27], v[192:195], v[104:107]
  ds_read_b64_tr_b16 v[20:21], v3 offset:216
  v_mfma_f32_16x16x32_bf16 v[108:111], v[24:27], v[196:199], v[108:111]
  ds_read_b64_tr_b16 v[22:23], v3 offset:4824
  v_mfma_f32_16x16x32_bf16 v[40:43], v[28:31], v[192:195], v[40:43]
  ds_read_b64_tr_b16 v[24:25], v3 offset:248
  v_mfma_f32_16x16x32_bf16 v[44:47], v[28:31], v[196:199], v[44:47]
  ds_read_b64_tr_b16 v[26:27], v3 offset:4856
  s_waitcnt lgkmcnt(6)
  v_mfma_f32_16x16x32_bf16 v[48:51], v[32:35], v[192:195], v[48:51]
  ds_read_b64_tr_b16 v[28:29], v3 offset:9288
  v_mfma_f32_16x16x32_bf16 v[52:55], v[32:35], v[196:199], v[52:55]
  ds_read_b64_tr_b16 v[30:31], v3 offset:13896
  ds_read_b128 v[200:203], v2 offset:0
  v_mfma_f32_16x16x32_bf16 v[72:75], v[36:39], v[192:195], v[72:75]
  ds_read_b64_tr_b16 v[32:33], v3 offset:9320
  v_mfma_f32_16x16x32_bf16 v[76:79], v[36:39], v[196:199], v[76:79]
  ds_read_b64_tr_b16 v[34:35], v3 offset:13928
  ds_read_b128 v[204:207], v2 offset:2048
  s_waitcnt lgkmcnt(8)
  v_mfma_f32_16x16x32_bf16 v[80:83], v[16:19], v[192:195], v[80:83]
  ds_read_b64_tr_b16 v[36:37], v4 offset:9216
  v_mfma_f32_16x16x32_bf16 v[84:87], v[16:19], v[196:199], v[84:87]
  ds_read_b64_tr_b16 v[38:39], v4 offset:13824
  v_mfma_f32_16x16x32_bf16 v[88:91], v[20:23], v[192:195], v[88:91]
  ds_read_b64_tr_b16 v[16:17], v3 offset:9216
  v_mfma_f32_16x16x32_bf16 v[92:95], v[20:23], v[196:199], v[92:95]
  ds_read_b64_tr_b16 v[18:19], v3 offset:13824
  s_waitcnt lgkmcnt(8)
  v_mfma_f32_16x16x32_bf16 v[96:99], v[24:27], v[192:195], v[96:99]
  ds_read_b64_tr_b16 v[20:21], v3 offset:9248
  v_mfma_f32_16x16x32_bf16 v[100:103], v[24:27], v[196:199], v[100:103]
  ds_read_b64_tr_b16 v[22:23], v3 offset:13856
  s_waitcnt lgkmcnt(9)
  v_mfma_f32_16x16x32_bf16 v[56:59], v[28:31], v[200:203], v[56:59]
  ds_read_b64_tr_b16 v[24:25], v3 offset:9360
  s_waitcnt lgkmcnt(7)
  v_mfma_f32_16x16x32_bf16 v[60:63], v[28:31], v[204:207], v[60:63]
  ds_read_b64_tr_b16 v[26:27], v3 offset:13968
  s_waitcnt lgkmcnt(6)
  v_mfma_f32_16x16x32_bf16 v[64:67], v[32:35], v[200:203], v[64:67]
  ds_read_b64_tr_b16 v[28:29], v3 offset:9392
  v_mfma_f32_16x16x32_bf16 v[68:71], v[32:35], v[204:207], v[68:71]
  ds_read_b64_tr_b16 v[30:31], v3 offset:14000
  v_mfma_f32_16x16x32_bf16 v[104:107], v[36:39], v[200:203], v[104:107]
  ds_read_b64_tr_b16 v[32:33], v3 offset:9432
  v_mfma_f32_16x16x32_bf16 v[108:111], v[36:39], v[204:207], v[108:111]
  ds_read_b64_tr_b16 v[34:35], v3 offset:14040
  s_waitcnt lgkmcnt(6)
  v_mfma_f32_16x16x32_bf16 v[40:43], v[16:19], v[200:203], v[40:43]
  ds_read_b64_tr_b16 v[36:37], v3 offset:9464
  v_mfma_f32_16x16x32_bf16 v[44:47], v[16:19], v[204:207], v[44:47]
  ds_read_b64_tr_b16 v[38:39], v3 offset:14072
  v_mfma_f32_16x16x32_bf16 v[48:51], v[20:23], v[200:203], v[48:51]
  v_add_u32 v1, 34816, v1
  v_add_u32 v2, 34816, v2
  v_add_u32 v3, 34816, v3
  v_add_u32 v4, 34816, v4
  s_barrier
  ds_read_b64_tr_b16 v[16:17], v3 offset:72
  v_mfma_f32_16x16x32_bf16 v[52:55], v[20:23], v[204:207], v[52:55]
  ds_read_b64_tr_b16 v[18:19], v3 offset:4680
  ds_read_b128 v[208:211], v1 offset:0
  s_waitcnt lgkmcnt(7)
  v_mfma_f32_16x16x32_bf16 v[72:75], v[24:27], v[200:203], v[72:75]
  ds_read_b64_tr_b16 v[20:21], v3 offset:104
  v_mfma_f32_16x16x32_bf16 v[76:79], v[24:27], v[204:207], v[76:79]
  ds_read_b64_tr_b16 v[22:23], v3 offset:4712
  ds_read_b128 v[212:215], v1 offset:2048
  v_mfma_f32_16x16x32_bf16 v[80:83], v[28:31], v[200:203], v[80:83]
  ds_read_b64_tr_b16 v[24:25], v4 offset:0
  v_mfma_f32_16x16x32_bf16 v[84:87], v[28:31], v[204:207], v[84:87]
  ds_read_b64_tr_b16 v[26:27], v4 offset:4608
  s_waitcnt lgkmcnt(8)
  v_mfma_f32_16x16x32_bf16 v[88:91], v[32:35], v[200:203], v[88:91]
  ds_read_b64_tr_b16 v[28:29], v3 offset:0
  v_mfma_f32_16x16x32_bf16 v[92:95], v[32:35], v[204:207], v[92:95]
  ds_read_b64_tr_b16 v[30:31], v3 offset:4608
  v_mfma_f32_16x16x32_bf16 v[96:99], v[36:39], v[200:203], v[96:99]
  ds_read_b64_tr_b16 v[32:33], v3 offset:32
  v_mfma_f32_16x16x32_bf16 v[100:103], v[36:39], v[204:207], v[100:103]
  ds_read_b64_tr_b16 v[34:35], v3 offset:4640
  s_waitcnt lgkmcnt(7)
  v_mfma_f32_16x16x32_bf16 v[56:59], v[16:19], v[208:211], v[56:59]
  ds_read_b64_tr_b16 v[36:37], v3 offset:144
  s_waitcnt lgkmcnt(7)
  v_mfma_f32_16x16x32_bf16 v[60:63], v[16:19], v[212:215], v[60:63]
  ds_read_b64_tr_b16 v[38:39], v3 offset:4752
  v_mfma_f32_16x16x32_bf16 v[64:67], v[20:23], v[208:211], v[64:67]
  ds_read_b64_tr_b16 v[16:17], v3 offset:176
  v_mfma_f32_16x16x32_bf16 v[68:71], v[20:23], v[212:215], v[68:71]
  ds_read_b64_tr_b16 v[18:19], v3 offset:4784
  s_waitcnt lgkmcnt(6)
  v_mfma_f32_16x16x32_bf16 v[104:107], v[24:27], v[208:211], v[104:107]
  ds_read_b64_tr_b16 v[20:21], v3 offset:216
  v_mfma_f32_16x16x32_bf16 v[108:111], v[24:27], v[212:215], v[108:111]
  ds_read_b64_tr_b16 v[22:23], v3 offset:4824
  v_mfma_f32_16x16x32_bf16 v[40:43], v[28:31], v[208:211], v[40:43]
  ds_read_b64_tr_b16 v[24:25], v3 offset:248
  v_mfma_f32_16x16x32_bf16 v[44:47], v[28:31], v[212:215], v[44:47]
  ds_read_b64_tr_b16 v[26:27], v3 offset:4856
  s_waitcnt lgkmcnt(6)
  v_mfma_f32_16x16x32_bf16 v[48:51], v[32:35], v[208:211], v[48:51]
  ds_read_b64_tr_b16 v[28:29], v3 offset:9288
  v_mfma_f32_16x16x32_bf16 v[52:55], v[32:35], v[212:215], v[52:55]
  ds_read_b64_tr_b16 v[30:31], v3 offset:13896
  ds_read_b128 v[216:219], v2 offset:0
  v_mfma_f32_16x16x32_bf16 v[72:75], v[36:39], v[208:211], v[72:75]
  ds_read_b64_tr_b16 v[32:33], v3 offset:9320
  v_mfma_f32_16x16x32_bf16 v[76:79], v[36:39], v[212:215], v[76:79]
  ds_read_b64_tr_b16 v[34:35], v3 offset:13928
  ds_read_b128 v[220:223], v2 offset:2048
  s_waitcnt lgkmcnt(8)
  v_mfma_f32_16x16x32_bf16 v[80:83], v[16:19], v[208:211], v[80:83]
  ds_read_b64_tr_b16 v[36:37], v4 offset:9216
  v_mfma_f32_16x16x32_bf16 v[84:87], v[16:19], v[212:215], v[84:87]
  ds_read_b64_tr_b16 v[38:39], v4 offset:13824
  v_mfma_f32_16x16x32_bf16 v[88:91], v[20:23], v[208:211], v[88:91]
  ds_read_b64_tr_b16 v[16:17], v3 offset:9216
  v_mfma_f32_16x16x32_bf16 v[92:95], v[20:23], v[212:215], v[92:95]
  ds_read_b64_tr_b16 v[18:19], v3 offset:13824
  s_waitcnt lgkmcnt(8)
  v_mfma_f32_16x16x32_bf16 v[96:99], v[24:27], v[208:211], v[96:99]
  ds_read_b64_tr_b16 v[20:21], v3 offset:9248
  v_mfma_f32_16x16x32_bf16 v[100:103], v[24:27], v[212:215], v[100:103]
  ds_read_b64_tr_b16 v[22:23], v3 offset:13856
  s_waitcnt lgkmcnt(9)
  v_mfma_f32_16x16x32_bf16 v[56:59], v[28:31], v[216:219], v[56:59]
  ds_read_b64_tr_b16 v[24:25], v3 offset:9360
  s_waitcnt lgkmcnt(7)
  v_mfma_f32_16x16x32_bf16 v[60:63], v[28:31], v[220:223], v[60:63]
  ds_read_b64_tr_b16 v[26:27], v3 offset:13968
  s_waitcnt lgkmcnt(6)
  v_mfma_f32_16x16x32_bf16 v[64:67], v[32:35], v[216:219], v[64:67]
  ds_read_b64_tr_b16 v[28:29], v3 offset:9392
  v_mfma_f32_16x16x32_bf16 v[68:71], v[32:35], v[220:223], v[68:71]
  ds_read_b64_tr_b16 v[30:31], v3 offset:14000
  v_mfma_f32_16x16x32_bf16 v[104:107], v[36:39], v[216:219], v[104:107]
  ds_read_b64_tr_b16 v[32:33], v3 offset:9432
  v_mfma_f32_16x16x32_bf16 v[108:111], v[36:39], v[220:223], v[108:111]
  ds_read_b64_tr_b16 v[34:35], v3 offset:14040
  s_waitcnt lgkmcnt(6)
  v_mfma_f32_16x16x32_bf16 v[40:43], v[16:19], v[216:219], v[40:43]
  ds_read_b64_tr_b16 v[36:37], v3 offset:9464
  v_mfma_f32_16x16x32_bf16 v[44:47], v[16:19], v[220:223], v[44:47]
  ds_read_b64_tr_b16 v[38:39], v3 offset:14072
  v_mfma_f32_16x16x32_bf16 v[48:51], v[20:23], v[216:219], v[48:51]
  v_add_u32 v1, 34816, v1
  v_add_u32 v2, 34816, v2
  v_add_u32 v3, 34816, v3
  v_add_u32 v4, 34816, v4
  s_barrier
  ds_read_b64_tr_b16 v[16:17], v3 offset:72
  v_mfma_f32_16x16x32_bf16 v[52:55], v[20:23], v[220:223], v[52:55]
  ds_read_b64_tr_b16 v[18:19], v3 offset:4680
  ds_read_b128 v[224:227], v1 offset:0
  s_waitcnt lgkmcnt(7)
  v_mfma_f32_16x16x32_bf16 v[72:75], v[24:27], v[216:219], v[72:75]
  ds_read_b64_tr_b16 v[20:21], v3 offset:104
  v_mfma_f32_16x16x32_bf16 v[76:79], v[24:27], v[220:223], v[76:79]
  ds_read_b64_tr_b16 v[22:23], v3 offset:4712
  ds_read_b128 v[228:231], v1 offset:2048
  v_mfma_f32_16x16x32_bf16 v[80:83], v[28:31], v[216:219], v[80:83]
  ds_read_b64_tr_b16 v[24:25], v4 offset:0
  v_mfma_f32_16x16x32_bf16 v[84:87], v[28:31], v[220:223], v[84:87]
  ds_read_b64_tr_b16 v[26:27], v4 offset:4608
  s_waitcnt lgkmcnt(8)
  v_mfma_f32_16x16x32_bf16 v[88:91], v[32:35], v[216:219], v[88:91]
  ds_read_b64_tr_b16 v[28:29], v3 offset:0
  v_mfma_f32_16x16x32_bf16 v[92:95], v[32:35], v[220:223], v[92:95]
  ds_read_b64_tr_b16 v[30:31], v3 offset:4608
  v_mfma_f32_16x16x32_bf16 v[96:99], v[36:39], v[216:219], v[96:99]
  ds_read_b64_tr_b16 v[32:33], v3 offset:32
  v_mfma_f32_16x16x32_bf16 v[100:103], v[36:39], v[220:223], v[100:103]
  ds_read_b64_tr_b16 v[34:35], v3 offset:4640
  s_waitcnt lgkmcnt(7)
  v_mfma_f32_16x16x32_bf16 v[56:59], v[16:19], v[224:227], v[56:59]
  ds_read_b64_tr_b16 v[36:37], v3 offset:144
  s_waitcnt lgkmcnt(7)
  v_mfma_f32_16x16x32_bf16 v[60:63], v[16:19], v[228:231], v[60:63]
  ds_read_b64_tr_b16 v[38:39], v3 offset:4752
  v_mfma_f32_16x16x32_bf16 v[64:67], v[20:23], v[224:227], v[64:67]
  ds_read_b64_tr_b16 v[16:17], v3 offset:176
  v_mfma_f32_16x16x32_bf16 v[68:71], v[20:23], v[228:231], v[68:71]
  ds_read_b64_tr_b16 v[18:19], v3 offset:4784
  s_waitcnt lgkmcnt(6)
  v_mfma_f32_16x16x32_bf16 v[104:107], v[24:27], v[224:227], v[104:107]
  ds_read_b64_tr_b16 v[20:21], v3 offset:216
  v_mfma_f32_16x16x32_bf16 v[108:111], v[24:27], v[228:231], v[108:111]
  ds_read_b64_tr_b16 v[22:23], v3 offset:4824
  v_mfma_f32_16x16x32_bf16 v[40:43], v[28:31], v[224:227], v[40:43]
  ds_read_b64_tr_b16 v[24:25], v3 offset:248
  v_mfma_f32_16x16x32_bf16 v[44:47], v[28:31], v[228:231], v[44:47]
  ds_read_b64_tr_b16 v[26:27], v3 offset:4856
  s_waitcnt lgkmcnt(6)
  v_mfma_f32_16x16x32_bf16 v[48:51], v[32:35], v[224:227], v[48:51]
  ds_read_b64_tr_b16 v[28:29], v3 offset:9288
  v_mfma_f32_16x16x32_bf16 v[52:55], v[32:35], v[228:231], v[52:55]
  ds_read_b64_tr_b16 v[30:31], v3 offset:13896
  ds_read_b128 v[232:235], v2 offset:0
  v_mfma_f32_16x16x32_bf16 v[72:75], v[36:39], v[224:227], v[72:75]
  ds_read_b64_tr_b16 v[32:33], v3 offset:9320
  v_mfma_f32_16x16x32_bf16 v[76:79], v[36:39], v[228:231], v[76:79]
  ds_read_b64_tr_b16 v[34:35], v3 offset:13928
  ds_read_b128 v[236:239], v2 offset:2048
  s_waitcnt lgkmcnt(8)
  v_mfma_f32_16x16x32_bf16 v[80:83], v[16:19], v[224:227], v[80:83]
  ds_read_b64_tr_b16 v[36:37], v4 offset:9216
  v_mfma_f32_16x16x32_bf16 v[84:87], v[16:19], v[228:231], v[84:87]
  ds_read_b64_tr_b16 v[38:39], v4 offset:13824
  v_mfma_f32_16x16x32_bf16 v[88:91], v[20:23], v[224:227], v[88:91]
  ds_read_b64_tr_b16 v[16:17], v3 offset:9216
  v_mfma_f32_16x16x32_bf16 v[92:95], v[20:23], v[228:231], v[92:95]
  ds_read_b64_tr_b16 v[18:19], v3 offset:13824
  s_waitcnt lgkmcnt(8)
  v_mfma_f32_16x16x32_bf16 v[96:99], v[24:27], v[224:227], v[96:99]
  ds_read_b64_tr_b16 v[20:21], v3 offset:9248
  v_mfma_f32_16x16x32_bf16 v[100:103], v[24:27], v[228:231], v[100:103]
  ds_read_b64_tr_b16 v[22:23], v3 offset:13856
  s_waitcnt lgkmcnt(9)
  v_mfma_f32_16x16x32_bf16 v[56:59], v[28:31], v[232:235], v[56:59]
  ds_read_b64_tr_b16 v[24:25], v3 offset:9360
  s_waitcnt lgkmcnt(7)
  v_mfma_f32_16x16x32_bf16 v[60:63], v[28:31], v[236:239], v[60:63]
  ds_read_b64_tr_b16 v[26:27], v3 offset:13968
  s_waitcnt lgkmcnt(6)
  v_mfma_f32_16x16x32_bf16 v[64:67], v[32:35], v[232:235], v[64:67]
  ds_read_b64_tr_b16 v[28:29], v3 offset:9392
  v_mfma_f32_16x16x32_bf16 v[68:71], v[32:35], v[236:239], v[68:71]
  ds_read_b64_tr_b16 v[30:31], v3 offset:14000
  v_mfma_f32_16x16x32_bf16 v[104:107], v[36:39], v[232:235], v[104:107]
  ds_read_b64_tr_b16 v[32:33], v3 offset:9432
  v_mfma_f32_16x16x32_bf16 v[108:111], v[36:39], v[236:239], v[108:111]
  ds_read_b64_tr_b16 v[34:35], v3 offset:14040
  s_waitcnt lgkmcnt(6)
  v_mfma_f32_16x16x32_bf16 v[40:43], v[16:19], v[232:235], v[40:43]
  ds_read_b64_tr_b16 v[36:37], v3 offset:9464
  v_mfma_f32_16x16x32_bf16 v[44:47], v[16:19], v[236:239], v[44:47]
  ds_read_b64_tr_b16 v[38:39], v3 offset:14072
  v_mfma_f32_16x16x32_bf16 v[48:51], v[20:23], v[232:235], v[48:51]
  v_add_u32 v1, 34816, v1
  v_add_u32 v2, 34816, v2
  v_add_u32 v3, 34816, v3
  v_add_u32 v4, 34816, v4
  s_waitcnt vmcnt(0)
  s_barrier
  ds_read_b64_tr_b16 v[16:17], v3 offset:72
  v_mfma_f32_16x16x32_bf16 v[52:55], v[20:23], v[236:239], v[52:55]
  ds_read_b64_tr_b16 v[18:19], v3 offset:4680
  ds_read_b128 v[240:243], v1 offset:0
  s_waitcnt lgkmcnt(7)
  v_mfma_f32_16x16x32_bf16 v[72:75], v[24:27], v[232:235], v[72:75]
  ds_read_b64_tr_b16 v[20:21], v3 offset:104
  v_mfma_f32_16x16x32_bf16 v[76:79], v[24:27], v[236:239], v[76:79]
  ds_read_b64_tr_b16 v[22:23], v3 offset:4712
  ds_read_b128 v[244:247], v1 offset:2048
  v_mfma_f32_16x16x32_bf16 v[80:83], v[28:31], v[232:235], v[80:83]
  ds_read_b64_tr_b16 v[24:25], v4 offset:0
  v_mfma_f32_16x16x32_bf16 v[84:87], v[28:31], v[236:239], v[84:87]
  ds_read_b64_tr_b16 v[26:27], v4 offset:4608
  s_waitcnt lgkmcnt(8)
  v_mfma_f32_16x16x32_bf16 v[88:91], v[32:35], v[232:235], v[88:91]
  ds_read_b64_tr_b16 v[28:29], v3 offset:0
  v_mfma_f32_16x16x32_bf16 v[92:95], v[32:35], v[236:239], v[92:95]
  ds_read_b64_tr_b16 v[30:31], v3 offset:4608
  v_mfma_f32_16x16x32_bf16 v[96:99], v[36:39], v[232:235], v[96:99]
  ds_read_b64_tr_b16 v[32:33], v3 offset:32
  v_mfma_f32_16x16x32_bf16 v[100:103], v[36:39], v[236:239], v[100:103]
  ds_read_b64_tr_b16 v[34:35], v3 offset:4640
  s_waitcnt lgkmcnt(7)
  v_mfma_f32_16x16x32_bf16 v[56:59], v[16:19], v[240:243], v[56:59]
  ds_read_b64_tr_b16 v[36:37], v3 offset:144
  s_waitcnt lgkmcnt(7)
  v_mfma_f32_16x16x32_bf16 v[60:63], v[16:19], v[244:247], v[60:63]
  ds_read_b64_tr_b16 v[38:39], v3 offset:4752
  v_mfma_f32_16x16x32_bf16 v[64:67], v[20:23], v[240:243], v[64:67]
  ds_read_b64_tr_b16 v[16:17], v3 offset:176
  v_mfma_f32_16x16x32_bf16 v[68:71], v[20:23], v[244:247], v[68:71]
  ds_read_b64_tr_b16 v[18:19], v3 offset:4784
  s_waitcnt lgkmcnt(6)
  v_mfma_f32_16x16x32_bf16 v[104:107], v[24:27], v[240:243], v[104:107]
  ds_read_b64_tr_b16 v[20:21], v3 offset:216
  v_mfma_f32_16x16x32_bf16 v[108:111], v[24:27], v[244:247], v[108:111]
  ds_read_b64_tr_b16 v[22:23], v3 offset:4824
  v_mfma_f32_16x16x32_bf16 v[40:43], v[28:31], v[240:243], v[40:43]
  ds_read_b64_tr_b16 v[24:25], v3 offset:248
  v_mfma_f32_16x16x32_bf16 v[44:47], v[28:31], v[244:247], v[44:47]
  ds_read_b64_tr_b16 v[26:27], v3 offset:4856
  s_waitcnt lgkmcnt(6)
  v_mfma_f32_16x16x32_bf16 v[48:51], v[32:35], v[240:243], v[48:51]
  ds_read_b64_tr_b16 v[28:29], v3 offset:9288
  v_mfma_f32_16x16x32_bf16 v[52:55], v[32:35], v[244:247], v[52:55]
  ds_read_b64_tr_b16 v[30:31], v3 offset:13896
  ds_read_b128 v[248:251], v2 offset:0
  v_mfma_f32_16x16x32_bf16 v[72:75], v[36:39], v[240:243], v[72:75]
  ds_read_b64_tr_b16 v[32:33], v3 offset:9320
  v_mfma_f32_16x16x32_bf16 v[76:79], v[36:39], v[244:247], v[76:79]
  ds_read_b64_tr_b16 v[34:35], v3 offset:13928
  ds_read_b128 v[252:255], v2 offset:2048
  s_waitcnt lgkmcnt(8)
  v_mfma_f32_16x16x32_bf16 v[80:83], v[16:19], v[240:243], v[80:83]
  ds_read_b64_tr_b16 v[36:37], v4 offset:9216
  v_mfma_f32_16x16x32_bf16 v[84:87], v[16:19], v[244:247], v[84:87]
  ds_read_b64_tr_b16 v[38:39], v4 offset:13824
  v_mfma_f32_16x16x32_bf16 v[88:91], v[20:23], v[240:243], v[88:91]
  ds_read_b64_tr_b16 v[16:17], v3 offset:9216
  v_mfma_f32_16x16x32_bf16 v[92:95], v[20:23], v[244:247], v[92:95]
  ds_read_b64_tr_b16 v[18:19], v3 offset:13824
  s_waitcnt lgkmcnt(8)
  v_mfma_f32_16x16x32_bf16 v[96:99], v[24:27], v[240:243], v[96:99]
  ds_read_b64_tr_b16 v[20:21], v3 offset:9248
  v_mfma_f32_16x16x32_bf16 v[100:103], v[24:27], v[244:247], v[100:103]
  ds_read_b64_tr_b16 v[22:23], v3 offset:13856
  s_waitcnt lgkmcnt(9)
  v_mfma_f32_16x16x32_bf16 v[56:59], v[28:31], v[248:251], v[56:59]
  ds_read_b64_tr_b16 v[24:25], v3 offset:9360
  s_waitcnt lgkmcnt(7)
  v_mfma_f32_16x16x32_bf16 v[60:63], v[28:31], v[252:255], v[60:63]
  ds_read_b64_tr_b16 v[26:27], v3 offset:13968
  s_waitcnt lgkmcnt(6)
  v_mfma_f32_16x16x32_bf16 v[64:67], v[32:35], v[248:251], v[64:67]
  ds_read_b64_tr_b16 v[28:29], v3 offset:9392
  v_mfma_f32_16x16x32_bf16 v[68:71], v[32:35], v[252:255], v[68:71]
  ds_read_b64_tr_b16 v[30:31], v3 offset:14000
  v_mfma_f32_16x16x32_bf16 v[104:107], v[36:39], v[248:251], v[104:107]
  ds_read_b64_tr_b16 v[32:33], v3 offset:9432
  v_mfma_f32_16x16x32_bf16 v[108:111], v[36:39], v[252:255], v[108:111]
  ds_read_b64_tr_b16 v[34:35], v3 offset:14040
  s_waitcnt lgkmcnt(6)
  v_mfma_f32_16x16x32_bf16 v[40:43], v[16:19], v[248:251], v[40:43]
  ds_read_b64_tr_b16 v[36:37], v3 offset:9464
  v_mfma_f32_16x16x32_bf16 v[44:47], v[16:19], v[252:255], v[44:47]
  ds_read_b64_tr_b16 v[38:39], v3 offset:14072
  v_mfma_f32_16x16x32_bf16 v[48:51], v[20:23], v[248:251], v[48:51]
  v_add_u32 v3, 4294846464, v3
  v_add_u32 v4, 4294846464, v4
  v_mfma_f32_16x16x32_bf16 v[52:55], v[20:23], v[252:255], v[52:55]
  v_cvt_pk_bf16_f32 v56, v56, v57
  v_cvt_pk_bf16_f32 v57, v58, v59
  s_waitcnt lgkmcnt(4)
  v_mfma_f32_16x16x32_bf16 v[72:75], v[24:27], v[248:251], v[72:75]
  v_cvt_pk_bf16_f32 v58, v64, v65
  v_cvt_pk_bf16_f32 v59, v66, v67
  v_mfma_f32_16x16x32_bf16 v[76:79], v[24:27], v[252:255], v[76:79]
  ds_write_b128 v12, v[56:59] offset:0
  v_cvt_pk_bf16_f32 v60, v60, v61
  v_mfma_f32_16x16x32_bf16 v[80:83], v[28:31], v[248:251], v[80:83]
  v_cvt_pk_bf16_f32 v61, v62, v63
  v_cvt_pk_bf16_f32 v62, v68, v69
  v_mfma_f32_16x16x32_bf16 v[84:87], v[28:31], v[252:255], v[84:87]
  v_cvt_pk_bf16_f32 v63, v70, v71
  ds_write_b128 v12, v[60:63] offset:1024
  s_waitcnt lgkmcnt(2)
  v_mfma_f32_16x16x32_bf16 v[88:91], v[32:35], v[248:251], v[88:91]
  v_cvt_pk_bf16_f32 v104, v104, v105
  v_cvt_pk_bf16_f32 v105, v106, v107
  v_mfma_f32_16x16x32_bf16 v[92:95], v[32:35], v[252:255], v[92:95]
  v_cvt_pk_bf16_f32 v106, v108, v109
  v_cvt_pk_bf16_f32 v107, v110, v111
  v_mfma_f32_16x16x32_bf16 v[96:99], v[36:39], v[248:251], v[96:99]
  s_mov_b64 exec, s[34:35]
  ds_write_b128 v13, v[104:107]
  s_mov_b64 exec, -1
  v_mfma_f32_16x16x32_bf16 v[100:103], v[36:39], v[252:255], v[100:103]
  s_waitcnt lgkmcnt(0)
  s_barrier
  v_cvt_pk_bf16_f32 v40, v40, v41
  v_cvt_pk_bf16_f32 v41, v42, v43
  v_cvt_pk_bf16_f32 v42, v48, v49
  v_cvt_pk_bf16_f32 v43, v50, v51
  v_cvt_pk_bf16_f32 v44, v44, v45
  v_cvt_pk_bf16_f32 v45, v46, v47
  v_cvt_pk_bf16_f32 v46, v52, v53
  v_cvt_pk_bf16_f32 v47, v54, v55
  ds_read_b64_tr_b16 v[16:17], v9 offset:0
  ds_read_b64_tr_b16 v[18:19], v10 offset:0
  ds_read_b64_tr_b16 v[20:21], v11 offset:0
  ds_read_b64_tr_b16 v[22:23], v9 offset:8
  ds_read_b64_tr_b16 v[24:25], v10 offset:8
  ds_read_b64_tr_b16 v[26:27], v11 offset:8
  ds_read_b64_tr_b16 v[28:29], v9 offset:16
  ds_read_b64_tr_b16 v[30:31], v10 offset:16
  ds_read_b64_tr_b16 v[32:33], v11 offset:16
  ds_read_b64_tr_b16 v[34:35], v9 offset:24
  ds_read_b64_tr_b16 v[36:37], v10 offset:24
  ds_read_b64_tr_b16 v[38:39], v11 offset:24
  ds_read_b64_tr_b16 v[48:49], v9 offset:32
  ds_read_b64_tr_b16 v[50:51], v10 offset:32
  ds_read_b64_tr_b16 v[52:53], v11 offset:32
  v_cvt_pk_bf16_f32 v72, v72, v73
  v_cvt_pk_bf16_f32 v73, v74, v75
  ds_write_b64 v5, v[72:73] offset:288
  v_cvt_pk_bf16_f32 v76, v76, v77
  v_cvt_pk_bf16_f32 v77, v78, v79
  ds_write_b64 v5, v[76:77] offset:7328
  v_cvt_pk_bf16_f32 v80, v80, v81
  v_cvt_pk_bf16_f32 v81, v82, v83
  ds_write_b64 v5, v[80:81] offset:320
  v_cvt_pk_bf16_f32 v84, v84, v85
  v_cvt_pk_bf16_f32 v85, v86, v87
  ds_write_b64 v5, v[84:85] offset:7360
  v_cvt_pk_bf16_f32 v88, v88, v89
  v_cvt_pk_bf16_f32 v89, v90, v91
  ds_write_b64 v5, v[88:89] offset:360
  s_waitcnt lgkmcnt(15)
  v_mfma_f32_16x16x32_bf16 v[56:59], v[16:19], v[40:43], 0
  v_mfma_f32_16x16x32_bf16 v[60:63], v[22:25], v[40:43], 0
  v_cvt_pk_bf16_f32 v92, v92, v93
  s_waitcnt lgkmcnt(12)
  v_mfma_f32_16x16x32_bf16 v[64:67], v[28:31], v[40:43], 0
  s_waitcnt lgkmcnt(9)
  v_mfma_f32_16x16x32_bf16 v[68:71], v[34:37], v[40:43], 0
  v_cvt_pk_bf16_f32 v93, v94, v95
  s_waitcnt lgkmcnt(6)
  v_mfma_f32_16x16x32_bf16 v[108:111], v[48:51], v[40:43], 0
  ds_write_b64 v5, v[92:93] offset:7400
  v_mfma_f32_16x16x32_bf16 v[72:75], v[16:19], v[44:47], 0
  v_mfma_f32_16x16x32_bf16 v[76:79], v[22:25], v[44:47], 0
  v_cvt_pk_bf16_f32 v96, v96, v97
  v_mfma_f32_16x16x32_bf16 v[80:83], v[28:31], v[44:47], 0
  v_mfma_f32_16x16x32_bf16 v[84:87], v[34:37], v[44:47], 0
  v_cvt_pk_bf16_f32 v97, v98, v99
  v_mfma_f32_16x16x32_bf16 v[88:91], v[48:51], v[44:47], 0
  ds_write_b64 v5, v[96:97] offset:392
  v_mfma_f32_16x16x16_bf16 v[56:59], v[20:21], v[104:105], v[56:59]
  v_mfma_f32_16x16x16_bf16 v[60:63], v[26:27], v[104:105], v[60:63]
  v_cvt_pk_bf16_f32 v100, v100, v101
  v_mfma_f32_16x16x16_bf16 v[64:67], v[32:33], v[104:105], v[64:67]
  v_mfma_f32_16x16x16_bf16 v[68:71], v[38:39], v[104:105], v[68:71]
  v_cvt_pk_bf16_f32 v101, v102, v103
  s_waitcnt lgkmcnt(7)
  v_mfma_f32_16x16x16_bf16 v[108:111], v[52:53], v[104:105], v[108:111]
  ds_write_b64 v5, v[100:101] offset:7432
  v_mfma_f32_16x16x16_bf16 v[72:75], v[20:21], v[106:107], v[72:75]
  v_mfma_f32_16x16x16_bf16 v[76:79], v[26:27], v[106:107], v[76:79]
  s_mov_b32 exec_lo, 0
  ds_write_b64 v6, v[104:105] offset:208
  s_mov_b32 exec_lo, -1
  v_mfma_f32_16x16x16_bf16 v[80:83], v[32:33], v[106:107], v[80:83]
  v_mfma_f32_16x16x16_bf16 v[84:87], v[38:39], v[106:107], v[84:87]
  s_mov_b32 exec_lo, 0
  ds_write_b64 v6, v[106:107] offset:7248
  s_mov_b32 exec_lo, -1
  v_mfma_f32_16x16x16_bf16 v[88:91], v[52:53], v[106:107], v[88:91]
  v_max3_f32 v54, v56, v57, v58
  v_max3_f32 v55, v59, v60, v61
  v_max3_f32 v54, v62, v63, v54
  v_max3_f32 v55, v64, v65, v55
  v_max3_f32 v54, v66, v67, v54
  v_max3_f32 v55, v68, v69, v55
  v_max3_f32 v54, v70, v71, v54
  v_max3_f32 v55, v108, v109, v55
  v_max_f32 v54, v54, v55
  v_mul_f32 v54, s76, v54
  v_pk_fma_f32 v[56:57], v[56:57], s[76:77], v[54:55] op_sel_hi:[1,1,0] neg_lo:[0,0,1] neg_hi:[0,0,1]
  v_pk_fma_f32 v[58:59], v[58:59], s[76:77], v[54:55] op_sel_hi:[1,1,0] neg_lo:[0,0,1] neg_hi:[0,0,1]
  v_pk_fma_f32 v[60:61], v[60:61], s[76:77], v[54:55] op_sel_hi:[1,1,0] neg_lo:[0,0,1] neg_hi:[0,0,1]
  v_pk_fma_f32 v[62:63], v[62:63], s[76:77], v[54:55] op_sel_hi:[1,1,0] neg_lo:[0,0,1] neg_hi:[0,0,1]
  v_pk_fma_f32 v[64:65], v[64:65], s[76:77], v[54:55] op_sel_hi:[1,1,0] neg_lo:[0,0,1] neg_hi:[0,0,1]
  v_pk_fma_f32 v[66:67], v[66:67], s[76:77], v[54:55] op_sel_hi:[1,1,0] neg_lo:[0,0,1] neg_hi:[0,0,1]
  v_pk_fma_f32 v[68:69], v[68:69], s[76:77], v[54:55] op_sel_hi:[1,1,0] neg_lo:[0,0,1] neg_hi:[0,0,1]
  v_pk_fma_f32 v[70:71], v[70:71], s[76:77], v[54:55] op_sel_hi:[1,1,0] neg_lo:[0,0,1] neg_hi:[0,0,1]
  v_pk_fma_f32 v[108:109], v[108:109], s[76:77], v[54:55] op_sel_hi:[1,1,0] neg_lo:[0,0,1] neg_hi:[0,0,1]
  v_exp_f32 v56, v56
  v_exp_f32 v57, v57
  v_exp_f32 v58, v58
  v_exp_f32 v59, v59
  v_exp_f32 v60, v60
  v_exp_f32 v61, v61
  v_exp_f32 v62, v62
  v_exp_f32 v63, v63
  v_exp_f32 v64, v64
  v_exp_f32 v65, v65
  v_exp_f32 v66, v66
  v_exp_f32 v67, v67
  v_exp_f32 v68, v68
  v_exp_f32 v69, v69
  v_exp_f32 v70, v70
  v_exp_f32 v71, v71
  v_exp_f32 v108, v108
  v_exp_f32 v109, v109
  v_pk_add_f32 v[54:55], v[56:57], v[58:59]
  v_pk_add_f32 v[54:55], v[54:55], v[60:61]
  v_pk_add_f32 v[54:55], v[54:55], v[62:63]
  v_pk_add_f32 v[54:55], v[54:55], v[64:65]
  v_pk_add_f32 v[54:55], v[54:55], v[66:67]
  v_pk_add_f32 v[54:55], v[54:55], v[68:69]
  v_pk_add_f32 v[54:55], v[54:55], v[70:71]
  v_pk_add_f32 v[54:55], v[54:55], v[108:109]
  v_add_f32 v54, v54, v55
  v_rcp_f32 v54, v54
  s_nop 0
  v_pk_mul_f32 v[56:57], v[56:57], v[54:55] op_sel_hi:[1,0]
  v_pk_mul_f32 v[58:59], v[58:59], v[54:55] op_sel_hi:[1,0]
  v_pk_mul_f32 v[60:61], v[60:61], v[54:55] op_sel_hi:[1,0]
  v_pk_mul_f32 v[62:63], v[62:63], v[54:55] op_sel_hi:[1,0]
  v_pk_mul_f32 v[64:65], v[64:65], v[54:55] op_sel_hi:[1,0]
  v_pk_mul_f32 v[66:67], v[66:67], v[54:55] op_sel_hi:[1,0]
  v_pk_mul_f32 v[68:69], v[68:69], v[54:55] op_sel_hi:[1,0]
  v_pk_mul_f32 v[70:71], v[70:71], v[54:55] op_sel_hi:[1,0]
  v_pk_mul_f32 v[108:109], v[108:109], v[54:55] op_sel_hi:[1,0]
  v_cvt_pk_bf16_f32 v56, v56, v57
  v_cvt_pk_bf16_f32 v57, v58, v59
  v_cvt_pk_bf16_f32 v58, v60, v61
  v_cvt_pk_bf16_f32 v59, v62, v63
  v_cvt_pk_bf16_f32 v60, v64, v65
  v_cvt_pk_bf16_f32 v61, v66, v67
  v_cvt_pk_bf16_f32 v62, v68, v69
  v_cvt_pk_bf16_f32 v63, v70, v71
  v_cvt_pk_bf16_f32 v64, v108, v109
  ds_write_b64 v7, v[56:57] offset:0
  ds_write_b64 v7, v[58:59] offset:8
  ds_write_b64 v7, v[60:61] offset:16
  ds_write_b64 v7, v[62:63] offset:24
  ds_write_b32 v8, v64 offset:0
  v_max3_f32 v54, v72, v73, v74
  v_max3_f32 v55, v75, v76, v77
  v_max3_f32 v54, v78, v79, v54
  v_max3_f32 v55, v80, v81, v55
  v_max3_f32 v54, v82, v83, v54
  v_max3_f32 v55, v84, v85, v55
  v_max3_f32 v54, v86, v87, v54
  v_max3_f32 v55, v88, v89, v55
  v_max_f32 v54, v54, v55
  v_mul_f32 v54, s76, v54
  v_pk_fma_f32 v[72:73], v[72:73], s[76:77], v[54:55] op_sel_hi:[1,1,0] neg_lo:[0,0,1] neg_hi:[0,0,1]
  v_pk_fma_f32 v[74:75], v[74:75], s[76:77], v[54:55] op_sel_hi:[1,1,0] neg_lo:[0,0,1] neg_hi:[0,0,1]
  v_pk_fma_f32 v[76:77], v[76:77], s[76:77], v[54:55] op_sel_hi:[1,1,0] neg_lo:[0,0,1] neg_hi:[0,0,1]
  v_pk_fma_f32 v[78:79], v[78:79], s[76:77], v[54:55] op_sel_hi:[1,1,0] neg_lo:[0,0,1] neg_hi:[0,0,1]
  v_pk_fma_f32 v[80:81], v[80:81], s[76:77], v[54:55] op_sel_hi:[1,1,0] neg_lo:[0,0,1] neg_hi:[0,0,1]
  v_pk_fma_f32 v[82:83], v[82:83], s[76:77], v[54:55] op_sel_hi:[1,1,0] neg_lo:[0,0,1] neg_hi:[0,0,1]
  v_pk_fma_f32 v[84:85], v[84:85], s[76:77], v[54:55] op_sel_hi:[1,1,0] neg_lo:[0,0,1] neg_hi:[0,0,1]
  v_pk_fma_f32 v[86:87], v[86:87], s[76:77], v[54:55] op_sel_hi:[1,1,0] neg_lo:[0,0,1] neg_hi:[0,0,1]
  v_pk_fma_f32 v[88:89], v[88:89], s[76:77], v[54:55] op_sel_hi:[1,1,0] neg_lo:[0,0,1] neg_hi:[0,0,1]
  v_exp_f32 v72, v72
  v_exp_f32 v73, v73
  v_exp_f32 v74, v74
  v_exp_f32 v75, v75
  v_exp_f32 v76, v76
  v_exp_f32 v77, v77
  v_exp_f32 v78, v78
  v_exp_f32 v79, v79
  v_exp_f32 v80, v80
  v_exp_f32 v81, v81
  v_exp_f32 v82, v82
  v_exp_f32 v83, v83
  v_exp_f32 v84, v84
  v_exp_f32 v85, v85
  v_exp_f32 v86, v86
  v_exp_f32 v87, v87
  v_exp_f32 v88, v88
  v_exp_f32 v89, v89
  v_pk_add_f32 v[54:55], v[72:73], v[74:75]
  v_pk_add_f32 v[54:55], v[54:55], v[76:77]
  v_pk_add_f32 v[54:55], v[54:55], v[78:79]
  v_pk_add_f32 v[54:55], v[54:55], v[80:81]
  v_pk_add_f32 v[54:55], v[54:55], v[82:83]
  v_pk_add_f32 v[54:55], v[54:55], v[84:85]
  v_pk_add_f32 v[54:55], v[54:55], v[86:87]
  v_pk_add_f32 v[54:55], v[54:55], v[88:89]
  v_add_f32 v54, v54, v55
  v_rcp_f32 v54, v54
  s_nop 0
  v_pk_mul_f32 v[72:73], v[72:73], v[54:55] op_sel_hi:[1,0]
  v_pk_mul_f32 v[74:75], v[74:75], v[54:55] op_sel_hi:[1,0]
  v_pk_mul_f32 v[76:77], v[76:77], v[54:55] op_sel_hi:[1,0]
  v_pk_mul_f32 v[78:79], v[78:79], v[54:55] op_sel_hi:[1,0]
  v_pk_mul_f32 v[80:81], v[80:81], v[54:55] op_sel_hi:[1,0]
  v_pk_mul_f32 v[82:83], v[82:83], v[54:55] op_sel_hi:[1,0]
  v_pk_mul_f32 v[84:85], v[84:85], v[54:55] op_sel_hi:[1,0]
  v_pk_mul_f32 v[86:87], v[86:87], v[54:55] op_sel_hi:[1,0]
  v_pk_mul_f32 v[88:89], v[88:89], v[54:55] op_sel_hi:[1,0]
  v_cvt_pk_bf16_f32 v72, v72, v73
  v_cvt_pk_bf16_f32 v73, v74, v75
  v_cvt_pk_bf16_f32 v74, v76, v77
  v_cvt_pk_bf16_f32 v75, v78, v79
  v_cvt_pk_bf16_f32 v76, v80, v81
  v_cvt_pk_bf16_f32 v77, v82, v83
  v_cvt_pk_bf16_f32 v78, v84, v85
  v_cvt_pk_bf16_f32 v79, v86, v87
  v_cvt_pk_bf16_f32 v80, v88, v89
  ds_write_b64 v7, v[72:73] offset:7040
  ds_write_b64 v7, v[74:75] offset:7048
  ds_write_b64 v7, v[76:77] offset:7056
  ds_write_b64 v7, v[78:79] offset:7064
  ds_write_b32 v8, v80 offset:7040
  v_add_u32 v1, 55296, v3
  v_add_u32 v2, 55296, v4
  v_add_u32 v5, 154368, v14
  v_mov_b32 v6, 163832
  ds_read_b64_tr_b16 v[16:17], v3 offset:72
  ds_read_b64_tr_b16 v[18:19], v3 offset:4680
  ds_read_b64_tr_b16 v[20:21], v3 offset:104
  ds_read_b64_tr_b16 v[22:23], v3 offset:4712
  ds_read_b64_tr_b16 v[24:25], v4 offset:0
  ds_read_b64_tr_b16 v[26:27], v4 offset:4608
  ds_read_b64_tr_b16 v[28:29], v3 offset:216
  ds_read_b64_tr_b16 v[30:31], v3 offset:4824
  ds_read_b64_tr_b16 v[32:33], v3 offset:248
  ds_read_b64_tr_b16 v[34:35], v3 offset:4856
  s_waitcnt lgkmcnt(10)
  s_barrier
  s_waitcnt lgkmcnt(8)
  v_mfma_f32_16x16x32_bf16 v[56:59], v[16:19], v[112:115], 0
  ds_read_b64_tr_b16 v[36:37], v4 offset:144
  v_mfma_f32_16x16x32_bf16 v[60:63], v[16:19], v[116:119], 0
  ds_read_b64_tr_b16 v[38:39], v4 offset:4752
  s_waitcnt lgkmcnt(8)
  v_mfma_f32_16x16x32_bf16 v[64:67], v[20:23], v[112:115], 0
  ds_read_b64_tr_b16 v[16:17], v3 offset:9288
  v_mfma_f32_16x16x32_bf16 v[68:71], v[20:23], v[116:119], 0
  ds_read_b64_tr_b16 v[18:19], v3 offset:13896
  s_waitcnt lgkmcnt(6)
  v_mfma_f32_16x16x32_bf16 v[72:75], v[24:27], v[112:115], 0
  ds_read_b64_tr_b16 v[20:21], v3 offset:9320
  v_mfma_f32_16x16x32_bf16 v[76:79], v[24:27], v[116:119], 0
  ds_read_b64_tr_b16 v[22:23], v3 offset:13928
  v_mfma_f32_16x16x32_bf16 v[56:59], v[28:31], v[120:123], v[56:59]
  ds_read_b64_tr_b16 v[24:25], v4 offset:9216
  v_mfma_f32_16x16x32_bf16 v[60:63], v[28:31], v[124:127], v[60:63]
  ds_read_b64_tr_b16 v[26:27], v4 offset:13824
  s_waitcnt lgkmcnt(6)
  v_mfma_f32_16x16x32_bf16 v[64:67], v[32:35], v[120:123], v[64:67]
  ds_read_b64_tr_b16 v[28:29], v3 offset:9432
  v_mfma_f32_16x16x32_bf16 v[68:71], v[32:35], v[124:127], v[68:71]
  ds_read_b64_tr_b16 v[30:31], v3 offset:14040
  v_mfma_f32_16x16x32_bf16 v[72:75], v[36:39], v[120:123], v[72:75]
  ds_read_b64_tr_b16 v[32:33], v3 offset:9464
  v_mfma_f32_16x16x32_bf16 v[76:79], v[36:39], v[124:127], v[76:79]
  ds_read_b64_tr_b16 v[34:35], v3 offset:14072
  s_waitcnt lgkmcnt(6)
  v_mfma_f32_16x16x32_bf16 v[56:59], v[16:19], v[192:195], v[56:59]
  ds_read_b64_tr_b16 v[36:37], v4 offset:9360
  v_mfma_f32_16x16x32_bf16 v[60:63], v[16:19], v[196:199], v[60:63]
  ds_read_b64_tr_b16 v[38:39], v4 offset:13968
  v_mfma_f32_16x16x32_bf16 v[64:67], v[20:23], v[192:195], v[64:67]
  ds_read_b64_tr_b16 v[16:17], v3 offset:18504
  v_mfma_f32_16x16x32_bf16 v[68:71], v[20:23], v[196:199], v[68:71]
  ds_read_b64_tr_b16 v[18:19], v3 offset:23112
  s_waitcnt lgkmcnt(6)
  v_mfma_f32_16x16x32_bf16 v[72:75], v[24:27], v[192:195], v[72:75]
  ds_read_b64_tr_b16 v[20:21], v3 offset:18536
  v_mfma_f32_16x16x32_bf16 v[76:79], v[24:27], v[196:199], v[76:79]
  ds_read_b64_tr_b16 v[22:23], v3 offset:23144
  v_mfma_f32_16x16x32_bf16 v[56:59], v[28:31], v[200:203], v[56:59]
  ds_read_b64_tr_b16 v[24:25], v4 offset:18432
  v_mfma_f32_16x16x32_bf16 v[60:63], v[28:31], v[204:207], v[60:63]
  ds_read_b64_tr_b16 v[26:27], v4 offset:23040
  s_waitcnt lgkmcnt(6)
  v_mfma_f32_16x16x32_bf16 v[64:67], v[32:35], v[200:203], v[64:67]
  ds_read_b64_tr_b16 v[28:29], v3 offset:18648
  v_mfma_f32_16x16x32_bf16 v[68:71], v[32:35], v[204:207], v[68:71]
  ds_read_b64_tr_b16 v[30:31], v3 offset:23256
  v_mfma_f32_16x16x32_bf16 v[72:75], v[36:39], v[200:203], v[72:75]
  ds_read_b64_tr_b16 v[32:33], v3 offset:18680
  v_mfma_f32_16x16x32_bf16 v[76:79], v[36:39], v[204:207], v[76:79]
  ds_read_b64_tr_b16 v[34:35], v3 offset:23288
  s_waitcnt lgkmcnt(6)
  v_mfma_f32_16x16x32_bf16 v[56:59], v[16:19], v[240:243], v[56:59]
  ds_read_b64_tr_b16 v[36:37], v4 offset:18576
  v_mfma_f32_16x16x32_bf16 v[60:63], v[16:19], v[244:247], v[60:63]
  ds_read_b64_tr_b16 v[38:39], v4 offset:23184
  v_mfma_f32_16x16x32_bf16 v[64:67], v[20:23], v[240:243], v[64:67]
  ds_read_b64_tr_b16 v[16:17], v3 offset:27720
  v_mfma_f32_16x16x32_bf16 v[68:71], v[20:23], v[244:247], v[68:71]
  ds_read_b64_tr_b16 v[18:19], v3 offset:32328
  s_waitcnt lgkmcnt(6)
  v_mfma_f32_16x16x32_bf16 v[72:75], v[24:27], v[240:243], v[72:75]
  ds_read_b64_tr_b16 v[20:21], v3 offset:27752
  v_mfma_f32_16x16x32_bf16 v[76:79], v[24:27], v[244:247], v[76:79]
  ds_read_b64_tr_b16 v[22:23], v3 offset:32360
  v_mfma_f32_16x16x32_bf16 v[56:59], v[28:31], v[248:251], v[56:59]
  ds_read_b64_tr_b16 v[24:25], v4 offset:27648
  v_mfma_f32_16x16x32_bf16 v[60:63], v[28:31], v[252:255], v[60:63]
  ds_read_b64_tr_b16 v[26:27], v4 offset:32256
  s_waitcnt lgkmcnt(6)
  v_mfma_f32_16x16x32_bf16 v[64:67], v[32:35], v[248:251], v[64:67]
  ds_read_b64_tr_b16 v[28:29], v3 offset:27864
  v_mfma_f32_16x16x32_bf16 v[68:71], v[32:35], v[252:255], v[68:71]
  ds_read_b64_tr_b16 v[30:31], v3 offset:32472
  v_mfma_f32_16x16x32_bf16 v[72:75], v[36:39], v[248:251], v[72:75]
  ds_read_b64_tr_b16 v[32:33], v3 offset:27896
  v_mfma_f32_16x16x32_bf16 v[76:79], v[36:39], v[252:255], v[76:79]
  ds_read_b64_tr_b16 v[34:35], v3 offset:32504
  s_waitcnt lgkmcnt(6)
  v_mfma_f32_16x16x32_bf16 v[56:59], v[16:19], v[128:131], v[56:59]
  ds_read_b64_tr_b16 v[36:37], v4 offset:27792
  v_mfma_f32_16x16x32_bf16 v[60:63], v[16:19], v[132:135], v[60:63]
  ds_read_b64_tr_b16 v[38:39], v4 offset:32400
  v_mfma_f32_16x16x32_bf16 v[64:67], v[20:23], v[128:131], v[64:67]
  ds_read_b64_tr_b16 v[16:17], v3 offset:36936
  v_mfma_f32_16x16x32_bf16 v[68:71], v[20:23], v[132:135], v[68:71]
  ds_read_b64_tr_b16 v[18:19], v3 offset:41544
  s_waitcnt lgkmcnt(6)
  v_mfma_f32_16x16x32_bf16 v[72:75], v[24:27], v[128:131], v[72:75]
  ds_read_b64_tr_b16 v[20:21], v3 offset:36968
  v_mfma_f32_16x16x32_bf16 v[76:79], v[24:27], v[132:135], v[76:79]
  ds_read_b64_tr_b16 v[22:23], v3 offset:41576
  v_mfma_f32_16x16x32_bf16 v[56:59], v[28:31], v[136:139], v[56:59]
  ds_read_b64_tr_b16 v[24:25], v4 offset:36864
  v_mfma_f32_16x16x32_bf16 v[60:63], v[28:31], v[140:143], v[60:63]
  ds_read_b64_tr_b16 v[26:27], v4 offset:41472
  s_waitcnt lgkmcnt(6)
  v_mfma_f32_16x16x32_bf16 v[64:67], v[32:35], v[136:139], v[64:67]
  ds_read_b64_tr_b16 v[28:29], v3 offset:37080
  v_mfma_f32_16x16x32_bf16 v[68:71], v[32:35], v[140:143], v[68:71]
  ds_read_b64_tr_b16 v[30:31], v3 offset:41688
  v_mfma_f32_16x16x32_bf16 v[72:75], v[36:39], v[136:139], v[72:75]
  ds_read_b64_tr_b16 v[32:33], v3 offset:37112
  v_mfma_f32_16x16x32_bf16 v[76:79], v[36:39], v[140:143], v[76:79]
  ds_read_b64_tr_b16 v[34:35], v3 offset:41720
  s_waitcnt lgkmcnt(6)
  v_mfma_f32_16x16x32_bf16 v[56:59], v[16:19], v[144:147], v[56:59]
  ds_read_b64_tr_b16 v[36:37], v4 offset:37008
  v_mfma_f32_16x16x32_bf16 v[60:63], v[16:19], v[148:151], v[60:63]
  ds_read_b64_tr_b16 v[38:39], v4 offset:41616
  v_mfma_f32_16x16x32_bf16 v[64:67], v[20:23], v[144:147], v[64:67]
  ds_read_b64_tr_b16 v[16:17], v3 offset:46152
  v_mfma_f32_16x16x32_bf16 v[68:71], v[20:23], v[148:151], v[68:71]
  ds_read_b64_tr_b16 v[18:19], v3 offset:50760
  s_waitcnt lgkmcnt(6)
  v_mfma_f32_16x16x32_bf16 v[72:75], v[24:27], v[144:147], v[72:75]
  ds_read_b64_tr_b16 v[20:21], v3 offset:46184
  v_mfma_f32_16x16x32_bf16 v[76:79], v[24:27], v[148:151], v[76:79]
  ds_read_b64_tr_b16 v[22:23], v3 offset:50792
  v_mfma_f32_16x16x32_bf16 v[56:59], v[28:31], v[152:155], v[56:59]
  ds_read_b64_tr_b16 v[24:25], v4 offset:46080
  v_mfma_f32_16x16x32_bf16 v[60:63], v[28:31], v[156:159], v[60:63]
  ds_read_b64_tr_b16 v[26:27], v4 offset:50688
  s_waitcnt lgkmcnt(6)
  v_mfma_f32_16x16x32_bf16 v[64:67], v[32:35], v[152:155], v[64:67]
  ds_read_b64_tr_b16 v[28:29], v3 offset:46296
  v_mfma_f32_16x16x32_bf16 v[68:71], v[32:35], v[156:159], v[68:71]
  ds_read_b64_tr_b16 v[30:31], v3 offset:50904
  v_mfma_f32_16x16x32_bf16 v[72:75], v[36:39], v[152:155], v[72:75]
  ds_read_b64_tr_b16 v[32:33], v3 offset:46328
  v_mfma_f32_16x16x32_bf16 v[76:79], v[36:39], v[156:159], v[76:79]
  ds_read_b64_tr_b16 v[34:35], v3 offset:50936
  s_waitcnt lgkmcnt(6)
  v_mfma_f32_16x16x32_bf16 v[56:59], v[16:19], v[160:163], v[56:59]
  ds_read_b64_tr_b16 v[36:37], v4 offset:46224
  v_mfma_f32_16x16x32_bf16 v[60:63], v[16:19], v[164:167], v[60:63]
  ds_read_b64_tr_b16 v[38:39], v4 offset:50832
  v_mfma_f32_16x16x32_bf16 v[64:67], v[20:23], v[160:163], v[64:67]
  s_barrier
  ds_read_b64_tr_b16 v[16:17], v1 offset:72
  v_mfma_f32_16x16x32_bf16 v[68:71], v[20:23], v[164:167], v[68:71]
  ds_read_b64_tr_b16 v[18:19], v1 offset:4680
  s_waitcnt lgkmcnt(6)
  v_mfma_f32_16x16x32_bf16 v[72:75], v[24:27], v[160:163], v[72:75]
  ds_read_b64_tr_b16 v[20:21], v1 offset:104
  v_mfma_f32_16x16x32_bf16 v[76:79], v[24:27], v[164:167], v[76:79]
  ds_read_b64_tr_b16 v[22:23], v1 offset:4712
  v_mfma_f32_16x16x32_bf16 v[56:59], v[28:31], v[168:171], v[56:59]
  ds_read_b64_tr_b16 v[24:25], v2 offset:0
  v_mfma_f32_16x16x32_bf16 v[60:63], v[28:31], v[172:175], v[60:63]
  ds_read_b64_tr_b16 v[26:27], v2 offset:4608
  s_waitcnt lgkmcnt(6)
  v_mfma_f32_16x16x32_bf16 v[64:67], v[32:35], v[168:171], v[64:67]
  ds_read_b64_tr_b16 v[28:29], v1 offset:216
  v_mfma_f32_16x16x32_bf16 v[68:71], v[32:35], v[172:175], v[68:71]
  ds_read_b64_tr_b16 v[30:31], v1 offset:4824
  v_mfma_f32_16x16x32_bf16 v[72:75], v[36:39], v[168:171], v[72:75]
  ds_read_b64_tr_b16 v[32:33], v1 offset:248
  v_mfma_f32_16x16x32_bf16 v[76:79], v[36:39], v[172:175], v[76:79]
  ds_read_b64_tr_b16 v[34:35], v1 offset:4856
  s_waitcnt lgkmcnt(6)
  v_mfma_f32_16x16x32_bf16 v[56:59], v[16:19], v[176:179], v[56:59]
  ds_read_b64_tr_b16 v[36:37], v2 offset:144
  v_mfma_f32_16x16x32_bf16 v[60:63], v[16:19], v[180:183], v[60:63]
  ds_read_b64_tr_b16 v[38:39], v2 offset:4752
  v_mfma_f32_16x16x32_bf16 v[64:67], v[20:23], v[176:179], v[64:67]
  ds_read_b64_tr_b16 v[16:17], v1 offset:9288
  v_mfma_f32_16x16x32_bf16 v[68:71], v[20:23], v[180:183], v[68:71]
  ds_read_b64_tr_b16 v[18:19], v1 offset:13896
  s_waitcnt lgkmcnt(6)
  v_mfma_f32_16x16x32_bf16 v[72:75], v[24:27], v[176:179], v[72:75]
  ds_read_b64_tr_b16 v[20:21], v1 offset:9320
  v_mfma_f32_16x16x32_bf16 v[76:79], v[24:27], v[180:183], v[76:79]
  ds_read_b64_tr_b16 v[22:23], v1 offset:13928
  v_mfma_f32_16x16x32_bf16 v[56:59], v[28:31], v[184:187], v[56:59]
  ds_read_b64_tr_b16 v[24:25], v2 offset:9216
  v_mfma_f32_16x16x32_bf16 v[60:63], v[28:31], v[188:191], v[60:63]
  ds_read_b64_tr_b16 v[26:27], v2 offset:13824
  s_waitcnt lgkmcnt(6)
  v_mfma_f32_16x16x32_bf16 v[64:67], v[32:35], v[184:187], v[64:67]
  ds_read_b64_tr_b16 v[28:29], v1 offset:9432
  v_mfma_f32_16x16x32_bf16 v[68:71], v[32:35], v[188:191], v[68:71]
  ds_read_b64_tr_b16 v[30:31], v1 offset:14040
  v_mfma_f32_16x16x32_bf16 v[72:75], v[36:39], v[184:187], v[72:75]
  ds_read_b64_tr_b16 v[32:33], v1 offset:9464
  v_mfma_f32_16x16x32_bf16 v[76:79], v[36:39], v[188:191], v[76:79]
  ds_read_b64_tr_b16 v[34:35], v1 offset:14072
  s_waitcnt lgkmcnt(6)
  v_mfma_f32_16x16x32_bf16 v[56:59], v[16:19], v[208:211], v[56:59]
  ds_read_b64_tr_b16 v[36:37], v2 offset:9360
  v_mfma_f32_16x16x32_bf16 v[60:63], v[16:19], v[212:215], v[60:63]
  ds_read_b64_tr_b16 v[38:39], v2 offset:13968
  v_mfma_f32_16x16x32_bf16 v[64:67], v[20:23], v[208:211], v[64:67]
  ds_read_b64_tr_b16 v[16:17], v1 offset:18504
  v_mfma_f32_16x16x32_bf16 v[68:71], v[20:23], v[212:215], v[68:71]
  ds_read_b64_tr_b16 v[18:19], v1 offset:23112
  s_waitcnt lgkmcnt(6)
  v_mfma_f32_16x16x32_bf16 v[72:75], v[24:27], v[208:211], v[72:75]
  ds_read_b64_tr_b16 v[20:21], v1 offset:18536
  v_mfma_f32_16x16x32_bf16 v[76:79], v[24:27], v[212:215], v[76:79]
  ds_read_b64_tr_b16 v[22:23], v1 offset:23144
  v_mfma_f32_16x16x32_bf16 v[56:59], v[28:31], v[216:219], v[56:59]
  ds_read_b64_tr_b16 v[24:25], v2 offset:18432
  v_mfma_f32_16x16x32_bf16 v[60:63], v[28:31], v[220:223], v[60:63]
  ds_read_b64_tr_b16 v[26:27], v2 offset:23040
  s_waitcnt lgkmcnt(6)
  v_mfma_f32_16x16x32_bf16 v[64:67], v[32:35], v[216:219], v[64:67]
  ds_read_b64_tr_b16 v[28:29], v1 offset:18648
  v_mfma_f32_16x16x32_bf16 v[68:71], v[32:35], v[220:223], v[68:71]
  ds_read_b64_tr_b16 v[30:31], v1 offset:23256
  v_mfma_f32_16x16x32_bf16 v[72:75], v[36:39], v[216:219], v[72:75]
  ds_read_b64_tr_b16 v[32:33], v1 offset:18680
  v_mfma_f32_16x16x32_bf16 v[76:79], v[36:39], v[220:223], v[76:79]
  ds_read_b64_tr_b16 v[34:35], v1 offset:23288
  s_waitcnt lgkmcnt(6)
  v_mfma_f32_16x16x32_bf16 v[56:59], v[16:19], v[224:227], v[56:59]
  ds_read_b64_tr_b16 v[36:37], v2 offset:18576
  v_mfma_f32_16x16x32_bf16 v[60:63], v[16:19], v[228:231], v[60:63]
  ds_read_b64_tr_b16 v[38:39], v2 offset:23184
  v_mfma_f32_16x16x32_bf16 v[64:67], v[20:23], v[224:227], v[64:67]
  ds_read_b64_tr_b16 v[16:17], v3 offset:0
  v_mfma_f32_16x16x32_bf16 v[68:71], v[20:23], v[228:231], v[68:71]
  ds_read_b64_tr_b16 v[18:19], v3 offset:4608
  s_waitcnt lgkmcnt(6)
  v_mfma_f32_16x16x32_bf16 v[72:75], v[24:27], v[224:227], v[72:75]
  ds_read_b64_tr_b16 v[20:21], v3 offset:32
  v_mfma_f32_16x16x32_bf16 v[76:79], v[24:27], v[228:231], v[76:79]
  ds_read_b64_tr_b16 v[22:23], v3 offset:4640
  v_mfma_f32_16x16x32_bf16 v[56:59], v[28:31], v[232:235], v[56:59]
  ds_read_b64_tr_b16 v[24:25], v3 offset:144
  v_mfma_f32_16x16x32_bf16 v[60:63], v[28:31], v[236:239], v[60:63]
  ds_read_b64_tr_b16 v[26:27], v3 offset:4752
  s_waitcnt lgkmcnt(6)
  v_mfma_f32_16x16x32_bf16 v[64:67], v[32:35], v[232:235], v[64:67]
  ds_read_b64_tr_b16 v[28:29], v3 offset:176
  v_mfma_f32_16x16x32_bf16 v[68:71], v[32:35], v[236:239], v[68:71]
  ds_read_b64_tr_b16 v[30:31], v3 offset:4784
  v_mfma_f32_16x16x32_bf16 v[72:75], v[36:39], v[232:235], v[72:75]
  ds_read_b64_tr_b16 v[32:33], v3 offset:9216
  v_mfma_f32_16x16x32_bf16 v[76:79], v[36:39], v[236:239], v[76:79]
  ds_read_b64_tr_b16 v[34:35], v3 offset:13824
  s_waitcnt lgkmcnt(6)
  v_mfma_f32_16x16x32_bf16 v[40:43], v[16:19], v[112:115], 0
  ds_read_b64_tr_b16 v[36:37], v3 offset:9248
  v_mfma_f32_16x16x32_bf16 v[44:47], v[16:19], v[116:119], 0
  ds_read_b64_tr_b16 v[38:39], v3 offset:13856
  v_mfma_f32_16x16x32_bf16 v[48:51], v[20:23], v[112:115], 0
  ds_read_b64_tr_b16 v[16:17], v3 offset:9360
  v_cvt_pk_bf16_f32 v56, v56, v57
  v_cvt_pk_bf16_f32 v57, v58, v59
  v_mfma_f32_16x16x32_bf16 v[52:55], v[20:23], v[116:119], 0
  ds_read_b64_tr_b16 v[18:19], v3 offset:13968
  v_cvt_pk_bf16_f32 v58, v64, v65
  v_cvt_pk_bf16_f32 v59, v66, v67
  s_waitcnt lgkmcnt(6)
  v_mfma_f32_16x16x32_bf16 v[40:43], v[24:27], v[120:123], v[40:43]
  ds_read_b64_tr_b16 v[20:21], v3 offset:9392
  ds_write_b128 v12, v[56:59] offset:0
  v_cvt_pk_bf16_f32 v60, v60, v61
  v_mfma_f32_16x16x32_bf16 v[44:47], v[24:27], v[124:127], v[44:47]
  ds_read_b64_tr_b16 v[22:23], v3 offset:14000
  v_cvt_pk_bf16_f32 v61, v62, v63
  v_cvt_pk_bf16_f32 v62, v68, v69
  v_mfma_f32_16x16x32_bf16 v[48:51], v[28:31], v[120:123], v[48:51]
  ds_read_b64_tr_b16 v[24:25], v3 offset:18432
  v_cvt_pk_bf16_f32 v63, v70, v71
  ds_write_b128 v12, v[60:63] offset:1024
  v_mfma_f32_16x16x32_bf16 v[52:55], v[28:31], v[124:127], v[52:55]
  ds_read_b64_tr_b16 v[26:27], v3 offset:23040
  v_cvt_pk_bf16_f32 v72, v72, v73
  v_cvt_pk_bf16_f32 v73, v74, v75
  s_waitcnt lgkmcnt(8)
  v_mfma_f32_16x16x32_bf16 v[40:43], v[32:35], v[192:195], v[40:43]
  ds_read_b64_tr_b16 v[28:29], v3 offset:18464
  v_cvt_pk_bf16_f32 v74, v76, v77
  v_cvt_pk_bf16_f32 v75, v78, v79
  v_mfma_f32_16x16x32_bf16 v[44:47], v[32:35], v[196:199], v[44:47]
  ds_read_b64_tr_b16 v[30:31], v3 offset:23072
  s_mov_b64 exec, s[34:35]
  ds_write_b128 v13, v[72:75]
  s_mov_b64 exec, -1
  v_mfma_f32_16x16x32_bf16 v[48:51], v[36:39], v[192:195], v[48:51]
  ds_read_b64_tr_b16 v[32:33], v3 offset:18576
  s_waitcnt lgkmcnt(1)
  s_barrier
  v_mfma_f32_16x16x32_bf16 v[52:55], v[36:39], v[196:199], v[52:55]
  ds_read_b64_tr_b16 v[34:35], v3 offset:23184
  v_cndmask_b32 v72, 0, v72, s[32:33]
  v_cndmask_b32 v73, 0, v73, s[32:33]
  v_mfma_f32_16x16x32_bf16 v[40:43], v[16:19], v[200:203], v[40:43]
  ds_read_b64_tr_b16 v[36:37], v3 offset:18608
  v_cndmask_b32 v74, 0, v74, s[32:33]
  v_cndmask_b32 v75, 0, v75, s[32:33]
  v_mfma_f32_16x16x32_bf16 v[44:47], v[16:19], v[204:207], v[44:47]
  ds_read_b64_tr_b16 v[38:39], v3 offset:23216
  v_mfma_f32_16x16x32_bf16 v[48:51], v[20:23], v[200:203], v[48:51]
  ds_read_b64_tr_b16 v[16:17], v3 offset:27648
  v_mfma_f32_16x16x32_bf16 v[52:55], v[20:23], v[204:207], v[52:55]
  ds_read_b64_tr_b16 v[18:19], v3 offset:32256
  v_mfma_f32_16x16x32_bf16 v[40:43], v[24:27], v[240:243], v[40:43]
  ds_read_b64_tr_b16 v[20:21], v3 offset:27680
  ds_read_b128 v[112:115], v5 offset:0
  v_mfma_f32_16x16x32_bf16 v[44:47], v[24:27], v[244:247], v[44:47]
  ds_read_b64_tr_b16 v[22:23], v3 offset:32288
  ds_read_b128 v[116:119], v5 offset:1024
  v_mfma_f32_16x16x32_bf16 v[48:51], v[28:31], v[240:243], v[48:51]
  ds_read_b64_tr_b16 v[24:25], v3 offset:27792
  ds_read_b128 v[120:123], v5 offset:2048
  v_mfma_f32_16x16x32_bf16 v[52:55], v[28:31], v[244:247], v[52:55]
  ds_read_b64_tr_b16 v[26:27], v3 offset:32400
  ds_read_b32 v6, v6
  s_waitcnt lgkmcnt(10)
  v_mfma_f32_16x16x32_bf16 v[40:43], v[32:35], v[248:251], v[40:43]
  ds_read_b64_tr_b16 v[28:29], v3 offset:27824
  v_mfma_f32_16x16x32_bf16 v[44:47], v[32:35], v[252:255], v[44:47]
  ds_read_b64_tr_b16 v[30:31], v3 offset:32432
  v_mfma_f32_16x16x32_bf16 v[48:51], v[36:39], v[248:251], v[48:51]
  ds_read_b64_tr_b16 v[32:33], v3 offset:36864
  v_mfma_f32_16x16x32_bf16 v[52:55], v[36:39], v[252:255], v[52:55]
  ds_read_b64_tr_b16 v[34:35], v3 offset:41472
  s_waitcnt lgkmcnt(9)
  v_mfma_f32_16x16x32_bf16 v[40:43], v[16:19], v[128:131], v[40:43]
  ds_read_b64_tr_b16 v[36:37], v3 offset:36896
  s_waitcnt lgkmcnt(9)
  v_add_u32 v118, s10, v118
  v_mfma_f32_16x16x32_bf16 v[44:47], v[16:19], v[132:135], v[44:47]
  ds_read_b64_tr_b16 v[38:39], v3 offset:41504
  v_add_u32 v125, s10, v14
  v_mfma_f32_16x16x32_bf16 v[48:51], v[20:23], v[128:131], v[48:51]
  ds_read_b64_tr_b16 v[16:17], v3 offset:37008
  v_add_u32 v126, s66, v14
  v_mfma_f32_16x16x32_bf16 v[52:55], v[20:23], v[132:135], v[52:55]
  ds_read_b64_tr_b16 v[18:19], v3 offset:41616
  v_add_u32 v127, 54272, v126
  s_waitcnt lgkmcnt(6)
  v_mfma_f32_16x16x32_bf16 v[40:43], v[24:27], v[136:139], v[40:43]
  ds_read_b64_tr_b16 v[20:21], v3 offset:37040
  v_add_u32 v124, 82944, v3
  v_mfma_f32_16x16x32_bf16 v[44:47], v[24:27], v[140:143], v[44:47]
  ds_read_b64_tr_b16 v[22:23], v3 offset:41648
  v_lshrrev_b32 v7, 3, v0
  v_mfma_f32_16x16x32_bf16 v[48:51], v[28:31], v[136:139], v[48:51]
  ds_read_b64_tr_b16 v[24:25], v3 offset:46080
  v_mul_u32_u24 v7, 2176, v7
  v_mfma_f32_16x16x32_bf16 v[52:55], v[28:31], v[140:143], v[52:55]
  ds_read_b64_tr_b16 v[26:27], v3 offset:50688
  v_add_u32 v7, v7, v14
  s_waitcnt lgkmcnt(6)
  v_mfma_f32_16x16x32_bf16 v[40:43], v[32:35], v[144:147], v[40:43]
  ds_read_b64_tr_b16 v[28:29], v3 offset:46112
  v_readfirstlane_b32 s79, v6
  v_mfma_f32_16x16x32_bf16 v[44:47], v[32:35], v[148:151], v[44:47]
  ds_read_b64_tr_b16 v[30:31], v3 offset:50720
  s_add_u32 s13, s52, 2097152
  s_addc_u32 s14, s53, 0
  s_cmp_eq_u32 s79, 0
  s_cselect_b32 s56, s13, s48
  s_cselect_b32 s57, s14, s49
  s_mov_b32 s58, 4718592
  s_mov_b32 s59, 0x20000
  v_mfma_f32_16x16x32_bf16 v[48:51], v[36:39], v[144:147], v[48:51]
  ds_read_b64_tr_b16 v[32:33], v3 offset:46224
  ds_read_b64_tr_b16 v[80:81], v9 offset:0
  v_mfma_f32_16x16x32_bf16 v[52:55], v[36:39], v[148:151], v[52:55]
  ds_read_b64_tr_b16 v[34:35], v3 offset:50832
  ds_read_b64_tr_b16 v[82:83], v10 offset:0
  s_waitcnt lgkmcnt(8)
  v_mfma_f32_16x16x32_bf16 v[40:43], v[16:19], v[152:155], v[40:43]
  ds_read_b64_tr_b16 v[36:37], v3 offset:46256
  ds_read_b64_tr_b16 v[84:85], v11 offset:0
  v_mfma_f32_16x16x32_bf16 v[44:47], v[16:19], v[156:159], v[44:47]
  ds_read_b64_tr_b16 v[38:39], v3 offset:50864
  ds_read_b64_tr_b16 v[86:87], v9 offset:8
  v_mfma_f32_16x16x32_bf16 v[48:51], v[20:23], v[152:155], v[48:51]
  ds_read_b64_tr_b16 v[16:17], v1 offset:0
  ds_read_b64_tr_b16 v[88:89], v10 offset:8
  v_mfma_f32_16x16x32_bf16 v[52:55], v[20:23], v[156:159], v[52:55]
  ds_read_b64_tr_b16 v[18:19], v1 offset:4608
  ds_read_b64_tr_b16 v[90:91], v11 offset:8
  s_waitcnt lgkmcnt(12)
  v_mfma_f32_16x16x32_bf16 v[40:43], v[24:27], v[160:163], v[40:43]
  ds_read_b64_tr_b16 v[20:21], v1 offset:32
  ds_read_b64_tr_b16 v[92:93], v9 offset:16
  v_mfma_f32_16x16x32_bf16 v[44:47], v[24:27], v[164:167], v[44:47]
  ds_read_b64_tr_b16 v[22:23], v1 offset:4640
  ds_read_b64_tr_b16 v[94:95], v10 offset:16
  v_mfma_f32_16x16x32_bf16 v[48:51], v[28:31], v[160:163], v[48:51]
  ds_read_b64_tr_b16 v[24:25], v1 offset:144
  ds_read_b64_tr_b16 v[96:97], v11 offset:16
  v_mfma_f32_16x16x32_bf16 v[52:55], v[28:31], v[164:167], v[52:55]
  ds_read_b64_tr_b16 v[26:27], v1 offset:4752
  ds_read_b64_tr_b16 v[98:99], v9 offset:24
  s_waitcnt lgkmcnt(13)
  v_mfma_f32_16x16x32_bf16 v[40:43], v[32:35], v[168:171], v[40:43]
  ds_read_b64_tr_b16 v[28:29], v1 offset:176
  ds_read_b64_tr_b16 v[100:101], v10 offset:24
  v_mfma_f32_16x16x32_bf16 v[44:47], v[32:35], v[172:175], v[44:47]
  ds_read_b64_tr_b16 v[30:31], v1 offset:4784
  ds_read_b64_tr_b16 v[102:103], v11 offset:24
  v_mfma_f32_16x16x32_bf16 v[48:51], v[36:39], v[168:171], v[48:51]
  ds_read_b64_tr_b16 v[32:33], v1 offset:9216
  ds_read_b64_tr_b16 v[104:105], v9 offset:32
  v_mfma_f32_16x16x32_bf16 v[52:55], v[36:39], v[172:175], v[52:55]
  ds_read_b64_tr_b16 v[34:35], v1 offset:13824
  ds_read_b64_tr_b16 v[106:107], v10 offset:32
  s_waitcnt lgkmcnt(13)
  v_mfma_f32_16x16x32_bf16 v[40:43], v[16:19], v[176:179], v[40:43]
  ds_read_b64_tr_b16 v[36:37], v1 offset:9248
  ds_read_b64_tr_b16 v[108:109], v11 offset:32
  v_mfma_f32_16x16x32_bf16 v[44:47], v[16:19], v[180:183], v[44:47]
  ds_read_b64_tr_b16 v[38:39], v1 offset:13856
  v_mfma_f32_16x16x32_bf16 v[48:51], v[20:23], v[176:179], v[48:51]
  ds_read_b64_tr_b16 v[16:17], v1 offset:9360
  v_mfma_f32_16x16x32_bf16 v[52:55], v[20:23], v[180:183], v[52:55]
  ds_read_b64_tr_b16 v[18:19], v1 offset:13968
  s_waitcnt lgkmcnt(10)
  v_mfma_f32_16x16x32_bf16 v[40:43], v[24:27], v[184:187], v[40:43]
  ds_read_b64_tr_b16 v[20:21], v1 offset:9392
  v_mfma_f32_16x16x32_bf16 v[44:47], v[24:27], v[188:191], v[44:47]
  ds_read_b64_tr_b16 v[22:23], v1 offset:14000
  v_mfma_f32_16x16x32_bf16 v[48:51], v[28:31], v[184:187], v[48:51]
  ds_read_b64_tr_b16 v[24:25], v1 offset:18432
  v_mfma_f32_16x16x32_bf16 v[52:55], v[28:31], v[188:191], v[52:55]
  ds_read_b64_tr_b16 v[26:27], v1 offset:23040
  s_waitcnt lgkmcnt(6)
  v_mfma_f32_16x16x32_bf16 v[40:43], v[32:35], v[208:211], v[40:43]
  ds_read_b64_tr_b16 v[28:29], v1 offset:18464
  v_mfma_f32_16x16x32_bf16 v[44:47], v[32:35], v[212:215], v[44:47]
  ds_read_b64_tr_b16 v[30:31], v1 offset:23072
  v_mfma_f32_16x16x32_bf16 v[48:51], v[36:39], v[208:211], v[48:51]
  ds_read_b64_tr_b16 v[32:33], v1 offset:18576
  v_mfma_f32_16x16x32_bf16 v[52:55], v[36:39], v[212:215], v[52:55]
  ds_read_b64_tr_b16 v[34:35], v1 offset:23184
  s_waitcnt lgkmcnt(6)
  v_mfma_f32_16x16x32_bf16 v[40:43], v[16:19], v[216:219], v[40:43]
  ds_read_b64_tr_b16 v[36:37], v1 offset:18608
  v_mfma_f32_16x16x32_bf16 v[44:47], v[16:19], v[220:223], v[44:47]
  ds_read_b64_tr_b16 v[38:39], v1 offset:23216
  v_mfma_f32_16x16x32_bf16 v[48:51], v[20:23], v[216:219], v[48:51]
  v_mfma_f32_16x16x32_bf16 v[52:55], v[20:23], v[220:223], v[52:55]
  s_waitcnt lgkmcnt(4)
  v_mfma_f32_16x16x32_bf16 v[40:43], v[24:27], v[224:227], v[40:43]
  v_mfma_f32_16x16x32_bf16 v[44:47], v[24:27], v[228:231], v[44:47]
  v_mfma_f32_16x16x32_bf16 v[48:51], v[28:31], v[224:227], v[48:51]
  v_mfma_f32_16x16x32_bf16 v[52:55], v[28:31], v[228:231], v[52:55]
  s_waitcnt lgkmcnt(0)
  v_mfma_f32_16x16x32_bf16 v[40:43], v[32:35], v[232:235], v[40:43]
  v_mfma_f32_16x16x32_bf16 v[44:47], v[32:35], v[236:239], v[44:47]
  v_mfma_f32_16x16x32_bf16 v[48:51], v[36:39], v[232:235], v[48:51]
  v_mfma_f32_16x16x32_bf16 v[52:55], v[36:39], v[236:239], v[52:55]
  v_mov_b32 v5, s67
  ds_write_b32 v5, v5
  v_mov_b32 v136, 0
  v_mov_b32 v137, 0
  v_mov_b32 v138, 0
  v_mov_b32 v139, 0
  v_mov_b32 v140, 0
  v_mov_b32 v141, 0
  v_cvt_pk_bf16_f32 v40, v40, v41
  v_cvt_pk_bf16_f32 v41, v42, v43
  v_cvt_pk_bf16_f32 v42, v48, v49
  v_cvt_pk_bf16_f32 v43, v50, v51
  v_cvt_pk_bf16_f32 v44, v44, v45
  v_cvt_pk_bf16_f32 v45, v46, v47
  v_cvt_pk_bf16_f32 v46, v52, v53
  v_cvt_pk_bf16_f32 v47, v54, v55
  v_mfma_f32_16x16x32_bf16 v[200:203], v[80:83], v[40:43], 0
  v_mfma_f32_16x16x32_bf16 v[204:207], v[86:89], v[40:43], 0
  v_mfma_f32_16x16x32_bf16 v[208:211], v[92:95], v[40:43], 0
  v_mfma_f32_16x16x32_bf16 v[212:215], v[98:101], v[40:43], 0
  v_mfma_f32_16x16x32_bf16 v[216:219], v[104:107], v[40:43], 0
  v_mfma_f32_16x16x32_bf16 v[220:223], v[80:83], v[44:47], 0
  v_mfma_f32_16x16x32_bf16 v[224:227], v[86:89], v[44:47], 0
  v_mov_b32 v142, 0
  v_mov_b32 v143, 0
  v_mfma_f32_16x16x32_bf16 v[228:231], v[92:95], v[44:47], 0
  v_mov_b32 v144, 0
  v_mov_b32 v145, 0
  v_mfma_f32_16x16x32_bf16 v[232:235], v[98:101], v[44:47], 0
  v_mov_b32 v146, 0
  v_mov_b32 v147, 0
  v_mfma_f32_16x16x32_bf16 v[236:239], v[104:107], v[44:47], 0
  v_mov_b32 v148, 0
  v_mov_b32 v149, 0
  v_mfma_f32_16x16x16_bf16 v[200:203], v[84:85], v[72:73], v[200:203]
  v_mov_b32 v150, 0
  v_mov_b32 v151, 0
  v_mfma_f32_16x16x16_bf16 v[204:207], v[90:91], v[72:73], v[204:207]
  v_mov_b32 v152, 0
  v_mov_b32 v153, 0
  v_mfma_f32_16x16x16_bf16 v[208:211], v[96:97], v[72:73], v[208:211]
  v_mov_b32 v154, 0
  v_mov_b32 v155, 0
  v_mfma_f32_16x16x16_bf16 v[212:215], v[102:103], v[72:73], v[212:215]
  v_mov_b32 v156, 0
  v_mov_b32 v157, 0
  v_mfma_f32_16x16x16_bf16 v[216:219], v[108:109], v[72:73], v[216:219]
  v_mov_b32 v158, 0
  v_mov_b32 v159, 0
  v_mfma_f32_16x16x16_bf16 v[220:223], v[84:85], v[74:75], v[220:223]
  v_mov_b32 v160, 0
  v_mov_b32 v161, 0
  v_mfma_f32_16x16x16_bf16 v[224:227], v[90:91], v[74:75], v[224:227]
  v_mov_b32 v162, 0
  v_mov_b32 v163, 0
  v_mfma_f32_16x16x16_bf16 v[228:231], v[96:97], v[74:75], v[228:231]
  v_mov_b32 v164, 0
  v_mov_b32 v165, 0
  v_mfma_f32_16x16x16_bf16 v[232:235], v[102:103], v[74:75], v[232:235]
  v_mfma_f32_16x16x16_bf16 v[236:239], v[108:109], v[74:75], v[236:239]
  v_max3_f32 v54, v200, v201, v202
  v_max3_f32 v55, v203, v204, v205
  v_max3_f32 v54, v206, v207, v54
  v_max3_f32 v55, v208, v209, v55
  v_max3_f32 v54, v210, v211, v54
  v_max3_f32 v55, v212, v213, v55
  v_max3_f32 v54, v214, v215, v54
  v_max3_f32 v55, v216, v217, v55
  v_max_f32 v54, v54, v55
  v_mul_f32 v54, s76, v54
  v_pk_fma_f32 v[200:201], v[200:201], s[76:77], v[54:55] op_sel_hi:[1,1,0] neg_lo:[0,0,1] neg_hi:[0,0,1]
  v_pk_fma_f32 v[202:203], v[202:203], s[76:77], v[54:55] op_sel_hi:[1,1,0] neg_lo:[0,0,1] neg_hi:[0,0,1]
  v_pk_fma_f32 v[204:205], v[204:205], s[76:77], v[54:55] op_sel_hi:[1,1,0] neg_lo:[0,0,1] neg_hi:[0,0,1]
  v_pk_fma_f32 v[206:207], v[206:207], s[76:77], v[54:55] op_sel_hi:[1,1,0] neg_lo:[0,0,1] neg_hi:[0,0,1]
  v_pk_fma_f32 v[208:209], v[208:209], s[76:77], v[54:55] op_sel_hi:[1,1,0] neg_lo:[0,0,1] neg_hi:[0,0,1]
  v_pk_fma_f32 v[210:211], v[210:211], s[76:77], v[54:55] op_sel_hi:[1,1,0] neg_lo:[0,0,1] neg_hi:[0,0,1]
  v_pk_fma_f32 v[212:213], v[212:213], s[76:77], v[54:55] op_sel_hi:[1,1,0] neg_lo:[0,0,1] neg_hi:[0,0,1]
  v_pk_fma_f32 v[214:215], v[214:215], s[76:77], v[54:55] op_sel_hi:[1,1,0] neg_lo:[0,0,1] neg_hi:[0,0,1]
  v_pk_fma_f32 v[216:217], v[216:217], s[76:77], v[54:55] op_sel_hi:[1,1,0] neg_lo:[0,0,1] neg_hi:[0,0,1]
  v_exp_f32 v200, v200
  v_exp_f32 v201, v201
  v_exp_f32 v202, v202
  v_exp_f32 v203, v203
  v_exp_f32 v204, v204
  v_exp_f32 v205, v205
  v_exp_f32 v206, v206
  v_exp_f32 v207, v207
  v_exp_f32 v208, v208
  v_exp_f32 v209, v209
  v_exp_f32 v210, v210
  v_exp_f32 v211, v211
  v_exp_f32 v212, v212
  v_exp_f32 v213, v213
  v_exp_f32 v214, v214
  v_exp_f32 v215, v215
  v_exp_f32 v216, v216
  v_exp_f32 v217, v217
  v_pk_add_f32 v[54:55], v[200:201], v[202:203]
  v_pk_add_f32 v[54:55], v[54:55], v[204:205]
  v_pk_add_f32 v[54:55], v[54:55], v[206:207]
  v_pk_add_f32 v[54:55], v[54:55], v[208:209]
  v_pk_add_f32 v[54:55], v[54:55], v[210:211]
  v_pk_add_f32 v[54:55], v[54:55], v[212:213]
  v_pk_add_f32 v[54:55], v[54:55], v[214:215]
  v_pk_add_f32 v[54:55], v[54:55], v[216:217]
  v_add_f32 v54, v54, v55
  v_rcp_f32 v54, v54
  s_nop 0
  v_pk_mul_f32 v[200:201], v[200:201], v[54:55] op_sel_hi:[1,0]
  v_pk_mul_f32 v[202:203], v[202:203], v[54:55] op_sel_hi:[1,0]
  v_pk_mul_f32 v[204:205], v[204:205], v[54:55] op_sel_hi:[1,0]
  v_pk_mul_f32 v[206:207], v[206:207], v[54:55] op_sel_hi:[1,0]
  v_pk_mul_f32 v[208:209], v[208:209], v[54:55] op_sel_hi:[1,0]
  v_pk_mul_f32 v[210:211], v[210:211], v[54:55] op_sel_hi:[1,0]
  v_pk_mul_f32 v[212:213], v[212:213], v[54:55] op_sel_hi:[1,0]
  v_pk_mul_f32 v[214:215], v[214:215], v[54:55] op_sel_hi:[1,0]
  v_pk_mul_f32 v[216:217], v[216:217], v[54:55] op_sel_hi:[1,0]
  v_cvt_pk_bf16_f32 v200, v200, v201
  v_cvt_pk_bf16_f32 v201, v202, v203
  v_cvt_pk_bf16_f32 v202, v204, v205
  v_cvt_pk_bf16_f32 v203, v206, v207
  v_cvt_pk_bf16_f32 v204, v208, v209
  v_cvt_pk_bf16_f32 v205, v210, v211
  v_cvt_pk_bf16_f32 v206, v212, v213
  v_cvt_pk_bf16_f32 v207, v214, v215
  v_cvt_pk_bf16_f32 v208, v216, v217
  v_mov_b32 v209, 0
  v_max3_f32 v54, v220, v221, v222
  v_max3_f32 v55, v223, v224, v225
  v_max3_f32 v54, v226, v227, v54
  v_max3_f32 v55, v228, v229, v55
  v_max3_f32 v54, v230, v231, v54
  v_max3_f32 v55, v232, v233, v55
  v_max3_f32 v54, v234, v235, v54
  v_max3_f32 v55, v236, v237, v55
  v_max_f32 v54, v54, v55
  v_mul_f32 v54, s76, v54
  v_pk_fma_f32 v[220:221], v[220:221], s[76:77], v[54:55] op_sel_hi:[1,1,0] neg_lo:[0,0,1] neg_hi:[0,0,1]
  v_pk_fma_f32 v[222:223], v[222:223], s[76:77], v[54:55] op_sel_hi:[1,1,0] neg_lo:[0,0,1] neg_hi:[0,0,1]
  v_pk_fma_f32 v[224:225], v[224:225], s[76:77], v[54:55] op_sel_hi:[1,1,0] neg_lo:[0,0,1] neg_hi:[0,0,1]
  v_pk_fma_f32 v[226:227], v[226:227], s[76:77], v[54:55] op_sel_hi:[1,1,0] neg_lo:[0,0,1] neg_hi:[0,0,1]
  v_pk_fma_f32 v[228:229], v[228:229], s[76:77], v[54:55] op_sel_hi:[1,1,0] neg_lo:[0,0,1] neg_hi:[0,0,1]
  v_pk_fma_f32 v[230:231], v[230:231], s[76:77], v[54:55] op_sel_hi:[1,1,0] neg_lo:[0,0,1] neg_hi:[0,0,1]
  v_pk_fma_f32 v[232:233], v[232:233], s[76:77], v[54:55] op_sel_hi:[1,1,0] neg_lo:[0,0,1] neg_hi:[0,0,1]
  v_pk_fma_f32 v[234:235], v[234:235], s[76:77], v[54:55] op_sel_hi:[1,1,0] neg_lo:[0,0,1] neg_hi:[0,0,1]
  v_pk_fma_f32 v[236:237], v[236:237], s[76:77], v[54:55] op_sel_hi:[1,1,0] neg_lo:[0,0,1] neg_hi:[0,0,1]
  v_exp_f32 v220, v220
  v_exp_f32 v221, v221
  v_exp_f32 v222, v222
  v_exp_f32 v223, v223
  v_exp_f32 v224, v224
  v_exp_f32 v225, v225
  v_exp_f32 v226, v226
  v_exp_f32 v227, v227
  v_exp_f32 v228, v228
  v_exp_f32 v229, v229
  v_exp_f32 v230, v230
  v_exp_f32 v231, v231
  v_exp_f32 v232, v232
  v_exp_f32 v233, v233
  v_exp_f32 v234, v234
  v_exp_f32 v235, v235
  v_exp_f32 v236, v236
  v_exp_f32 v237, v237
  v_pk_add_f32 v[54:55], v[220:221], v[222:223]
  v_pk_add_f32 v[54:55], v[54:55], v[224:225]
  v_pk_add_f32 v[54:55], v[54:55], v[226:227]
  v_pk_add_f32 v[54:55], v[54:55], v[228:229]
  v_pk_add_f32 v[54:55], v[54:55], v[230:231]
  v_pk_add_f32 v[54:55], v[54:55], v[232:233]
  v_pk_add_f32 v[54:55], v[54:55], v[234:235]
  v_pk_add_f32 v[54:55], v[54:55], v[236:237]
  v_add_f32 v54, v54, v55
  v_rcp_f32 v54, v54
  s_nop 0
  v_pk_mul_f32 v[220:221], v[220:221], v[54:55] op_sel_hi:[1,0]
  v_pk_mul_f32 v[222:223], v[222:223], v[54:55] op_sel_hi:[1,0]
  v_pk_mul_f32 v[224:225], v[224:225], v[54:55] op_sel_hi:[1,0]
  v_pk_mul_f32 v[226:227], v[226:227], v[54:55] op_sel_hi:[1,0]
  v_pk_mul_f32 v[228:229], v[228:229], v[54:55] op_sel_hi:[1,0]
  v_pk_mul_f32 v[230:231], v[230:231], v[54:55] op_sel_hi:[1,0]
  v_pk_mul_f32 v[232:233], v[232:233], v[54:55] op_sel_hi:[1,0]
  v_pk_mul_f32 v[234:235], v[234:235], v[54:55] op_sel_hi:[1,0]
  v_pk_mul_f32 v[236:237], v[236:237], v[54:55] op_sel_hi:[1,0]
  v_cvt_pk_bf16_f32 v220, v220, v221
  v_cvt_pk_bf16_f32 v221, v222, v223
  v_cvt_pk_bf16_f32 v222, v224, v225
  v_cvt_pk_bf16_f32 v223, v226, v227
  v_cvt_pk_bf16_f32 v224, v228, v229
  v_cvt_pk_bf16_f32 v225, v230, v231
  v_cvt_pk_bf16_f32 v226, v232, v233
  v_cvt_pk_bf16_f32 v227, v234, v235
  v_cvt_pk_bf16_f32 v228, v236, v237
  v_mov_b32 v229, 0
  s_barrier
  s_add_u32 s14, s29, 36864
  s_add_u32 s15, s30, 36864
  s_mov_b64 exec, s[16:17]
  ds_read_b128 v[156:159], v113 offset:0
  ds_read_b128 v[136:139], v112 offset:0
  ds_read_b128 v[146:149], v112 offset:64
  ds_read_b128 v[160:163], v113 offset:304
  ds_read_b128 v[140:143], v112 offset:304
  ds_read_b128 v[150:153], v112 offset:368
  ds_read_b32 v164, v115 offset:0
  ds_read_b32 v144, v114 offset:0
  ds_read_b32 v154, v114 offset:32
  s_mov_b64 exec, -1
  s_waitcnt lgkmcnt(8)
  v_mfma_f32_16x16x32_bf16 v[24:27], v[156:159], v[200:203], 0
  s_waitcnt lgkmcnt(7)
  v_mfma_f32_16x16x32_bf16 v[16:19], v[136:139], v[200:203], 0
  s_waitcnt lgkmcnt(6)
  v_mfma_f32_16x16x32_bf16 v[20:23], v[146:149], v[200:203], 0
  v_mfma_f32_16x16x32_bf16 v[36:39], v[156:159], v[220:223], 0
  v_mfma_f32_16x16x32_bf16 v[28:31], v[136:139], v[220:223], 0
  v_mfma_f32_16x16x32_bf16 v[32:35], v[146:149], v[220:223], 0
  s_waitcnt lgkmcnt(5)
  v_mfma_f32_16x16x32_bf16 v[24:27], v[160:163], v[204:207], v[24:27]
  s_waitcnt lgkmcnt(4)
  v_mfma_f32_16x16x32_bf16 v[16:19], v[140:143], v[204:207], v[16:19]
  s_waitcnt lgkmcnt(3)
  v_mfma_f32_16x16x32_bf16 v[20:23], v[150:153], v[204:207], v[20:23]
  v_mfma_f32_16x16x32_bf16 v[36:39], v[160:163], v[224:227], v[36:39]
  v_mfma_f32_16x16x32_bf16 v[28:31], v[140:143], v[224:227], v[28:31]
  v_mfma_f32_16x16x32_bf16 v[32:35], v[150:153], v[224:227], v[32:35]
  s_waitcnt lgkmcnt(2)
  v_mfma_f32_16x16x16_bf16 v[24:27], v[164:165], v[208:209], v[24:27]
  s_waitcnt lgkmcnt(1)
  v_mfma_f32_16x16x16_bf16 v[16:19], v[144:145], v[208:209], v[16:19]
  s_waitcnt lgkmcnt(0)
  v_mfma_f32_16x16x16_bf16 v[20:23], v[154:155], v[208:209], v[20:23]
  v_mfma_f32_16x16x16_bf16 v[36:39], v[164:165], v[228:229], v[36:39]
  v_mfma_f32_16x16x16_bf16 v[28:31], v[144:145], v[228:229], v[28:31]
  v_mfma_f32_16x16x16_bf16 v[32:35], v[154:155], v[228:229], v[32:35]
  s_nop 0
  v_add_f32 v24, s78, v24
  v_rcp_f32 v24, v24
  s_nop 0
  v_pk_mul_f32 v[16:17], v[16:17], v[24:25] op_sel_hi:[1,0]
  v_pk_mul_f32 v[18:19], v[18:19], v[24:25] op_sel_hi:[1,0]
  v_pk_mul_f32 v[20:21], v[20:21], v[24:25] op_sel_hi:[1,0]
  v_pk_mul_f32 v[22:23], v[22:23], v[24:25] op_sel_hi:[1,0]
  v_pk_mul_f32 v[26:27], v[26:27], v[24:25] op_sel_hi:[1,0]
  v_cvt_pk_bf16_f32 v64, v16, v17
  v_cvt_pk_bf16_f32 v65, v18, v19
  v_cvt_pk_bf16_f32 v66, v20, v21
  v_cvt_pk_bf16_f32 v67, v22, v23
  s_cmp_eq_u32 s79, 0
  s_cbranch_scc1 L_do0B
  buffer_store_dwordx4 v[64:67], v7, s[56:59], s29 offen
L_d_oko0B:
  v_cvt_pk_bf16_f32 v56, v26, v27
  v_mov_b32 v57, v56
  v_add_f32 v36, s78, v36
  v_rcp_f32 v36, v36
  s_nop 0
  v_pk_mul_f32 v[28:29], v[28:29], v[36:37] op_sel_hi:[1,0]
  v_pk_mul_f32 v[30:31], v[30:31], v[36:37] op_sel_hi:[1,0]
  v_pk_mul_f32 v[32:33], v[32:33], v[36:37] op_sel_hi:[1,0]
  v_pk_mul_f32 v[34:35], v[34:35], v[36:37] op_sel_hi:[1,0]
  v_pk_mul_f32 v[38:39], v[38:39], v[36:37] op_sel_hi:[1,0]
  v_cvt_pk_bf16_f32 v68, v28, v29
  v_cvt_pk_bf16_f32 v69, v30, v31
  v_cvt_pk_bf16_f32 v70, v32, v33
  v_cvt_pk_bf16_f32 v71, v34, v35
  s_cmp_eq_u32 s79, 0
  s_cbranch_scc1 L_do1B
  buffer_store_dwordx4 v[68:71], v7, s[56:59], s14 offen
L_d_oko1B:
  v_cvt_pk_bf16_f32 v60, v38, v39
  v_mov_b32 v61, v60
  v_permlane32_swap_b32 v56, v57
  s_nop 0
  v_permlane32_swap_b32 v60, v61
  s_barrier
  ds_read_b64_tr_b16 v[136:137], v124 offset:0
  ds_read_b64_tr_b16 v[138:139], v124 offset:4608
  ds_read_b64_tr_b16 v[140:141], v124 offset:32
  ds_read_b64_tr_b16 v[142:143], v124 offset:4640
  ds_read_b64_tr_b16 v[144:145], v124 offset:64
  ds_read_b64_tr_b16 v[146:147], v124 offset:4672
  ds_read_b64_tr_b16 v[148:149], v124 offset:96
  ds_read_b64_tr_b16 v[150:151], v124 offset:4704
  ds_read_b64_tr_b16 v[152:153], v124 offset:128
  ds_read_b64_tr_b16 v[154:155], v124 offset:4736
  ds_read_b128 v[72:75], v12 offset:0
  ds_read_b128 v[76:79], v12 offset:1024
  ds_read_b64 v[58:59], v13 offset:0
  ds_read_b64 v[62:63], v13 offset:8
  s_waitcnt lgkmcnt(12)
  v_mfma_f32_16x16x32_bf16 v[16:19], v[136:139], v[64:67], 0
  ds_read_b64_tr_b16 v[156:157], v124 offset:144
  v_mfma_f32_16x16x32_bf16 v[20:23], v[136:139], v[68:71], 0
  ds_read_b64_tr_b16 v[158:159], v124 offset:4752
  s_waitcnt lgkmcnt(12)
  v_mfma_f32_16x16x32_bf16 v[24:27], v[140:143], v[64:67], 0
  ds_read_b64_tr_b16 v[160:161], v124 offset:176
  v_mfma_f32_16x16x32_bf16 v[28:31], v[140:143], v[68:71], 0
  ds_read_b64_tr_b16 v[162:163], v124 offset:4784
  s_waitcnt lgkmcnt(12)
  v_mfma_f32_16x16x32_bf16 v[32:35], v[144:147], v[64:67], 0
  ds_read_b64_tr_b16 v[164:165], v124 offset:208
  v_mfma_f32_16x16x32_bf16 v[36:39], v[144:147], v[68:71], 0
  ds_read_b64_tr_b16 v[166:167], v124 offset:4816
  s_waitcnt lgkmcnt(12)
  v_mfma_f32_16x16x32_bf16 v[40:43], v[148:151], v[64:67], 0
  ds_read_b64_tr_b16 v[168:169], v124 offset:240
  v_mfma_f32_16x16x32_bf16 v[44:47], v[148:151], v[68:71], 0
  ds_read_b64_tr_b16 v[170:171], v124 offset:4848
  s_waitcnt lgkmcnt(12)
  v_mfma_f32_16x16x32_bf16 v[48:51], v[152:155], v[64:67], 0
  ds_read_b64_tr_b16 v[172:173], v124 offset:272
  s_waitcnt lgkmcnt(9)
  v_mov_b32 v15, v63
  s_cmp_eq_u32 s79, 0
  s_cbranch_scc1 L_dorB
  s_mov_b64 exec, 0xffff
  buffer_store_dwordx4 v[56:59], v7, s[56:59], s30 offen
  buffer_store_dwordx4 v[60:63], v7, s[56:59], s15 offen
  s_mov_b64 exec, -1
L_d_okorB:
  v_mfma_f32_16x16x32_bf16 v[52:55], v[152:155], v[68:71], 0
  ds_read_b64_tr_b16 v[174:175], v124 offset:4880
  s_waitcnt lgkmcnt(8)
  v_mfma_f32_16x16x32_bf16 v[16:19], v[156:159], v[72:75], v[16:19]
  ds_read_b64_tr_b16 v[176:177], v124 offset:9216
  v_mfma_f32_16x16x32_bf16 v[20:23], v[156:159], v[76:79], v[20:23]
  ds_read_b64_tr_b16 v[178:179], v124 offset:13824
  s_waitcnt lgkmcnt(8)
  v_mfma_f32_16x16x32_bf16 v[24:27], v[160:163], v[72:75], v[24:27]
  ds_read_b64_tr_b16 v[180:181], v124 offset:9248
  v_mfma_f32_16x16x32_bf16 v[28:31], v[160:163], v[76:79], v[28:31]
  ds_read_b64_tr_b16 v[182:183], v124 offset:13856
  s_waitcnt lgkmcnt(8)
  v_mfma_f32_16x16x32_bf16 v[32:35], v[164:167], v[72:75], v[32:35]
  ds_read_b64_tr_b16 v[184:185], v124 offset:9280
  v_mfma_f32_16x16x32_bf16 v[36:39], v[164:167], v[76:79], v[36:39]
  ds_read_b64_tr_b16 v[186:187], v124 offset:13888
  s_waitcnt lgkmcnt(8)
  v_mfma_f32_16x16x32_bf16 v[40:43], v[168:171], v[72:75], v[40:43]
  ds_read_b64_tr_b16 v[188:189], v124 offset:9312
  v_mfma_f32_16x16x32_bf16 v[44:47], v[168:171], v[76:79], v[44:47]
  ds_read_b64_tr_b16 v[190:191], v124 offset:13920
  s_waitcnt lgkmcnt(8)
  v_mfma_f32_16x16x32_bf16 v[48:51], v[172:175], v[72:75], v[48:51]
  ds_read_b64_tr_b16 v[192:193], v124 offset:9344
  v_mfma_f32_16x16x32_bf16 v[52:55], v[172:175], v[76:79], v[52:55]
  ds_read_b64_tr_b16 v[194:195], v124 offset:13952
  ds_read_b64_tr_b16 v[196:197], v124 offset:9360
  ds_read_b64_tr_b16 v[198:199], v124 offset:13968
  ds_read_b64_tr_b16 v[200:201], v124 offset:9392
  ds_read_b64_tr_b16 v[202:203], v124 offset:14000
  ds_read_b64_tr_b16 v[204:205], v124 offset:9424
  ds_read_b64_tr_b16 v[206:207], v124 offset:14032
  ds_read_b64_tr_b16 v[208:209], v124 offset:9456
  ds_read_b64_tr_b16 v[210:211], v124 offset:14064
  ds_read_b64_tr_b16 v[212:213], v124 offset:9488
  ds_read_b64_tr_b16 v[214:215], v124 offset:14096
  ds_read_b64_tr_b16 v[216:217], v124 offset:18432
  ds_read_b64_tr_b16 v[218:219], v124 offset:23040
  ds_read_b64_tr_b16 v[220:221], v124 offset:18464
  ds_read_b64_tr_b16 v[222:223], v124 offset:23072
  ds_read_b64_tr_b16 v[224:225], v124 offset:18496
  ds_read_b64_tr_b16 v[226:227], v124 offset:23104
  ds_read_b64_tr_b16 v[228:229], v124 offset:18528
  ds_read_b64_tr_b16 v[230:231], v124 offset:23136
  ds_read_b64_tr_b16 v[232:233], v124 offset:18560
  ds_read_b64_tr_b16 v[234:235], v124 offset:23168
  ds_read_b64_tr_b16 v[236:237], v124 offset:18576
  ds_read_b64_tr_b16 v[238:239], v124 offset:23184
  ds_read_b64_tr_b16 v[240:241], v124 offset:18608
  ds_read_b64_tr_b16 v[242:243], v124 offset:23216
  ds_read_b64_tr_b16 v[244:245], v124 offset:18640
  ds_read_b64_tr_b16 v[246:247], v124 offset:23248
  ds_read_b64_tr_b16 v[248:249], v124 offset:18672
  ds_read_b64_tr_b16 v[250:251], v124 offset:23280
  ds_read_b64_tr_b16 v[252:253], v124 offset:18704
  ds_read_b64_tr_b16 v[254:255], v124 offset:23312
  ds_read_b64_tr_b16 v[136:137], v124 offset:27648
  ds_read_b64_tr_b16 v[138:139], v124 offset:32256
  ds_read_b64_tr_b16 v[140:141], v124 offset:27680
  ds_read_b64_tr_b16 v[142:143], v124 offset:32288
  ds_read_b64_tr_b16 v[144:145], v124 offset:27712
  ds_read_b64_tr_b16 v[146:147], v124 offset:32320
  ds_read_b64_tr_b16 v[148:149], v124 offset:27744
  ds_read_b64_tr_b16 v[150:151], v124 offset:32352
  ds_read_b64_tr_b16 v[152:153], v124 offset:27776
  ds_read_b64_tr_b16 v[154:155], v124 offset:32384
  ds_read_b64_tr_b16 v[156:157], v124 offset:27792
  ds_read_b64_tr_b16 v[158:159], v124 offset:32400
  ds_read_b64_tr_b16 v[160:161], v124 offset:27824
  ds_read_b64_tr_b16 v[162:163], v124 offset:32432
  ds_read_b64_tr_b16 v[164:165], v124 offset:27856
  ds_read_b64_tr_b16 v[166:167], v124 offset:32464
  ds_read_b64_tr_b16 v[168:169], v124 offset:27888
  ds_read_b64_tr_b16 v[170:171], v124 offset:32496
  ds_read_b64_tr_b16 v[172:173], v124 offset:27920
  ds_read_b64_tr_b16 v[174:175], v124 offset:32528
  s_waitcnt lgkmcnt(0)
  s_barrier
  ds_read_b128 v[80:83], v126 offset:0
  ds_read_b128 v[84:87], v126 offset:2048
  ds_read_b128 v[88:91], v126 offset:1024
  ds_read_b128 v[92:95], v126 offset:3072
  s_waitcnt lgkmcnt(3)
  v_mfma_f32_16x16x32_bf16 v[16:19], v[176:179], v[80:83], v[16:19]
  s_waitcnt lgkmcnt(2)
  v_mfma_f32_16x16x32_bf16 v[20:23], v[176:179], v[84:87], v[20:23]
  ds_read_b64_tr_b16 v[176:177], v124 offset:36864
  v_mfma_f32_16x16x32_bf16 v[24:27], v[180:183], v[80:83], v[24:27]
  ds_read_b64_tr_b16 v[178:179], v124 offset:41472
  v_mfma_f32_16x16x32_bf16 v[28:31], v[180:183], v[84:87], v[28:31]
  ds_read_b64_tr_b16 v[180:181], v124 offset:36896
  v_mfma_f32_16x16x32_bf16 v[32:35], v[184:187], v[80:83], v[32:35]
  ds_read_b64_tr_b16 v[182:183], v124 offset:41504
  v_mfma_f32_16x16x32_bf16 v[36:39], v[184:187], v[84:87], v[36:39]
  ds_read_b64_tr_b16 v[184:185], v124 offset:36928
  v_mfma_f32_16x16x32_bf16 v[40:43], v[188:191], v[80:83], v[40:43]
  s_waitcnt lgkmcnt(5)
  s_barrier
  v_mfma_f32_16x16x32_bf16 v[44:47], v[188:191], v[84:87], v[44:47]
  ds_read_b128 v[96:99], v126 offset:16384
  v_mfma_f32_16x16x32_bf16 v[48:51], v[192:195], v[80:83], v[48:51]
  ds_read_b128 v[100:103], v126 offset:18432
  v_mfma_f32_16x16x32_bf16 v[52:55], v[192:195], v[84:87], v[52:55]
  ds_read_b64_tr_b16 v[186:187], v124 offset:41536
  v_mfma_f32_16x16x32_bf16 v[16:19], v[196:199], v[88:91], v[16:19]
  ds_read_b64_tr_b16 v[188:189], v124 offset:36960
  v_mfma_f32_16x16x32_bf16 v[20:23], v[196:199], v[92:95], v[20:23]
  ds_read_b64_tr_b16 v[190:191], v124 offset:41568
  v_mfma_f32_16x16x32_bf16 v[24:27], v[200:203], v[88:91], v[24:27]
  ds_read_b64_tr_b16 v[192:193], v124 offset:36992
  v_mfma_f32_16x16x32_bf16 v[28:31], v[200:203], v[92:95], v[28:31]
  ds_read_b64_tr_b16 v[194:195], v124 offset:41600
  v_mfma_f32_16x16x32_bf16 v[32:35], v[204:207], v[88:91], v[32:35]
  ds_read_b64_tr_b16 v[196:197], v124 offset:37008
  v_mfma_f32_16x16x32_bf16 v[36:39], v[204:207], v[92:95], v[36:39]
  ds_read_b64_tr_b16 v[198:199], v124 offset:41616
  v_mfma_f32_16x16x32_bf16 v[40:43], v[208:211], v[88:91], v[40:43]
  ds_read_b128 v[104:107], v126 offset:17408
  v_mfma_f32_16x16x32_bf16 v[44:47], v[208:211], v[92:95], v[44:47]
  ds_read_b128 v[108:111], v126 offset:19456
  v_mfma_f32_16x16x32_bf16 v[48:51], v[212:215], v[88:91], v[48:51]
  ds_read_b64_tr_b16 v[200:201], v124 offset:37040
  v_mfma_f32_16x16x32_bf16 v[52:55], v[212:215], v[92:95], v[52:55]
  ds_read_b64_tr_b16 v[202:203], v124 offset:41648
  s_waitcnt lgkmcnt(12)
  v_mfma_f32_16x16x32_bf16 v[16:19], v[216:219], v[96:99], v[16:19]
  ds_read_b64_tr_b16 v[204:205], v124 offset:37072
  s_waitcnt lgkmcnt(12)
  v_mfma_f32_16x16x32_bf16 v[20:23], v[216:219], v[100:103], v[20:23]
  ds_read_b64_tr_b16 v[206:207], v124 offset:41680
  v_mfma_f32_16x16x32_bf16 v[24:27], v[220:223], v[96:99], v[24:27]
  ds_read_b64_tr_b16 v[208:209], v124 offset:37104
  v_mfma_f32_16x16x32_bf16 v[28:31], v[220:223], v[100:103], v[28:31]
  ds_read_b64_tr_b16 v[210:211], v124 offset:41712
  v_mfma_f32_16x16x32_bf16 v[32:35], v[224:227], v[96:99], v[32:35]
  ds_read_b64_tr_b16 v[212:213], v124 offset:37136
  v_mfma_f32_16x16x32_bf16 v[36:39], v[224:227], v[100:103], v[36:39]
  ds_read_b64_tr_b16 v[214:215], v124 offset:41744
  v_mfma_f32_16x16x32_bf16 v[40:43], v[228:231], v[96:99], v[40:43]
  s_waitcnt lgkmcnt(8)
  s_barrier
  v_mfma_f32_16x16x32_bf16 v[44:47], v[228:231], v[100:103], v[44:47]
  ds_read_b128 v[80:83], v126 offset:32768
  v_mfma_f32_16x16x32_bf16 v[48:51], v[232:235], v[96:99], v[48:51]
  ds_read_b128 v[84:87], v126 offset:34816
  v_mfma_f32_16x16x32_bf16 v[52:55], v[232:235], v[100:103], v[52:55]
  ds_read_b64_tr_b16 v[216:217], v124 offset:46080
  v_mfma_f32_16x16x32_bf16 v[16:19], v[236:239], v[104:107], v[16:19]
  ds_read_b64_tr_b16 v[218:219], v124 offset:50688
  v_mfma_f32_16x16x32_bf16 v[20:23], v[236:239], v[108:111], v[20:23]
  ds_read_b64_tr_b16 v[220:221], v124 offset:46112
  v_mfma_f32_16x16x32_bf16 v[24:27], v[240:243], v[104:107], v[24:27]
  ds_read_b64_tr_b16 v[222:223], v124 offset:50720
  v_mfma_f32_16x16x32_bf16 v[28:31], v[240:243], v[108:111], v[28:31]
  ds_read_b64_tr_b16 v[224:225], v124 offset:46144
  v_mfma_f32_16x16x32_bf16 v[32:35], v[244:247], v[104:107], v[32:35]
  ds_read_b64_tr_b16 v[226:227], v124 offset:50752
  v_mfma_f32_16x16x32_bf16 v[36:39], v[244:247], v[108:111], v[36:39]
  ds_read_b64_tr_b16 v[228:229], v124 offset:46176
  v_mfma_f32_16x16x32_bf16 v[40:43], v[248:251], v[104:107], v[40:43]
  ds_read_b128 v[88:91], v126 offset:33792
  v_mfma_f32_16x16x32_bf16 v[44:47], v[248:251], v[108:111], v[44:47]
  ds_read_b128 v[92:95], v126 offset:35840
  v_mfma_f32_16x16x32_bf16 v[48:51], v[252:255], v[104:107], v[48:51]
  ds_read_b64_tr_b16 v[230:231], v124 offset:50784
  v_mfma_f32_16x16x32_bf16 v[52:55], v[252:255], v[108:111], v[52:55]
  ds_read_b64_tr_b16 v[232:233], v124 offset:46208
  s_waitcnt lgkmcnt(12)
  v_mfma_f32_16x16x32_bf16 v[16:19], v[136:139], v[80:83], v[16:19]
  ds_read_b64_tr_b16 v[234:235], v124 offset:50816
  s_waitcnt lgkmcnt(12)
  v_mfma_f32_16x16x32_bf16 v[20:23], v[136:139], v[84:87], v[20:23]
  ds_read_b64_tr_b16 v[236:237], v124 offset:46224
  v_mfma_f32_16x16x32_bf16 v[24:27], v[140:143], v[80:83], v[24:27]
  ds_read_b64_tr_b16 v[238:239], v124 offset:50832
  v_mfma_f32_16x16x32_bf16 v[28:31], v[140:143], v[84:87], v[28:31]
  ds_read_b64_tr_b16 v[240:241], v124 offset:46256
  v_mfma_f32_16x16x32_bf16 v[32:35], v[144:147], v[80:83], v[32:35]
  ds_read_b64_tr_b16 v[242:243], v124 offset:50864
  v_mfma_f32_16x16x32_bf16 v[36:39], v[144:147], v[84:87], v[36:39]
  ds_read_b64_tr_b16 v[244:245], v124 offset:46288
  v_mfma_f32_16x16x32_bf16 v[40:43], v[148:151], v[80:83], v[40:43]
  s_waitcnt lgkmcnt(8)
  s_barrier
  v_mfma_f32_16x16x32_bf16 v[44:47], v[148:151], v[84:87], v[44:47]
  ds_read_b128 v[96:99], v127 offset:56320
  v_mfma_f32_16x16x32_bf16 v[48:51], v[152:155], v[80:83], v[48:51]
  ds_read_b128 v[100:103], v127 offset:58368
  v_mfma_f32_16x16x32_bf16 v[52:55], v[152:155], v[84:87], v[52:55]
  ds_read_b64_tr_b16 v[246:247], v124 offset:50896
  v_mfma_f32_16x16x32_bf16 v[16:19], v[156:159], v[88:91], v[16:19]
  ds_read_b64_tr_b16 v[248:249], v124 offset:46320
  v_mfma_f32_16x16x32_bf16 v[20:23], v[156:159], v[92:95], v[20:23]
  ds_read_b64_tr_b16 v[250:251], v124 offset:50928
  v_mfma_f32_16x16x32_bf16 v[24:27], v[160:163], v[88:91], v[24:27]
  ds_read_b64_tr_b16 v[252:253], v124 offset:46352
  v_mfma_f32_16x16x32_bf16 v[28:31], v[160:163], v[92:95], v[28:31]
  ds_read_b64_tr_b16 v[254:255], v124 offset:50960
  v_mfma_f32_16x16x32_bf16 v[32:35], v[164:167], v[88:91], v[32:35]
  ds_read_b64_tr_b16 v[136:137], v3 offset:0
  v_mfma_f32_16x16x32_bf16 v[36:39], v[164:167], v[92:95], v[36:39]
  ds_read_b64_tr_b16 v[138:139], v3 offset:4608
  v_mfma_f32_16x16x32_bf16 v[40:43], v[168:171], v[88:91], v[40:43]
  ds_read_b128 v[104:107], v127 offset:57344
  v_mfma_f32_16x16x32_bf16 v[44:47], v[168:171], v[92:95], v[44:47]
  ds_read_b128 v[108:111], v127 offset:59392
  v_mfma_f32_16x16x32_bf16 v[48:51], v[172:175], v[88:91], v[48:51]
  ds_read_b64_tr_b16 v[140:141], v3 offset:32
  v_mfma_f32_16x16x32_bf16 v[52:55], v[172:175], v[92:95], v[52:55]
  ds_read_b64_tr_b16 v[142:143], v3 offset:4640
  s_waitcnt lgkmcnt(12)
  v_mfma_f32_16x16x32_bf16 v[16:19], v[176:179], v[96:99], v[16:19]
  ds_read_b64_tr_b16 v[144:145], v3 offset:64
  s_waitcnt lgkmcnt(12)
  v_mfma_f32_16x16x32_bf16 v[20:23], v[176:179], v[100:103], v[20:23]
  ds_read_b64_tr_b16 v[146:147], v3 offset:4672
  v_mfma_f32_16x16x32_bf16 v[24:27], v[180:183], v[96:99], v[24:27]
  ds_read_b64_tr_b16 v[148:149], v3 offset:96
  v_mfma_f32_16x16x32_bf16 v[28:31], v[180:183], v[100:103], v[28:31]
  ds_read_b64_tr_b16 v[150:151], v3 offset:4704
  v_mfma_f32_16x16x32_bf16 v[32:35], v[184:187], v[96:99], v[32:35]
  ds_read_b64_tr_b16 v[152:153], v3 offset:128
  v_mfma_f32_16x16x32_bf16 v[36:39], v[184:187], v[100:103], v[36:39]
  ds_read_b64_tr_b16 v[154:155], v3 offset:4736
  v_mfma_f32_16x16x32_bf16 v[40:43], v[188:191], v[96:99], v[40:43]
  s_waitcnt lgkmcnt(8)
  s_barrier
  v_mfma_f32_16x16x32_bf16 v[44:47], v[188:191], v[100:103], v[44:47]
  ds_read_b128 v[80:83], v127 offset:0
  v_mfma_f32_16x16x32_bf16 v[48:51], v[192:195], v[96:99], v[48:51]
  ds_read_b128 v[84:87], v127 offset:2048
  v_mfma_f32_16x16x32_bf16 v[52:55], v[192:195], v[100:103], v[52:55]
  ds_read_b64_tr_b16 v[156:157], v3 offset:144
  v_mfma_f32_16x16x32_bf16 v[16:19], v[196:199], v[104:107], v[16:19]
  ds_read_b64_tr_b16 v[158:159], v3 offset:4752
  v_mfma_f32_16x16x32_bf16 v[20:23], v[196:199], v[108:111], v[20:23]
  ds_read_b64_tr_b16 v[160:161], v3 offset:176
  v_mfma_f32_16x16x32_bf16 v[24:27], v[200:203], v[104:107], v[24:27]
  ds_read_b64_tr_b16 v[162:163], v3 offset:4784
  v_mfma_f32_16x16x32_bf16 v[28:31], v[200:203], v[108:111], v[28:31]
  ds_read_b64_tr_b16 v[164:165], v3 offset:208
  v_mfma_f32_16x16x32_bf16 v[32:35], v[204:207], v[104:107], v[32:35]
  ds_read_b64_tr_b16 v[166:167], v3 offset:4816
  v_mfma_f32_16x16x32_bf16 v[36:39], v[204:207], v[108:111], v[36:39]
  ds_read_b64_tr_b16 v[168:169], v3 offset:240
  v_mfma_f32_16x16x32_bf16 v[40:43], v[208:211], v[104:107], v[40:43]
  ds_read_b128 v[88:91], v127 offset:1024
  v_mfma_f32_16x16x32_bf16 v[44:47], v[208:211], v[108:111], v[44:47]
  ds_read_b128 v[92:95], v127 offset:3072
  v_mfma_f32_16x16x32_bf16 v[48:51], v[212:215], v[104:107], v[48:51]
  ds_read_b64_tr_b16 v[170:171], v3 offset:4848
  v_mfma_f32_16x16x32_bf16 v[52:55], v[212:215], v[108:111], v[52:55]
  ds_read_b64_tr_b16 v[172:173], v3 offset:272
  s_waitcnt lgkmcnt(12)
  v_mfma_f32_16x16x32_bf16 v[16:19], v[216:219], v[80:83], v[16:19]
  ds_read_b64_tr_b16 v[174:175], v3 offset:4880
  s_waitcnt lgkmcnt(12)
  v_mfma_f32_16x16x32_bf16 v[20:23], v[216:219], v[84:87], v[20:23]
  ds_read_b64_tr_b16 v[176:177], v3 offset:9216
  v_mfma_f32_16x16x32_bf16 v[24:27], v[220:223], v[80:83], v[24:27]
  ds_read_b64_tr_b16 v[178:179], v3 offset:13824
  v_mfma_f32_16x16x32_bf16 v[28:31], v[220:223], v[84:87], v[28:31]
  ds_read_b64_tr_b16 v[180:181], v3 offset:9248
  v_mfma_f32_16x16x32_bf16 v[32:35], v[224:227], v[80:83], v[32:35]
  ds_read_b64_tr_b16 v[182:183], v3 offset:13856
  v_mfma_f32_16x16x32_bf16 v[36:39], v[224:227], v[84:87], v[36:39]
  ds_read_b64_tr_b16 v[184:185], v3 offset:9280
  v_mfma_f32_16x16x32_bf16 v[40:43], v[228:231], v[80:83], v[40:43]
  s_waitcnt lgkmcnt(8)
  s_barrier
  v_mfma_f32_16x16x32_bf16 v[44:47], v[228:231], v[84:87], v[44:47]
  ds_read_b128 v[96:99], v127 offset:16384
  v_mfma_f32_16x16x32_bf16 v[48:51], v[232:235], v[80:83], v[48:51]
  ds_read_b128 v[100:103], v127 offset:18432
  v_mfma_f32_16x16x32_bf16 v[52:55], v[232:235], v[84:87], v[52:55]
  ds_read_b64_tr_b16 v[186:187], v3 offset:13888
  v_mfma_f32_16x16x32_bf16 v[16:19], v[236:239], v[88:91], v[16:19]
  ds_read_b64_tr_b16 v[188:189], v3 offset:9312
  v_mfma_f32_16x16x32_bf16 v[20:23], v[236:239], v[92:95], v[20:23]
  ds_read_b64_tr_b16 v[190:191], v3 offset:13920
  v_mfma_f32_16x16x32_bf16 v[24:27], v[240:243], v[88:91], v[24:27]
  ds_read_b64_tr_b16 v[192:193], v3 offset:9344
  v_mfma_f32_16x16x32_bf16 v[28:31], v[240:243], v[92:95], v[28:31]
  ds_read_b64_tr_b16 v[194:195], v3 offset:13952
  v_mfma_f32_16x16x32_bf16 v[32:35], v[244:247], v[88:91], v[32:35]
  ds_read_b64_tr_b16 v[196:197], v3 offset:9360
  v_mfma_f32_16x16x32_bf16 v[36:39], v[244:247], v[92:95], v[36:39]
  ds_read_b64_tr_b16 v[198:199], v3 offset:13968
  v_mfma_f32_16x16x32_bf16 v[40:43], v[248:251], v[88:91], v[40:43]
  ds_read_b128 v[104:107], v127 offset:17408
  v_mfma_f32_16x16x32_bf16 v[44:47], v[248:251], v[92:95], v[44:47]
  ds_read_b128 v[108:111], v127 offset:19456
  v_mfma_f32_16x16x32_bf16 v[48:51], v[252:255], v[88:91], v[48:51]
  ds_read_b64_tr_b16 v[200:201], v3 offset:9392
  v_mfma_f32_16x16x32_bf16 v[52:55], v[252:255], v[92:95], v[52:55]
  ds_read_b64_tr_b16 v[202:203], v3 offset:14000
  s_waitcnt lgkmcnt(12)
  v_mfma_f32_16x16x32_bf16 v[16:19], v[136:139], v[96:99], v[16:19]
  ds_read_b64_tr_b16 v[204:205], v3 offset:9424
  s_waitcnt lgkmcnt(12)
  v_mfma_f32_16x16x32_bf16 v[20:23], v[136:139], v[100:103], v[20:23]
  ds_read_b64_tr_b16 v[206:207], v3 offset:14032
  v_mfma_f32_16x16x32_bf16 v[24:27], v[140:143], v[96:99], v[24:27]
  ds_read_b64_tr_b16 v[208:209], v3 offset:9456
  v_mfma_f32_16x16x32_bf16 v[28:31], v[140:143], v[100:103], v[28:31]
  ds_read_b64_tr_b16 v[210:211], v3 offset:14064
  v_mfma_f32_16x16x32_bf16 v[32:35], v[144:147], v[96:99], v[32:35]
  ds_read_b64_tr_b16 v[212:213], v3 offset:9488
  v_mfma_f32_16x16x32_bf16 v[36:39], v[144:147], v[100:103], v[36:39]
  ds_read_b64_tr_b16 v[214:215], v3 offset:14096
  v_mfma_f32_16x16x32_bf16 v[40:43], v[148:151], v[96:99], v[40:43]
  s_waitcnt lgkmcnt(8)
  s_barrier
  v_mfma_f32_16x16x32_bf16 v[44:47], v[148:151], v[100:103], v[44:47]
  ds_read_b128 v[80:83], v126 offset:0
  v_mfma_f32_16x16x32_bf16 v[48:51], v[152:155], v[96:99], v[48:51]
  ds_read_b64_tr_b16 v[216:217], v3 offset:18432
  v_mfma_f32_16x16x32_bf16 v[52:55], v[152:155], v[100:103], v[52:55]
  ds_read_b64_tr_b16 v[218:219], v3 offset:23040
  v_mfma_f32_16x16x32_bf16 v[16:19], v[156:159], v[104:107], v[16:19]
  ds_read_b64_tr_b16 v[220:221], v3 offset:18464
  v_mfma_f32_16x16x32_bf16 v[20:23], v[156:159], v[108:111], v[20:23]
  ds_read_b128 v[84:87], v126 offset:1024
  v_mfma_f32_16x16x32_bf16 v[24:27], v[160:163], v[104:107], v[24:27]
  ds_read_b64_tr_b16 v[222:223], v3 offset:23072
  v_mfma_f32_16x16x32_bf16 v[28:31], v[160:163], v[108:111], v[28:31]
  ds_read_b64_tr_b16 v[224:225], v3 offset:18496
  v_mfma_f32_16x16x32_bf16 v[32:35], v[164:167], v[104:107], v[32:35]
  ds_read_b64_tr_b16 v[226:227], v3 offset:23104
  v_mfma_f32_16x16x32_bf16 v[36:39], v[164:167], v[108:111], v[36:39]
  ds_read_b64_tr_b16 v[228:229], v3 offset:18528
  v_mfma_f32_16x16x32_bf16 v[40:43], v[168:171], v[104:107], v[40:43]
  s_waitcnt lgkmcnt(4)
  s_barrier
  v_mfma_f32_16x16x32_bf16 v[44:47], v[168:171], v[108:111], v[44:47]
  ds_read_b128 v[88:91], v126 offset:16384
  v_mfma_f32_16x16x32_bf16 v[48:51], v[172:175], v[104:107], v[48:51]
  ds_read_b64_tr_b16 v[230:231], v3 offset:23136
  v_mfma_f32_16x16x32_bf16 v[52:55], v[172:175], v[108:111], v[52:55]
  ds_read_b64_tr_b16 v[232:233], v3 offset:18560
  v_mfma_f32_16x16x32_bf16 v[16:19], v[176:179], v[80:83], v[16:19]
  ds_read_b64_tr_b16 v[234:235], v3 offset:23168
  v_mfma_f32_16x16x32_bf16 v[24:27], v[180:183], v[80:83], v[24:27]
  ds_read_b128 v[92:95], v126 offset:17408
  v_mfma_f32_16x16x32_bf16 v[32:35], v[184:187], v[80:83], v[32:35]
  ds_read_b64_tr_b16 v[236:237], v3 offset:18576
  v_mfma_f32_16x16x32_bf16 v[40:43], v[188:191], v[80:83], v[40:43]
  ds_read_b64_tr_b16 v[238:239], v3 offset:23184
  v_mfma_f32_16x16x32_bf16 v[48:51], v[192:195], v[80:83], v[48:51]
  ds_read_b64_tr_b16 v[240:241], v3 offset:18608
  v_mfma_f32_16x16x32_bf16 v[16:19], v[196:199], v[84:87], v[16:19]
  ds_read_b64_tr_b16 v[242:243], v3 offset:23216
  v_mfma_f32_16x16x32_bf16 v[24:27], v[200:203], v[84:87], v[24:27]
  ds_read_b128 v[96:99], v126 offset:2048
  v_mfma_f32_16x16x32_bf16 v[32:35], v[204:207], v[84:87], v[32:35]
  ds_read_b64_tr_b16 v[244:245], v3 offset:18640
  v_mfma_f32_16x16x32_bf16 v[40:43], v[208:211], v[84:87], v[40:43]
  ds_read_b64_tr_b16 v[246:247], v3 offset:23248
  v_mfma_f32_16x16x32_bf16 v[48:51], v[212:215], v[84:87], v[48:51]
  ds_read_b64_tr_b16 v[248:249], v3 offset:18672
  s_waitcnt lgkmcnt(12)
  v_mfma_f32_16x16x32_bf16 v[16:19], v[216:219], v[88:91], v[16:19]
  ds_read_b64_tr_b16 v[250:251], v3 offset:23280
  v_mfma_f32_16x16x32_bf16 v[24:27], v[220:223], v[88:91], v[24:27]
  ds_read_b128 v[100:103], v126 offset:3072
  v_mfma_f32_16x16x32_bf16 v[32:35], v[224:227], v[88:91], v[32:35]
  ds_read_b64_tr_b16 v[252:253], v3 offset:18704
  s_waitcnt lgkmcnt(14)
  v_mfma_f32_16x16x32_bf16 v[40:43], v[228:231], v[88:91], v[40:43]
  ds_read_b64_tr_b16 v[254:255], v3 offset:23312
  s_waitcnt lgkmcnt(13)
  v_mfma_f32_16x16x32_bf16 v[48:51], v[232:235], v[88:91], v[48:51]
  s_waitcnt lgkmcnt(10)
  v_mfma_f32_16x16x32_bf16 v[16:19], v[236:239], v[92:95], v[16:19]
  s_waitcnt lgkmcnt(8)
  v_mfma_f32_16x16x32_bf16 v[24:27], v[240:243], v[92:95], v[24:27]
  ds_read_b128 v[104:107], v126 offset:18432
  s_waitcnt lgkmcnt(6)
  v_mfma_f32_16x16x32_bf16 v[32:35], v[244:247], v[92:95], v[32:35]
  s_waitcnt lgkmcnt(4)
  v_mfma_f32_16x16x32_bf16 v[40:43], v[248:251], v[92:95], v[40:43]
  s_waitcnt lgkmcnt(1)
  v_mfma_f32_16x16x32_bf16 v[48:51], v[252:255], v[92:95], v[48:51]
  v_mfma_f32_16x16x32_bf16 v[20:23], v[176:179], v[96:99], v[20:23]
  v_mfma_f32_16x16x32_bf16 v[28:31], v[180:183], v[96:99], v[28:31]
  ds_read_b128 v[108:111], v126 offset:19456
  v_mfma_f32_16x16x32_bf16 v[36:39], v[184:187], v[96:99], v[36:39]
  v_mfma_f32_16x16x32_bf16 v[44:47], v[188:191], v[96:99], v[44:47]
  v_mfma_f32_16x16x32_bf16 v[52:55], v[192:195], v[96:99], v[52:55]
  v_cvt_pk_bf16_f32 v16, v16, v17
  v_cvt_pk_bf16_f32 v17, v18, v19
  v_mfma_f32_16x16x32_bf16 v[20:23], v[196:199], v[100:103], v[20:23]
  ds_write_b64 v118, v[16:17] offset:0
  v_cvt_pk_bf16_f32 v24, v24, v25
  v_mfma_f32_16x16x32_bf16 v[28:31], v[200:203], v[100:103], v[28:31]
  v_cvt_pk_bf16_f32 v25, v26, v27
  ds_write_b64 v118, v[24:25] offset:32
  v_mfma_f32_16x16x32_bf16 v[36:39], v[204:207], v[100:103], v[36:39]
  v_cvt_pk_bf16_f32 v32, v32, v33
  v_cvt_pk_bf16_f32 v33, v34, v35
  v_mfma_f32_16x16x32_bf16 v[44:47], v[208:211], v[100:103], v[44:47]
  ds_write_b64 v118, v[32:33] offset:64
  v_cvt_pk_bf16_f32 v40, v40, v41
  v_mfma_f32_16x16x32_bf16 v[52:55], v[212:215], v[100:103], v[52:55]
  v_cvt_pk_bf16_f32 v41, v42, v43
  ds_write_b64 v118, v[40:41] offset:96
  s_waitcnt lgkmcnt(5)
  v_mfma_f32_16x16x32_bf16 v[20:23], v[216:219], v[104:107], v[20:23]
  v_cvt_pk_bf16_f32 v48, v48, v49
  v_cvt_pk_bf16_f32 v49, v50, v51
  v_mfma_f32_16x16x32_bf16 v[28:31], v[220:223], v[104:107], v[28:31]
  s_mov_b32 exec_hi, 0
  ds_write_b64 v118, v[48:49] offset:128
  s_mov_b32 exec_hi, -1
  s_waitcnt lgkmcnt(0)
  v_mfma_f32_16x16x32_bf16 v[36:39], v[224:227], v[104:107], v[36:39]
  ds_read_b128 v[56:59], v125 offset:0
  ds_read_b128 v[60:63], v125 offset:1024
  v_mfma_f32_16x16x32_bf16 v[44:47], v[228:231], v[104:107], v[44:47]
  v_mfma_f32_16x16x32_bf16 v[52:55], v[232:235], v[104:107], v[52:55]
  v_mfma_f32_16x16x32_bf16 v[20:23], v[236:239], v[108:111], v[20:23]
  v_mfma_f32_16x16x32_bf16 v[28:31], v[240:243], v[108:111], v[28:31]
  v_mfma_f32_16x16x32_bf16 v[36:39], v[244:247], v[108:111], v[36:39]
  v_mfma_f32_16x16x32_bf16 v[44:47], v[248:251], v[108:111], v[44:47]
  v_mfma_f32_16x16x32_bf16 v[52:55], v[252:255], v[108:111], v[52:55]
  s_barrier
  s_waitcnt lgkmcnt(1)
  buffer_store_dwordx4 v[56:59], v119, s[48:51], s11 offen
  s_waitcnt lgkmcnt(0)
  buffer_store_dwordx4 v[60:63], v120, s[48:51], s11 offen
  v_cvt_pk_bf16_f32 v20, v20, v21
  v_cvt_pk_bf16_f32 v21, v22, v23
  ds_write_b64 v118, v[20:21] offset:2304
  v_cvt_pk_bf16_f32 v28, v28, v29
  v_cvt_pk_bf16_f32 v29, v30, v31
  ds_write_b64 v118, v[28:29] offset:2336
  v_cvt_pk_bf16_f32 v36, v36, v37
  v_cvt_pk_bf16_f32 v37, v38, v39
  ds_write_b64 v118, v[36:37] offset:2368
  v_cvt_pk_bf16_f32 v44, v44, v45
  v_cvt_pk_bf16_f32 v45, v46, v47
  ds_write_b64 v118, v[44:45] offset:2400
  v_cvt_pk_bf16_f32 v52, v52, v53
  v_cvt_pk_bf16_f32 v53, v54, v55
  s_mov_b32 exec_hi, 0
  ds_write_b64 v118, v[52:53] offset:2432
  s_mov_b32 exec_hi, -1
  s_waitcnt lgkmcnt(0)
  ds_read_b128 v[64:67], v125 offset:2048
  ds_read_b128 v[68:71], v125 offset:3072
  ds_read_b128 v[72:75], v125 offset:4096
  s_waitcnt lgkmcnt(2)
  buffer_store_dwordx4 v[64:67], v121, s[48:51], s11 offen
  s_waitcnt lgkmcnt(1)
  buffer_store_dwordx4 v[68:71], v122, s[48:51], s11 offen
  s_mov_b32 exec_hi, 0
  s_waitcnt lgkmcnt(0)
  buffer_store_dwordx4 v[72:75], v123, s[48:51], s11 offen
  s_endpgm
  s_nop 0
L_HB:
  s_mov_b32 s56, s26
  s_mov_b32 s57, s27
  s_mov_b32 s58, 20736
  s_mov_b32 s59, 0x20000
  s_lshl_b32 s13, s8, 10
  s_add_u32 m0, s13, 139264
  s_mul_i32 s14, s6, 2592
  s_add_u32 s14, s14, s13
  s_cmp_eq_u32 s8, 3
  s_cselect_b32 s14, 1073741824, s14
  buffer_load_dwordx4 v18, s[56:59], s14 offen lds
  s_mov_b64 s[0:1], s[30:31]
  s_mov_b32 s52, s34
  s_mov_b32 s53, s35
  s_mov_b32 s54, 0x2000000
  s_mov_b32 s55, 0x20000
  s_mov_b32 s60, s32
  s_mov_b32 s61, s33
  s_mov_b32 s62, 256
  s_mov_b32 s63, 0x20000
  s_lshl_b32 s14, s4, 3
  s_add_u32 s14, s14, s6
  s_mul_i32 s26, s14, 90112
  s_mul_i32 s27, s5, 5632
  s_add_u32 s27, s27, s26
  s_lshl2_add_u32 s13, s5, s8
  s_mul_i32 s28, s13, 73728
  s_mul_i32 s13, s4, 1152
  s_add_u32 s28, s28, s13
  s_mov_b64 s[70:71], 0xffff
  s_mov_b32 s76, 1069066811
  s_mov_b32 s77, 1069066811
  s_mov_b32 s78, 897988541
  s_lshl_b32 s29, s6, 7
  s_add_u32 s29, s29, s28
  s_mul_i32 s30, s6, 4608
  s_add_u32 s30, s30, s28
  s_add_u32 s30, s30, 1024
  s_mov_b32 s31, 0
  s_mov_b32 s46, 663552
  s_mov_b32 s47, 0x20000
  v_mov_b32 v48, -1
  v_mov_b32 v49, -1
  v_mov_b32 v50, -1
  v_mov_b32 v51, -1
  s_setprio 2
  v_lshrrev_b32 v16, 4, v0
  v_and_b32 v17, 15, v0
  v_mov_b32 v46, 2147483392
  v_mul_u32_u24 v41, 3641, v0
  v_lshrrev_b32 v41, 16, v41
  v_mul_u32_u24 v42, 18, v41
  v_sub_u32 v42, v0, v42
  v_cmp_le_u32 s[72:73], 9, v42
  v_lshlrev_b32 v42, 4, v42
  v_and_b32 v43, 4, v41
  v_add_u32 v43, v43, v41
  v_mul_u32_u24 v44, 3456, v43
  v_add_u32 v44, v44, v42
  v_add_u32 v45, 110448, v44
  v_cndmask_b32 v7, v44, v45, s[72:73]
  v_mul_u32_u24 v44, 1152, v43
  v_add_u32 v44, v44, v42
  v_add_u32 v45, 41328, v44
  v_cndmask_b32 v10, v44, v45, s[72:73]
  v_lshrrev_b32 v43, 2, v41
  v_mul_u32_u24 v43, 72, v43
  v_bfe_u32 v44, v41, 1, 1
  v_mul_u32_u24 v44, 18, v44
  v_and_b32 v45, 1, v41
  v_add3_u32 v43, v43, v44, v45
  v_mul_u32_u24 v44, 1152, v43
  v_add_u32 v44, v44, v42
  v_add_u32 v45, 331632, v44
  v_cndmask_b32 v13, v44, v45, s[72:73]
  v_add_u32 v40, 64, v0
  v_mul_u32_u24 v41, 3641, v40
  v_lshrrev_b32 v41, 16, v41
  v_mul_u32_u24 v42, 18, v41
  v_sub_u32 v42, v40, v42
  v_cmp_le_u32 s[72:73], 9, v42
  v_lshlrev_b32 v42, 4, v42
  v_subrev_u32 v42, 1024, v42
  v_and_b32 v43, 4, v41
  v_add_u32 v43, v43, v41
  v_mul_u32_u24 v44, 3456, v43
  v_add_u32 v44, v44, v42
  v_add_u32 v45, 110448, v44
  v_cndmask_b32 v8, v44, v45, s[72:73]
  v_mul_u32_u24 v44, 1152, v43
  v_add_u32 v44, v44, v42
  v_add_u32 v45, 41328, v44
  v_cndmask_b32 v11, v44, v45, s[72:73]
  v_lshrrev_b32 v43, 2, v41
  v_mul_u32_u24 v43, 72, v43
  v_bfe_u32 v44, v41, 1, 1
  v_mul_u32_u24 v44, 18, v44
  v_and_b32 v45, 1, v41
  v_add3_u32 v43, v43, v44, v45
  v_mul_u32_u24 v44, 1152, v43
  v_add_u32 v44, v44, v42
  v_add_u32 v45, 331632, v44
  v_cndmask_b32 v14, v44, v45, s[72:73]
  v_add_u32 v40, 128, v0
  v_mul_u32_u24 v41, 3641, v40
  v_lshrrev_b32 v41, 16, v41
  s_add_u32 m0, s64, 0
  s_nop 0
  buffer_load_dwordx4 v1, s[36:39], s10 offen offset:0  lds
  v_mul_u32_u24 v42, 18, v41
  v_sub_u32 v42, v40, v42
  v_cmp_le_u32 s[72:73], 9, v42
  v_lshlrev_b32 v42, 4, v42
  v_subrev_u32 v42, 2048, v42
  v_and_b32 v43, 4, v41
  v_add_u32 v43, v43, v41
  v_mul_u32_u24 v44, 3456, v43
  v_add_u32 v44, v44, v42
  v_add_u32 v45, 110448, v44
  v_cndmask_b32 v9, v44, v45, s[72:73]
  v_mul_u32_u24 v44, 1152, v43
  v_add_u32 v44, v44, v42
  v_add_u32 v45, 41328, v44
  v_cndmask_b32 v12, v44, v45, s[72:73]
  v_lshrrev_b32 v43, 2, v41
  v_mul_u32_u24 v43, 72, v43
  v_bfe_u32 v44, v41, 1, 1
  v_mul_u32_u24 v44, 18, v44
  v_and_b32 v45, 1, v41
  v_add3_u32 v43, v43, v44, v45
  v_mul_u32_u24 v44, 1152, v43
  v_add_u32 v44, v44, v42
  v_add_u32 v45, 331632, v44
  v_cndmask_b32 v15, v44, v45, s[72:73]
  s_and_b32 s69, s8, 1
  s_lshl_b32 s66, s69, 4
  s_mul_i32 s67, s69, 18
  s_and_b32 s69, s8, 2
  s_lshl_b32 s69, s69, 1
  s_add_u32 s66, s66, s69
  s_add_u32 s67, s67, s69
  s_mul_i32 s66, s66, 3456
  s_mul_i32 s69, s6, 72
  s_add_u32 s67, s67, s69
  s_add_u32 s13, s10, 8192
  buffer_load_dwordx4 v1, s[36:39], s13 offen offset:1024  lds
  s_mul_i32 s67, s67, 1152
  s_lshl_b32 s69, s69, 1
  s_add_u32 s51, s66, s69
  s_add_u32 s67, s67, s69
  s_mul_i32 s69, s9, 221184
  s_add_u32 s66, s51, s69
  s_mul_i32 s68, s8, 2304
  v_and_b32 v40, 28, v0
  v_and_b32 v41, 2, v16
  v_add_u32 v40, v40, v41
  v_mul_u32_u24 v40, 440, v40
  v_add_u32 v40, 82944, v40
  v_and_b32 v41, 3, v0
  v_and_b32 v42, 1, v0
  s_mul_i32 s69, s8, 36
  s_and_b32 s3, s8, 1
  s_lshl_b32 s3, s3, 2
  s_sub_u32 s69, s69, s3
  s_add_u32 s69, s69, 288
  v_lshlrev_b32 v43, 3, v41
  v_add3_u32 v20, v40, v43, s69
  s_add_u32 s69, s69, 32
  v_mov_b32 v44, s69
  v_cmp_ne_u32 s[72:73], 0, v41
  v_mov_b32 v45, 432
  s_nop 0
  v_cndmask_b32 v44, v44, v45, s[72:73]
  v_add_u32 v21, v40, v44
  s_mul_i32 s69, s8, 72
  v_lshrrev_b32 v44, 1, v41
  v_mul_u32_u24 v44, 40, v44
  v_lshl_add_u32 v44, v42, 4, v44
  v_add3_u32 v44, v40, v44, s69
  s_and_b32 s3, s5, 1
  s_lshl_b32 s3, s3, 3
  v_add_u32 v19, s3, v44
  s_add_u32 s13, s10, 16384
  buffer_load_dwordx4 v1, s[36:39], s13 offen offset:2048  lds
  s_xor_b32 s3, s3, 8
  v_add_u32 v30, s3, v44
  v_add3_u32 v22, v40, 32, s69
  s_and_b32 s3, s8, 1
  s_lshl_b32 s3, s3, 1
  v_subrev_u32 v40, s3, v17
  v_add_u32 v41, 16, v40
  v_cmp_gt_u32 s[72:73], 18, v41
  v_cmp_gt_u32 s[74:75], 4, v17
  s_nop 0
  s_and_b64 s[72:73], s[72:73], s[74:75]
  v_cndmask_b32 v41, -1, v41, s[72:73]
  v_cmp_eq_u32 s[72:73], 4, v17
  v_mul_u32_u24 v43, 19, v16
  s_nop 0
  v_cndmask_b32 v41, v41, 18, s[72:73]
  v_cmp_gt_u32 s[72:73], 19, v40
  s_mul_i32 s69, s8, 1216
  v_add_u32 v44, v43, v40
  v_lshl_add_u32 v44, v44, 4, s69
  v_cndmask_b32 v23, v46, v44, s[72:73]
  s_and_b64 s[72:73], s[72:73], s[70:71]
  s_mul_i32 s69, s8, 152
  s_add_u32 s69, s69, 4864
  v_lshl_add_u32 v44, v40, 3, s69
  v_cndmask_b32 v24, v46, v44, s[72:73]
  v_cmp_gt_u32 s[72:73], 19, v41
  s_mul_i32 s69, s8, 1216
  v_add_u32 v44, v43, v41
  v_lshl_add_u32 v44, v44, 4, s69
  v_cndmask_b32 v25, v46, v44, s[72:73]
  s_and_b64 s[72:73], s[72:73], s[70:71]
  s_mul_i32 s69, s8, 152
  s_add_u32 s69, s69, 4864
  v_lshl_add_u32 v44, v41, 3, s69
  v_cndmask_b32 v26, v46, v44, s[72:73]
  s_and_b32 s3, s5, 1
  s_add_u32 s13, s10, 24576
  buffer_load_dwordx4 v1, s[36:39], s13 offen offset:3072  lds
  s_lshl_b32 s3, s3, 3
  v_xor_b32 v24, s3, v24
  v_xor_b32 v26, s3, v26
  s_mul_i32 s69, s8, 1408
  v_add_u32 v44, s69, v18
  v_add_u32 v29, 157440, v44
  s_add_u32 s69, s69, 1408
  s_min_u32 s69, s69, 5472
  v_mov_b32 v27, v44
  v_add_u32 v44, 1024, v44
  v_cmp_gt_u32 s[32:33], s69, v44
  s_nop 1
  v_cndmask_b32 v28, v46, v44, s[32:33]
  v_and_b32 v32, 31, v0
  s_lshl_b32 s69, s8, 5
  v_add_u32 v44, s69, v32
  v_mul_u32_u24 v44, 440, v44
  v_add_u32 v33, 83376, v44
  v_lshlrev_b32 v32, 2, v32
  v_mov_b32 v34, 0x3f803f80
  v_mov_b32 v35, 0x3f803f80
  v_bfe_u32 v41, v0, 2, 2
  v_cmp_eq_u32 s[72:73], v16, v41
  v_lshlrev_b32 v40, 4, v42
  v_mov_b32 v41, 0x3f80
  v_lshlrev_b32 v40, v40, v41
  v_cndmask_b32 v40, 0, v40, s[72:73]
  v_and_b32 v41, 2, v0
  v_cmp_eq_u32 s[72:73], 0, v41
  s_nop 1
  v_cndmask_b32 v36, 0, v40, s[72:73]
  v_cndmask_b32 v37, v40, 0, s[72:73]
  v_mov_b32 v38, v36
  v_mov_b32 v39, v37
  s_lshr_b32 s3, s2, 3
  s_lshl_b32 s3, s3, 2
  s_add_u32 s3, s3, s8
  s_add_u32 m0, s65, 0
  s_nop 0
  buffer_load_dwordx4 v2, s[40:43], s11 offen offset:0 lds
  s_mul_i32 s3, s3, 41
  v_add_u32 v40, s3, v0
  v_lshlrev_b32 v40, 7, v40
  v_cmp_gt_u32 s[72:73], 41, v0
  s_nop 1
  v_cndmask_b32 v254, v46, v40, s[72:73]
  v_lshrrev_b32 v40, 3, v0
  v_mul_u32_u24 v40, 2176, v40
  v_add_u32 v255, v40, v18
  s_mul_i32 s3, s8, 14080
  s_add_u32 s3, s3, 83088
  v_mul_u32_u24 v40, 440, v17
  v_mul_u32_u24 v41, 36, v16
  v_add3_u32 v40, v40, v41, s3
  v_and_b32 v41, 1, v16
  v_lshl_add_u32 v250, v41, 2, v40
  v_lshlrev_b32 v41, 5, v41
  v_sub_u32 v40, v40, v41
  v_add_u32 v251, 32, v40
  v_lshrrev_b32 v40, 3, v17
  v_and_b32 v41, 4, v17
  v_and_b32 v42, 3, v17
  v_lshl_add_u32 v43, v41, 1, v42
  v_add_u32 v44, 14, v42
  v_cmp_gt_u32 s[16:17], 2, v42
  v_and_b32 v41, 1, v16
  v_lshl_add_u32 v42, v40, 1, v41
  v_cndmask_b32 v44, v44, 18, s[16:17]
  v_mul_u32_u24 v42, 608, v42
  v_add_u32 v42, 159872, v42
  v_lshl_add_u32 v60, v43, 4, v42
  v_lshl_add_u32 v61, v44, 4, v42
  v_mul_u32_u24 v42, 152, v40
  v_lshl_add_u32 v42, v41, 2, v42
  v_add_u32 v42, 162608, v42
  v_lshl_add_u32 v62, v43, 3, v42
  buffer_load_dwordx4 v3, s[40:43], s11 offen offset:1024 lds
  v_lshl_add_u32 v63, v44, 3, v42
  v_lshrrev_b32 v41, 1, v16
  v_cmp_eq_u32 s[16:17], v41, v40
  v_and_b32 v40, 1, v0
  v_mul_u32_u24 v40, 2880, v40
  v_add_u32 v40, 149920, v40
  v_bfe_u32 v41, v0, 1, 1
  v_mul_u32_u24 v41, 18, v41
  v_lshrrev_b32 v42, 2, v0
  v_mov_b32 v43, 154240
  v_add_u32 v44, 0, v42
  v_sub_u32 v45, v44, v41
  v_cmp_gt_u32 s[72:73], 18, v45
  v_mul_u32_u24 v44, 40, v44
  v_add_u32 v44, v44, v40
  v_cndmask_b32 v64, v43, v44, s[72:73]
  v_add_u32 v44, 16, v42
  v_sub_u32 v45, v44, v41
  v_cmp_gt_u32 s[72:73], 18, v45
  v_mul_u32_u24 v44, 40, v44
  v_add_u32 v44, v44, v40
  v_cndmask_b32 v65, v43, v44, s[72:73]
  v_add_u32 v44, 28, v42
  v_sub_u32 v45, v44, v41
  v_cmp_gt_u32 s[72:73], 18, v45
  v_mul_u32_u24 v44, 40, v44
  v_add_u32 v44, v44, v40
  s_andn2_b64 s[72:73], s[72:73], s[70:71]
  v_cndmask_b32 v66, v43, v44, s[72:73]
  s_lshl_b32 s3, s8, 11
  s_add_u32 s3, s3, 139264
  v_add_u32 v252, s3, v18
  s_lshl_b32 s3, s8, 8
  s_add_u32 s3, s3, 147456
  v_lshl_add_u32 v253, v17, 4, s3
  s_waitcnt vmcnt(7)
  s_barrier
  buffer_load_dwordx4 v4, s[40:43], s11 offen offset:2048 lds
  buffer_load_dwordx4 v5, s[40:43], s11 offen offset:3072 lds
  s_add_u32 m0, s65, 4096
  s_mov_b32 exec_hi, 0
  buffer_load_dwordx4 v6, s[40:43], s11 offen lds
  s_mov_b32 exec_hi, -1
  s_bfe_u32 s14, s48, 262148
  s_mul_i32 s15, s14, 128
  s_add_u32 s10, s49, s15
  s_mul_i32 s15, s14, 221184
  s_add_u32 s11, s50, s15
  s_add_u32 m0, s64, 34816
  s_nop 0
  buffer_load_dwordx4 v1, s[36:39], s10 offen offset:0  lds
  s_add_u32 s13, s10, 8192
  buffer_load_dwordx4 v1, s[36:39], s13 offen offset:1024  lds
  s_add_u32 s13, s10, 16384
  buffer_load_dwordx4 v1, s[36:39], s13 offen offset:2048  lds
  s_add_u32 s13, s10, 24576
  buffer_load_dwordx4 v1, s[36:39], s13 offen offset:3072  lds
  s_add_u32 m0, s65, 34816
  s_nop 0
  buffer_load_dwordx4 v2, s[40:43], s11 offen offset:0 lds
  buffer_load_dwordx4 v3, s[40:43], s11 offen offset:1024 lds
  s_waitcnt vmcnt(6)
  s_barrier
  buffer_load_dwordx4 v4, s[40:43], s11 offen offset:2048 lds
  s_lshl_b32 s24, s8, 6
  v_add_u32 v72, s24, v0
  v_mul_u32_u24 v73, 6554, v72
  v_lshrrev_b32 v73, 16, v73
  v_sub_u32 v74, v72, v73
  v_lshlrev_b32 v74, 2, v74
  v_add_u32 v74, 139264, v74
  ds_read_b32 v76, v74
  v_mul_u32_u24 v73, 10, v73
  buffer_load_dwordx4 v5, s[40:43], s11 offen offset:3072 lds
  v_sub_u32 v73, v72, v73
  v_cmp_ne_u32 s[24:25], 9, v73
  s_waitcnt lgkmcnt(0)
  s_nop 0
  v_cndmask_b32 v76, 0, v76, s[24:25]
  v_xor_b32 v80, 0x80008000, v76
  v_add_u32 v72, 256, v72
  v_mul_u32_u24 v73, 6554, v72
  v_lshrrev_b32 v73, 16, v73
  v_sub_u32 v74, v72, v73
  v_lshlrev_b32 v74, 2, v74
  s_add_u32 m0, s65, 38912
  s_mov_b32 exec_hi, 0
  buffer_load_dwordx4 v6, s[40:43], s11 offen lds
  s_mov_b32 exec_hi, -1
  s_bfe_u32 s14, s48, 262152
  s_mul_i32 s15, s14, 128
  s_add_u32 s10, s49, s15
  s_mul_i32 s15, s14, 221184
  s_add_u32 s11, s50, s15
  v_add_u32 v74, 139264, v74
  ds_read_b32 v77, v74
  v_mul_u32_u24 v73, 10, v73
  v_sub_u32 v73, v72, v73
  v_cmp_ne_u32 s[24:25], 9, v73
  s_waitcnt lgkmcnt(0)
  s_nop 0
  v_cndmask_b32 v77, 0, v77, s[24:25]
  v_xor_b32 v81, 0x80008000, v77
  v_add_u32 v72, 256, v72
  v_mul_u32_u24 v73, 6554, v72
  s_add_u32 m0, s64, 69632
  s_nop 0
  buffer_load_dwordx4 v1, s[36:39], s10 offen offset:0  lds
  v_lshrrev_b32 v73, 16, v73
  v_sub_u32 v74, v72, v73
  v_lshlrev_b32 v74, 2, v74
  v_add_u32 v74, 139264, v74
  ds_read_b32 v78, v74
  v_mul_u32_u24 v73, 10, v73
  s_add_u32 s13, s10, 8192
  buffer_load_dwordx4 v1, s[36:39], s13 offen offset:1024  lds
  v_sub_u32 v73, v72, v73
  v_cmp_ne_u32 s[24:25], 9, v73
  s_waitcnt lgkmcnt(0)
  s_nop 0
  v_cndmask_b32 v78, 0, v78, s[24:25]
  v_xor_b32 v82, 0x80008000, v78
  v_lshlrev_b32 v72, 2, v72
  v_add_u32 v72, 146432, v72
  s_add_u32 s13, s10, 16384
  buffer_load_dwordx4 v1, s[36:39], s13 offen offset:2048  lds
  ds_write_b32 v72, v76
  ds_write_b32 v72, v80 offset:2880
  ds_write_b32 v72, v77 offset:1024
  ds_write_b32 v72, v81 offset:3904
  v_mov_b32 v73, 149312
  v_cmp_gt_u32 s[24:25], v73, v72
  s_add_u32 s13, s10, 24576
  buffer_load_dwordx4 v1, s[36:39], s13 offen offset:3072  lds
  v_mov_b32 v75, 161780
  v_cndmask_b32 v82, 0, v82, s[24:25]
  v_cndmask_b32 v74, v75, v72, s[24:25]
  ds_write_b32 v74, v78 offset:2048
  v_add_u32 v73, 40, v73
  v_cmp_gt_u32 s[24:25], v73, v72
  s_add_u32 m0, s65, 69632
  s_nop 0
  buffer_load_dwordx4 v2, s[40:43], s11 offen offset:0 lds
  v_mov_b32 v75, 158900
  v_cndmask_b32 v74, v75, v72, s[24:25]
  ds_write_b32 v74, v82 offset:4928
  buffer_load_dwordx4 v3, s[40:43], s11 offen offset:1024 lds
  s_waitcnt vmcnt(6)
  s_waitcnt lgkmcnt(0)
  s_barrier
  buffer_load_dwordx4 v4, s[40:43], s11 offen offset:2048 lds
  buffer_load_dwordx4 v5, s[40:43], s11 offen offset:3072 lds
  s_add_u32 m0, s65, 73728
  s_mov_b32 exec_hi, 0
  buffer_load_dwordx4 v6, s[40:43], s11 offen lds
  s_mov_b32 exec_hi, -1
  s_bfe_u32 s14, s48, 262156
  s_mul_i32 s15, s14, 128
  s_add_u32 s10, s49, s15
  s_mul_i32 s15, s14, 221184
  s_add_u32 s11, s50, s15
  s_add_u32 m0, s64, 104448
  s_nop 0
  buffer_load_dwordx4 v1, s[36:39], s10 offen offset:0  lds
  s_add_u32 s13, s10, 8192
  buffer_load_dwordx4 v1, s[36:39], s13 offen offset:1024  lds
  s_add_u32 s13, s10, 16384
  buffer_load_dwordx4 v1, s[36:39], s13 offen offset:2048  lds
  s_add_u32 s13, s10, 24576
  buffer_load_dwordx4 v1, s[36:39], s13 offen offset:3072  lds
  s_add_u32 m0, s65, 104448
  s_nop 0
  buffer_load_dwordx4 v2, s[40:43], s11 offen offset:0 lds
  buffer_load_dwordx4 v3, s[40:43], s11 offen offset:1024 lds
  s_waitcnt vmcnt(6)
  s_barrier
  buffer_load_dwordx4 v4, s[40:43], s11 offen offset:2048 lds
  buffer_load_dwordx4 v5, s[40:43], s11 offen offset:3072 lds
  s_add_u32 m0, s65, 108544
  s_mov_b32 exec_hi, 0
  buffer_load_dwordx4 v6, s[40:43], s11 offen lds
  s_mov_b32 exec_hi, -1
  s_bfe_u32 s14, s48, 262160
  s_mul_i32 s15, s14, 128
  s_add_u32 s10, s49, s15
  s_mul_i32 s15, s14, 221184
  s_add_u32 s11, s50, s15
  s_add_u32 m0, s64, 0
  s_nop 0
  buffer_load_dwordx4 v1, s[36:39], s10 offen offset:0  lds
  s_add_u32 s13, s10, 8192
  buffer_load_dwordx4 v1, s[36:39], s13 offen offset:1024  lds
  s_add_u32 s13, s10, 16384
  buffer_load_dwordx4 v1, s[36:39], s13 offen offset:2048  lds
  s_add_u32 s13, s10, 24576
  buffer_load_dwordx4 v1, s[36:39], s13 offen offset:3072  lds
  s_add_u32 m0, s65, 0
  s_nop 0
  buffer_load_dwordx4 v2, s[40:43], s11 offen offset:0 lds
  buffer_load_dwordx4 v3, s[40:43], s11 offen offset:1024 lds
  s_waitcnt vmcnt(6)
  s_barrier
  buffer_load_dwordx4 v4, s[40:43], s11 offen offset:2048 lds
  buffer_load_dwordx4 v5, s[40:43], s11 offen offset:3072 lds
  s_add_u32 m0, s65, 4096
  s_mov_b32 exec_hi, 0
  buffer_load_dwordx4 v6, s[40:43], s11 offen lds
  s_mov_b32 exec_hi, -1
  s_bfe_u32 s14, s48, 262164
  s_mul_i32 s15, s14, 128
  s_add_u32 s10, s49, s15
  s_mul_i32 s15, s14, 221184
  s_add_u32 s11, s50, s15
  s_add_u32 m0, s64, 34816
  s_nop 0
  buffer_load_dwordx4 v1, s[36:39], s10 offen offset:0  lds
  s_add_u32 s13, s10, 8192
  buffer_load_dwordx4 v1, s[36:39], s13 offen offset:1024  lds
  s_add_u32 s13, s10, 16384
  buffer_load_dwordx4 v1, s[36:39], s13 offen offset:2048  lds
  s_add_u32 s13, s10, 24576
  buffer_load_dwordx4 v1, s[36:39], s13 offen offset:3072  lds
  s_add_u32 m0, s65, 34816
  s_nop 0
  buffer_load_dwordx4 v2, s[40:43], s11 offen offset:0 lds
  buffer_load_dwordx4 v3, s[40:43], s11 offen offset:1024 lds
  s_waitcnt vmcnt(6)
  s_barrier
  buffer_load_dwordx4 v4, s[40:43], s11 offen offset:2048 lds
  buffer_load_dwordx4 v5, s[40:43], s11 offen offset:3072 lds
  s_add_u32 m0, s65, 38912
  s_mov_b32 exec_hi, 0
  buffer_load_dwordx4 v6, s[40:43], s11 offen lds
  s_mov_b32 exec_hi, -1
  s_bfe_u32 s14, s48, 262168
  s_mul_i32 s15, s14, 128
  s_add_u32 s10, s49, s15
  s_mul_i32 s15, s14, 221184
  s_add_u32 s11, s50, s15
  s_add_u32 m0, s64, 69632
  s_nop 0
  buffer_load_dwordx4 v1, s[36:39], s10 offen offset:0  lds
  s_add_u32 s13, s10, 8192
  buffer_load_dwordx4 v1, s[36:39], s13 offen offset:1024  lds
  s_add_u32 s13, s10, 16384
  buffer_load_dwordx4 v1, s[36:39], s13 offen offset:2048  lds
  s_add_u32 s13, s10, 24576
  buffer_load_dwordx4 v1, s[36:39], s13 offen offset:3072  lds
  s_add_u32 m0, s65, 69632
  s_nop 0
  buffer_load_dwordx4 v2, s[40:43], s11 offen offset:0 lds
  buffer_load_dwordx4 v3, s[40:43], s11 offen offset:1024 lds
  s_waitcnt vmcnt(6)
  s_barrier
  buffer_load_dwordx4 v4, s[40:43], s11 offen offset:2048 lds
  buffer_load_dwordx4 v5, s[40:43], s11 offen offset:3072 lds
  s_add_u32 m0, s65, 73728
  s_mov_b32 exec_hi, 0
  buffer_load_dwordx4 v6, s[40:43], s11 offen lds
  s_mov_b32 exec_hi, -1
  s_bfe_u32 s14, s48, 262172
  s_mul_i32 s15, s14, 128
  s_add_u32 s10, s49, s15
  s_mul_i32 s15, s14, 221184
  s_add_u32 s11, s50, s15
  s_add_u32 m0, s64, 104448
  s_nop 0
  buffer_load_dwordx4 v1, s[36:39], s10 offen offset:0  lds
  s_add_u32 s13, s10, 8192
  buffer_load_dwordx4 v1, s[36:39], s13 offen offset:1024  lds
  s_add_u32 s13, s10, 16384
  buffer_load_dwordx4 v1, s[36:39], s13 offen offset:2048  lds
  s_add_u32 s13, s10, 24576
  buffer_load_dwordx4 v1, s[36:39], s13 offen offset:3072  lds
  s_add_u32 m0, s65, 104448
  s_nop 0
  buffer_load_dwordx4 v2, s[40:43], s11 offen offset:0 lds
  buffer_load_dwordx4 v3, s[40:43], s11 offen offset:1024 lds
  s_waitcnt vmcnt(6)
  s_barrier
  buffer_load_dwordx4 v4, s[40:43], s11 offen offset:2048 lds
  buffer_load_dwordx4 v5, s[40:43], s11 offen offset:3072 lds
  s_add_u32 m0, s65, 108544
  s_mov_b32 exec_hi, 0
  buffer_load_dwordx4 v6, s[40:43], s11 offen lds
  s_mov_b32 exec_hi, -1
  ds_read_b64_tr_b16 v[200:201], v64 offset:0
  ds_read_b64_tr_b16 v[202:203], v65 offset:0
  ds_read_b64_tr_b16 v[204:205], v66 offset:0
  ds_read_b64_tr_b16 v[206:207], v64 offset:8
  ds_read_b64_tr_b16 v[208:209], v65 offset:8
  ds_read_b64_tr_b16 v[210:211], v66 offset:8
  ds_read_b64_tr_b16 v[212:213], v64 offset:16
  ds_read_b64_tr_b16 v[214:215], v65 offset:16
  ds_read_b64_tr_b16 v[216:217], v66 offset:16
  ds_read_b64_tr_b16 v[218:219], v64 offset:24
  ds_read_b64_tr_b16 v[220:221], v65 offset:24
  ds_read_b64_tr_b16 v[222:223], v66 offset:24
  ds_read_b64_tr_b16 v[224:225], v64 offset:32
  ds_read_b64_tr_b16 v[226:227], v65 offset:32
  ds_read_b64_tr_b16 v[228:229], v66 offset:32
  s_add_u32 m0, s68, 0
  s_nop 0
  buffer_load_dwordx4 v7, s[40:43], s66 offen offset:0 lds
  buffer_load_dwordx4 v8, s[40:43], s66 offen offset:1024 lds
  s_mov_b64 exec, 0xffff
  buffer_load_dwordx4 v9, s[40:43], s66 offen offset:2048 lds
  s_mov_b64 exec, -1
  s_bfe_u32 s14, s48, 262160
  s_mul_i32 s15, s14, 221184
  s_add_u32 s66, s51, s15
  s_add_u32 m0, s68, 9216
  s_nop 0
  buffer_load_dwordx4 v7, s[40:43], s66 offen offset:0 lds
  buffer_load_dwordx4 v8, s[40:43], s66 offen offset:1024 lds
  s_mov_b64 exec, 0xffff
  buffer_load_dwordx4 v9, s[40:43], s66 offen offset:2048 lds
  s_mov_b64 exec, -1
  s_bfe_u32 s14, s48, 262172
  s_mul_i32 s15, s14, 221184
  s_add_u32 s66, s51, s15
  s_waitcnt vmcnt(6)
  s_barrier
  s_add_u32 m0, s68, 18432
  s_nop 0
  buffer_load_dwordx4 v7, s[40:43], s66 offen offset:0 lds
  buffer_load_dwordx4 v8, s[40:43], s66 offen offset:1024 lds
  s_mov_b64 exec, 0xffff
  buffer_load_dwordx4 v9, s[40:43], s66 offen offset:2048 lds
  s_mov_b64 exec, -1
  s_bfe_u32 s14, s48, 262144
  s_mul_i32 s15, s14, 221184
  s_add_u32 s66, s51, s15
  s_waitcnt lgkmcnt(0)
  s_waitcnt vmcnt(6)
  s_barrier
  s_setprio 1
  ds_read_b128 v[64:67], v252 offset:0
  ds_read_b128 v[68:71], v252 offset:1024
  ds_read_b128 v[72:75], v253
  s_mov_b32 exec_hi, 0
  ds_write_b64 v33, v[34:35]
  s_mov_b32 exec_hi, -1
  buffer_load_dword v31, v32, s[60:63], 0 offen offset:128 sc1
  s_add_u32 m0, s68, 27648
  s_nop 0
  buffer_load_dwordx4 v7, s[40:43], s66 offen offset:0 lds
  s_waitcnt lgkmcnt(3)
  v_mfma_f32_16x16x32_bf16 v[80:83], v[200:203], v[64:67], 0
  v_mfma_f32_16x16x32_bf16 v[84:87], v[206:209], v[64:67], 0
  v_mfma_f32_16x16x32_bf16 v[88:91], v[212:215], v[64:67], 0
  v_mfma_f32_16x16x32_bf16 v[92:95], v[218:221], v[64:67], 0
  v_mfma_f32_16x16x32_bf16 v[96:99], v[224:227], v[64:67], 0
  s_waitcnt lgkmcnt(2)
  v_mfma_f32_16x16x32_bf16 v[100:103], v[200:203], v[68:71], 0
  v_mfma_f32_16x16x32_bf16 v[104:107], v[206:209], v[68:71], 0
  v_mfma_f32_16x16x32_bf16 v[108:111], v[212:215], v[68:71], 0
  v_mfma_f32_16x16x32_bf16 v[112:115], v[218:221], v[68:71], 0
  buffer_load_dwordx4 v8, s[40:43], s66 offen offset:1024 lds
  v_mfma_f32_16x16x32_bf16 v[116:119], v[224:227], v[68:71], 0
  s_waitcnt lgkmcnt(1)
  v_mfma_f32_16x16x16_bf16 v[80:83], v[204:205], v[72:73], v[80:83]
  v_mfma_f32_16x16x16_bf16 v[84:87], v[210:211], v[72:73], v[84:87]
  v_mfma_f32_16x16x16_bf16 v[88:91], v[216:217], v[72:73], v[88:91]
  v_mfma_f32_16x16x16_bf16 v[92:95], v[222:223], v[72:73], v[92:95]
  v_mfma_f32_16x16x16_bf16 v[96:99], v[228:229], v[72:73], v[96:99]
  v_mfma_f32_16x16x16_bf16 v[100:103], v[204:205], v[74:75], v[100:103]
  v_mfma_f32_16x16x16_bf16 v[104:107], v[210:211], v[74:75], v[104:107]
  s_mov_b64 exec, 0xffff
  buffer_load_dwordx4 v9, s[40:43], s66 offen offset:2048 lds
  s_mov_b64 exec, -1
  s_bfe_u32 s14, s48, 262148
  s_mul_i32 s15, s14, 221184
  s_add_u32 s66, s51, s15
  v_mfma_f32_16x16x16_bf16 v[108:111], v[216:217], v[74:75], v[108:111]
  v_mfma_f32_16x16x16_bf16 v[112:115], v[222:223], v[74:75], v[112:115]
  v_mfma_f32_16x16x16_bf16 v[116:119], v[228:229], v[74:75], v[116:119]
  v_max3_f32 v76, v80, v81, v82
  v_max3_f32 v77, v83, v84, v85
  v_max3_f32 v76, v86, v87, v76
  v_max3_f32 v77, v88, v89, v77
  v_max3_f32 v76, v90, v91, v76
  v_max3_f32 v77, v92, v93, v77
  s_add_u32 m0, s68, 36864
  s_nop 0
  buffer_load_dwordx4 v7, s[40:43], s66 offen offset:0 lds
  v_max3_f32 v76, v94, v95, v76
  v_max3_f32 v77, v96, v97, v77
  v_max_f32 v76, v76, v77
  v_mul_f32 v76, s76, v76
  v_pk_fma_f32 v[80:81], v[80:81], s[76:77], v[76:77] op_sel_hi:[1,1,0] neg_lo:[0,0,1] neg_hi:[0,0,1]
  v_pk_fma_f32 v[82:83], v[82:83], s[76:77], v[76:77] op_sel_hi:[1,1,0] neg_lo:[0,0,1] neg_hi:[0,0,1]
  v_pk_fma_f32 v[84:85], v[84:85], s[76:77], v[76:77] op_sel_hi:[1,1,0] neg_lo:[0,0,1] neg_hi:[0,0,1]
  v_pk_fma_f32 v[86:87], v[86:87], s[76:77], v[76:77] op_sel_hi:[1,1,0] neg_lo:[0,0,1] neg_hi:[0,0,1]
  buffer_load_dwordx4 v8, s[40:43], s66 offen offset:1024 lds
  v_pk_fma_f32 v[88:89], v[88:89], s[76:77], v[76:77] op_sel_hi:[1,1,0] neg_lo:[0,0,1] neg_hi:[0,0,1]
  v_pk_fma_f32 v[90:91], v[90:91], s[76:77], v[76:77] op_sel_hi:[1,1,0] neg_lo:[0,0,1] neg_hi:[0,0,1]
  v_pk_fma_f32 v[92:93], v[92:93], s[76:77], v[76:77] op_sel_hi:[1,1,0] neg_lo:[0,0,1] neg_hi:[0,0,1]
  v_pk_fma_f32 v[94:95], v[94:95], s[76:77], v[76:77] op_sel_hi:[1,1,0] neg_lo:[0,0,1] neg_hi:[0,0,1]
  v_pk_fma_f32 v[96:97], v[96:97], s[76:77], v[76:77] op_sel_hi:[1,1,0] neg_lo:[0,0,1] neg_hi:[0,0,1]
  v_exp_f32 v80, v80
  v_exp_f32 v81, v81
  v_exp_f32 v82, v82
  v_exp_f32 v83, v83
  s_mov_b64 exec, 0xffff
  buffer_load_dwordx4 v9, s[40:43], s66 offen offset:2048 lds
  s_mov_b64 exec, -1
  s_bfe_u32 s14, s48, 262152
  s_mul_i32 s15, s14, 221184
  s_add_u32 s66, s51, s15
  v_exp_f32 v84, v84
  v_exp_f32 v85, v85
  v_exp_f32 v86, v86
  v_exp_f32 v87, v87
  v_exp_f32 v88, v88
  v_exp_f32 v89, v89
  v_exp_f32 v90, v90
  v_exp_f32 v91, v91
  s_add_u32 m0, s68, 46080
  s_nop 0
  buffer_load_dwordx4 v7, s[40:43], s66 offen offset:0 lds
  v_exp_f32 v92, v92
  v_exp_f32 v93, v93
  v_exp_f32 v94, v94
  v_exp_f32 v95, v95
  v_exp_f32 v96, v96
  v_exp_f32 v97, v97
  v_pk_add_f32 v[76:77], v[80:81], v[82:83]
  v_pk_add_f32 v[76:77], v[76:77], v[84:85]
  buffer_load_dwordx4 v8, s[40:43], s66 offen offset:1024 lds
  v_pk_add_f32 v[76:77], v[76:77], v[86:87]
  v_pk_add_f32 v[76:77], v[76:77], v[88:89]
  v_pk_add_f32 v[76:77], v[76:77], v[90:91]
  v_pk_add_f32 v[76:77], v[76:77], v[92:93]
  v_pk_add_f32 v[76:77], v[76:77], v[94:95]
  v_pk_add_f32 v[76:77], v[76:77], v[96:97]
  v_add_f32 v76, v76, v77
  v_rcp_f32 v76, v76
  s_nop 0
  v_pk_mul_f32 v[80:81], v[80:81], v[76:77] op_sel_hi:[1,0]
  s_mov_b64 exec, 0xffff
  buffer_load_dwordx4 v9, s[40:43], s66 offen offset:2048 lds
  s_mov_b64 exec, -1
  s_bfe_u32 s14, s48, 262156
  s_mul_i32 s15, s14, 221184
  s_add_u32 s66, s51, s15
  v_pk_mul_f32 v[82:83], v[82:83], v[76:77] op_sel_hi:[1,0]
  v_pk_mul_f32 v[84:85], v[84:85], v[76:77] op_sel_hi:[1,0]
  v_pk_mul_f32 v[86:87], v[86:87], v[76:77] op_sel_hi:[1,0]
  v_pk_mul_f32 v[88:89], v[88:89], v[76:77] op_sel_hi:[1,0]
  v_pk_mul_f32 v[90:91], v[90:91], v[76:77] op_sel_hi:[1,0]
  v_pk_mul_f32 v[92:93], v[92:93], v[76:77] op_sel_hi:[1,0]
  v_pk_mul_f32 v[94:95], v[94:95], v[76:77] op_sel_hi:[1,0]
  v_pk_mul_f32 v[96:97], v[96:97], v[76:77] op_sel_hi:[1,0]
  s_add_u32 m0, s68, 55296
  s_nop 0
  buffer_load_dwordx4 v7, s[40:43], s66 offen offset:0 lds
  v_cvt_pk_bf16_f32 v80, v80, v81
  v_cvt_pk_bf16_f32 v81, v82, v83
  v_cvt_pk_bf16_f32 v82, v84, v85
  v_cvt_pk_bf16_f32 v83, v86, v87
  v_cvt_pk_bf16_f32 v84, v88, v89
  v_cvt_pk_bf16_f32 v85, v90, v91
  v_cvt_pk_bf16_f32 v86, v92, v93
  v_cvt_pk_bf16_f32 v87, v94, v95
  v_cvt_pk_bf16_f32 v88, v96, v97
  buffer_load_dwordx4 v8, s[40:43], s66 offen offset:1024 lds
  ds_write_b64 v250, v[80:81] offset:0
  ds_write_b64 v250, v[82:83] offset:8
  ds_write_b64 v250, v[84:85] offset:16
  ds_write_b64 v250, v[86:87] offset:24
  ds_write_b32 v251, v88 offset:0
  v_max3_f32 v76, v100, v101, v102
  v_max3_f32 v77, v103, v104, v105
  v_max3_f32 v76, v106, v107, v76
  s_mov_b64 exec, 0xffff
  buffer_load_dwordx4 v9, s[40:43], s66 offen offset:2048 lds
  s_mov_b64 exec, -1
  s_bfe_u32 s14, s48, 262164
  s_mul_i32 s15, s14, 221184
  s_add_u32 s66, s51, s15
  v_max3_f32 v77, v108, v109, v77
  v_max3_f32 v76, v110, v111, v76
  v_max3_f32 v77, v112, v113, v77
  v_max3_f32 v76, v114, v115, v76
  v_max3_f32 v77, v116, v117, v77
  v_max_f32 v76, v76, v77
  v_mul_f32 v76, s76, v76
  v_pk_fma_f32 v[100:101], v[100:101], s[76:77], v[76:77] op_sel_hi:[1,1,0] neg_lo:[0,0,1] neg_hi:[0,0,1]
  v_pk_fma_f32 v[102:103], v[102:103], s[76:77], v[76:77] op_sel_hi:[1,1,0] neg_lo:[0,0,1] neg_hi:[0,0,1]
  s_add_u32 m0, s68, 64512
  s_nop 0
  buffer_load_dwordx4 v7, s[40:43], s66 offen offset:0 lds
  v_pk_fma_f32 v[104:105], v[104:105], s[76:77], v[76:77] op_sel_hi:[1,1,0] neg_lo:[0,0,1] neg_hi:[0,0,1]
  v_pk_fma_f32 v[106:107], v[106:107], s[76:77], v[76:77] op_sel_hi:[1,1,0] neg_lo:[0,0,1] neg_hi:[0,0,1]
  v_pk_fma_f32 v[108:109], v[108:109], s[76:77], v[76:77] op_sel_hi:[1,1,0] neg_lo:[0,0,1] neg_hi:[0,0,1]
  v_pk_fma_f32 v[110:111], v[110:111], s[76:77], v[76:77] op_sel_hi:[1,1,0] neg_lo:[0,0,1] neg_hi:[0,0,1]
  v_pk_fma_f32 v[112:113], v[112:113], s[76:77], v[76:77] op_sel_hi:[1,1,0] neg_lo:[0,0,1] neg_hi:[0,0,1]
  v_pk_fma_f32 v[114:115], v[114:115], s[76:77], v[76:77] op_sel_hi:[1,1,0] neg_lo:[0,0,1] neg_hi:[0,0,1]
  v_pk_fma_f32 v[116:117], v[116:117], s[76:77], v[76:77] op_sel_hi:[1,1,0] neg_lo:[0,0,1] neg_hi:[0,0,1]
  v_exp_f32 v100, v100
  buffer_load_dwordx4 v8, s[40:43], s66 offen offset:1024 lds
  v_exp_f32 v101, v101
  v_exp_f32 v102, v102
  v_exp_f32 v103, v103
  v_exp_f32 v104, v104
  v_exp_f32 v105, v105
  v_exp_f32 v106, v106
  v_exp_f32 v107, v107
  v_exp_f32 v108, v108
  s_mov_b64 exec, 0xffff
  buffer_load_dwordx4 v9, s[40:43], s66 offen offset:2048 lds
  s_mov_b64 exec, -1
  s_bfe_u32 s14, s48, 262168
  s_mul_i32 s15, s14, 221184
  s_add_u32 s66, s51, s15
  v_exp_f32 v109, v109
  v_exp_f32 v110, v110
  v_exp_f32 v111, v111
  v_exp_f32 v112, v112
  v_exp_f32 v113, v113
  v_exp_f32 v114, v114
  v_exp_f32 v115, v115
  v_exp_f32 v116, v116
  v_exp_f32 v117, v117
  s_add_u32 m0, s68, 73728
  s_nop 0
  buffer_load_dwordx4 v7, s[40:43], s66 offen offset:0 lds
  v_pk_add_f32 v[76:77], v[100:101], v[102:103]
  v_pk_add_f32 v[76:77], v[76:77], v[104:105]
  v_pk_add_f32 v[76:77], v[76:77], v[106:107]
  v_pk_add_f32 v[76:77], v[76:77], v[108:109]
  v_pk_add_f32 v[76:77], v[76:77], v[110:111]
  v_pk_add_f32 v[76:77], v[76:77], v[112:113]
  v_pk_add_f32 v[76:77], v[76:77], v[114:115]
  v_pk_add_f32 v[76:77], v[76:77], v[116:117]
  buffer_load_dwordx4 v8, s[40:43], s66 offen offset:1024 lds
  v_add_f32 v76, v76, v77
  v_rcp_f32 v76, v76
  s_nop 0
  v_pk_mul_f32 v[100:101], v[100:101], v[76:77] op_sel_hi:[1,0]
  v_pk_mul_f32 v[102:103], v[102:103], v[76:77] op_sel_hi:[1,0]
  v_pk_mul_f32 v[104:105], v[104:105], v[76:77] op_sel_hi:[1,0]
  v_pk_mul_f32 v[106:107], v[106:107], v[76:77] op_sel_hi:[1,0]
  v_pk_mul_f32 v[108:109], v[108:109], v[76:77] op_sel_hi:[1,0]
  v_pk_mul_f32 v[110:111], v[110:111], v[76:77] op_sel_hi:[1,0]
  v_pk_mul_f32 v[112:113], v[112:113], v[76:77] op_sel_hi:[1,0]
  s_mov_b64 exec, 0xffff
  buffer_load_dwordx4 v9, s[40:43], s66 offen offset:2048 lds
  s_mov_b64 exec, -1
  v_pk_mul_f32 v[114:115], v[114:115], v[76:77] op_sel_hi:[1,0]
  v_pk_mul_f32 v[116:117], v[116:117], v[76:77] op_sel_hi:[1,0]
  v_cvt_pk_bf16_f32 v100, v100, v101
  v_cvt_pk_bf16_f32 v101, v102, v103
  v_cvt_pk_bf16_f32 v102, v104, v105
  v_cvt_pk_bf16_f32 v103, v106, v107
  v_cvt_pk_bf16_f32 v104, v108, v109
  v_cvt_pk_bf16_f32 v105, v110, v111
  buffer_load_dword v254, v254, s[44:47], 0 offen
  v_cvt_pk_bf16_f32 v106, v112, v113
  v_cvt_pk_bf16_f32 v107, v114, v115
  v_cvt_pk_bf16_f32 v108, v116, v117
  ds_write_b64 v250, v[100:101] offset:7040
  ds_write_b64 v250, v[102:103] offset:7048
  ds_write_b64 v250, v[104:105] offset:7056
  ds_write_b64 v250, v[106:107] offset:7064
  ds_write_b32 v251, v108 offset:7040
  s_setprio 0
  s_waitcnt vmcnt(10)
  s_waitcnt lgkmcnt(0)
  s_barrier
  s_setprio 3
  ds_read_b64_tr_b16 v[64:65], v20 offset:0
  ds_read_b64_tr_b16 v[66:67], v20 offset:440
  ds_read_b64_tr_b16 v[72:73], v19 offset:0
  ds_read_b64_tr_b16 v[74:75], v19 offset:440
  ds_read_b64_tr_b16 v[68:69], v21 offset:0
  ds_read_b64_tr_b16 v[70:71], v21 offset:440
  ds_read_b64_tr_b16 v[76:77], v30 offset:0
  ds_read_b64_tr_b16 v[78:79], v30 offset:440
  ds_read_b64_tr_b16 v[80:81], v22 offset:0
  ds_read_b64_tr_b16 v[82:83], v22 offset:440
  ds_read_b64_tr_b16 v[84:85], v20 offset:14080
  ds_read_b64_tr_b16 v[86:87], v20 offset:14520
  ds_read_b64_tr_b16 v[92:93], v19 offset:14080
  ds_read_b64_tr_b16 v[94:95], v19 offset:14520
  ds_read_b64_tr_b16 v[88:89], v21 offset:14080
  ds_read_b64_tr_b16 v[90:91], v21 offset:14520
  ds_read_b64_tr_b16 v[96:97], v30 offset:14080
  ds_read_b64_tr_b16 v[98:99], v30 offset:14520
  ds_read_b64_tr_b16 v[100:101], v22 offset:14080
  ds_read_b64_tr_b16 v[102:103], v22 offset:14520
  s_waitcnt lgkmcnt(15)
  v_mfma_f32_16x16x32_bf16 v[144:147], v[72:75], v[64:67], 0
  ds_read_b64_tr_b16 v[104:105], v20 offset:28160
  ds_read_b64_tr_b16 v[106:107], v20 offset:28600
  s_waitcnt lgkmcnt(15)
  v_mfma_f32_16x16x32_bf16 v[156:159], v[72:75], v[68:71], 0
  ds_read_b64_tr_b16 v[112:113], v19 offset:28160
  ds_read_b64_tr_b16 v[114:115], v19 offset:28600
  s_waitcnt lgkmcnt(15)
  v_mfma_f32_16x16x32_bf16 v[148:151], v[76:79], v[64:67], 0
  ds_read_b64_tr_b16 v[108:109], v21 offset:28160
  ds_read_b64_tr_b16 v[110:111], v21 offset:28600
  v_mfma_f32_16x16x32_bf16 v[160:163], v[76:79], v[68:71], 0
  ds_read_b64_tr_b16 v[116:117], v30 offset:28160
  ds_read_b64_tr_b16 v[118:119], v30 offset:28600
  s_waitcnt lgkmcnt(15)
  v_mfma_f32_16x16x32_bf16 v[152:155], v[80:83], v[64:67], 0
  ds_read_b64_tr_b16 v[120:121], v22 offset:28160
  ds_read_b64_tr_b16 v[122:123], v22 offset:28600
  v_mfma_f32_16x16x32_bf16 v[164:167], v[80:83], v[68:71], 0
  s_waitcnt lgkmcnt(15)
  v_mfma_f32_16x16x32_bf16 v[144:147], v[92:95], v[84:87], v[144:147]
  ds_read_b64_tr_b16 v[124:125], v20 offset:42240
  ds_read_b64_tr_b16 v[126:127], v20 offset:42680
  s_waitcnt lgkmcnt(15)
  v_mfma_f32_16x16x32_bf16 v[156:159], v[92:95], v[88:91], v[156:159]
  ds_read_b64_tr_b16 v[132:133], v19 offset:42240
  ds_read_b64_tr_b16 v[134:135], v19 offset:42680
  s_waitcnt lgkmcnt(15)
  v_mfma_f32_16x16x32_bf16 v[148:151], v[96:99], v[84:87], v[148:151]
  ds_read_b64_tr_b16 v[128:129], v21 offset:42240
  ds_read_b64_tr_b16 v[130:131], v21 offset:42680
  v_mfma_f32_16x16x32_bf16 v[160:163], v[96:99], v[88:91], v[160:163]
  ds_read_b64_tr_b16 v[136:137], v30 offset:42240
  ds_read_b64_tr_b16 v[138:139], v30 offset:42680
  s_waitcnt lgkmcnt(15)
  v_mfma_f32_16x16x32_bf16 v[152:155], v[100:103], v[84:87], v[152:155]
  ds_read_b64_tr_b16 v[140:141], v22 offset:42240
  ds_read_b64_tr_b16 v[142:143], v22 offset:42680
  v_mfma_f32_16x16x32_bf16 v[164:167], v[100:103], v[88:91], v[164:167]
  s_waitcnt lgkmcnt(15)
  v_mfma_f32_16x16x32_bf16 v[144:147], v[112:115], v[104:107], v[144:147]
  s_waitcnt lgkmcnt(14)
  v_mfma_f32_16x16x32_bf16 v[156:159], v[112:115], v[108:111], v[156:159]
  s_waitcnt lgkmcnt(12)
  v_mfma_f32_16x16x32_bf16 v[148:151], v[116:119], v[104:107], v[148:151]
  v_mfma_f32_16x16x32_bf16 v[160:163], v[116:119], v[108:111], v[160:163]
  s_waitcnt lgkmcnt(10)
  v_mfma_f32_16x16x32_bf16 v[152:155], v[120:123], v[104:107], v[152:155]
  v_mfma_f32_16x16x32_bf16 v[164:167], v[120:123], v[108:111], v[164:167]
  s_waitcnt lgkmcnt(6)
  v_mfma_f32_16x16x32_bf16 v[144:147], v[132:135], v[124:127], v[144:147]
  s_waitcnt lgkmcnt(4)
  v_mfma_f32_16x16x32_bf16 v[156:159], v[132:135], v[128:131], v[156:159]
  s_waitcnt lgkmcnt(2)
  v_mfma_f32_16x16x32_bf16 v[148:151], v[136:139], v[124:127], v[148:151]
  v_mfma_f32_16x16x32_bf16 v[160:163], v[136:139], v[128:131], v[160:163]
  s_waitcnt lgkmcnt(0)
  v_mfma_f32_16x16x32_bf16 v[152:155], v[140:143], v[124:127], v[152:155]
  v_mfma_f32_16x16x32_bf16 v[164:167], v[140:143], v[128:131], v[164:167]
  v_cvt_pk_bf16_f32 v168, v144, v145
  v_cvt_pk_bf16_f32 v169, v146, v147
  s_nop 1
  v_cvt_pk_bf16_f32 v170, v148, v149
  v_cvt_pk_bf16_f32 v171, v150, v151
  s_nop 0
  v_cvt_pk_bf16_f32 v172, v152, v153
  v_cvt_pk_bf16_f32 v173, v154, v155
  buffer_store_dwordx4 v[168:171], v23, s[52:55], s27 offen sc1
  buffer_store_dwordx2 v[172:173], v24, s[52:55], s27 offen sc1
  v_cvt_pk_bf16_f32 v174, v156, v157
  v_cvt_pk_bf16_f32 v175, v158, v159
  v_cvt_pk_bf16_f32 v176, v160, v161
  v_cvt_pk_bf16_f32 v177, v162, v163
  v_cvt_pk_bf16_f32 v178, v164, v165
  v_cvt_pk_bf16_f32 v179, v166, v167
  buffer_store_dwordx4 v[174:177], v25, s[52:55], s27 offen sc1
  buffer_store_dwordx2 v[178:179], v26, s[52:55], s27 offen sc1
  s_setprio 0
  v_and_b32 v47, 0x80808080, v31
  v_cmp_ne_u32 vcc, 0x80808080, v47
  s_nop 0
  s_cbranch_vccnz L_ic1B
L_ic_ok1B:
  s_getreg_b32 s13, hwreg(HW_REG_XCC_ID, 0, 4)
  s_or_b32 s13, s13, 0x80
  s_mul_i32 s13, s13, 0x01010101
  v_cmp_eq_u32 vcc, s13, v31
  s_lshl_b32 s14, s5, 1
  s_lshr_b32 s15, vcc_lo, s14
  s_and_b32 s15, s15, 3
  s_cmp_eq_u32 s15, 3
  s_cselect_b32 s79, 1, 0
  v_mov_b32 v47, s79
  v_mov_b32 v46, 163832
  ds_write_b32 v46, v47
  s_add_u32 s13, s52, 2097152
  s_addc_u32 s14, s53, 0
  s_cmp_eq_u32 s79, 0
  s_cselect_b32 s56, s13, s0
  s_cselect_b32 s57, s14, s1
  s_mov_b32 s58, 4718592
  s_mov_b32 s59, 0x20000
  s_waitcnt vmcnt(5)
  s_waitcnt lgkmcnt(0)
  s_mov_b32 s12, s6
  v_mov_b32 v64, 0
  v_mov_b32 v65, 0
  v_mov_b32 v130, 0
  v_mov_b32 v131, 0
  v_mov_b32 v132, 0
  v_mov_b32 v133, 0
  v_mov_b32 v198, 0
  v_mov_b32 v199, 0
  s_add_u32 s13, s29, 18432
  s_add_u32 s14, s29, 36864
  s_add_u32 s15, s29, 55296
  s_add_u32 s3, s30, 36864
  s_cmp_eq_u32 s79, 0
  s_cbranch_scc1 L_dpfB
  buffer_store_dwordx4 v[48:51], v255, s[56:59], s29 offen
  buffer_store_dwordx4 v[48:51], v255, s[56:59], s13 offen
  buffer_store_dwordx4 v[48:51], v255, s[56:59], s14 offen
  buffer_store_dwordx4 v[48:51], v255, s[56:59], s15 offen
  s_mov_b64 exec, 0xffff
  buffer_store_dwordx4 v[48:51], v255, s[56:59], s30 offen
  buffer_store_dwordx4 v[48:51], v255, s[56:59], s3 offen
  s_mov_b64 exec, -1
L_d_okpfB:
  s_barrier
  s_add_u32 m0, s68, 82944
  s_nop 0
  buffer_load_dwordx4 v10, s[44:47], s67 offen offset:0 lds
  buffer_load_dwordx4 v11, s[44:47], s67 offen offset:1024 lds
  s_mov_b64 exec, 0xffff
  buffer_load_dwordx4 v12, s[44:47], s67 offen offset:2048 lds
  s_mov_b64 exec, -1
  s_add_u32 s12, s12, 1
  s_cmp_eq_u32 s12, 8
  s_cselect_b32 s14, 663552, 0
  s_add_u32 s67, s67, 82944
  s_sub_u32 s67, s67, s14
  s_add_u32 m0, s68, 92160
  s_nop 0
  buffer_load_dwordx4 v10, s[44:47], s67 offen offset:0 lds
  buffer_load_dwordx4 v11, s[44:47], s67 offen offset:1024 lds
  s_mov_b64 exec, 0xffff
  buffer_load_dwordx4 v12, s[44:47], s67 offen offset:2048 lds
  s_mov_b64 exec, -1
  s_add_u32 s12, s12, 1
  s_cmp_eq_u32 s12, 8
  s_cselect_b32 s14, 663552, 0
  s_add_u32 s67, s67, 82944
  s_sub_u32 s67, s67, s14
  s_add_u32 m0, s68, 101376
  s_nop 0
  buffer_load_dwordx4 v10, s[44:47], s67 offen offset:0 lds
  buffer_load_dwordx4 v11, s[44:47], s67 offen offset:1024 lds
  s_mov_b64 exec, 0xffff
  buffer_load_dwordx4 v12, s[44:47], s67 offen offset:2048 lds
  s_mov_b64 exec, -1
  s_add_u32 s12, s12, 1
  s_cmp_eq_u32 s12, 8
  s_cselect_b32 s14, 663552, 0
  s_add_u32 s67, s67, 82944
  s_sub_u32 s67, s67, s14
  s_lshl_b32 s14, s8, 2
  s_add_u32 s66, s27, 5504
  s_add_u32 s66, s66, s14
  s_mul_i32 s11, s5, 5632
  s_add_u32 s11, s11, 726400
  s_add_u32 s11, s11, s14
  v_mov_b32 v1, 1
  v_and_b32 v32, 7, v0
  s_mov_b32 s14, 90112
  v_mul_lo_u32 v32, v32, s14
  s_waitcnt vmcnt(9)
  s_cmp_eq_u32 s79, 0
  s_cbranch_scc1 L_df2B
  s_mov_b64 exec, 1
  buffer_store_dword v1, v18, s[52:55], s66 offen
  s_mov_b64 exec, -1
L_d_okf2B:
  v_and_b32 v19, 1, v0
  v_and_b32 v26, 2, v0
  v_lshl_add_u32 v19, v26, 3, v19
  v_mul_u32_u24 v19, 2304, v19
  s_mov_b64 exec, 15
  buffer_load_dword v19, v19, s[56:59], s30 offen
  s_mov_b64 exec, -1
  s_and_b32 s69, s5, 3
  s_lshl_b32 s69, s69, 2
  s_mul_i32 s10, s69, 5632
  s_add_u32 s10, s10, s26
  buffer_load_dwordx4 v[66:69], v27, s[52:55], s10 offen sc1
  buffer_load_dwordx4 v[134:137], v28, s[52:55], s10 offen sc1
  s_barrier
  s_setprio 2
  ds_read_b128 v[20:23], v252 offset:0
  ds_read_b128 v[2:5], v252 offset:1024
  ds_read_b128 v[6:9], v253
  s_waitcnt lgkmcnt(2)
  v_mfma_f32_16x16x32_bf16 v[230:233], v[200:203], v[20:23], 0
  v_mfma_f32_16x16x32_bf16 v[234:237], v[206:209], v[20:23], 0
  v_mfma_f32_16x16x32_bf16 v[238:241], v[212:215], v[20:23], 0
  v_mfma_f32_16x16x32_bf16 v[242:245], v[218:221], v[20:23], 0
  v_mfma_f32_16x16x32_bf16 v[246:249], v[224:227], v[20:23], 0
  s_waitcnt lgkmcnt(1)
  v_mfma_f32_16x16x32_bf16 v[40:43], v[200:203], v[2:5], 0
  v_mfma_f32_16x16x32_bf16 v[44:47], v[206:209], v[2:5], 0
  v_mfma_f32_16x16x32_bf16 v[48:51], v[212:215], v[2:5], 0
  v_mfma_f32_16x16x32_bf16 v[52:55], v[218:221], v[2:5], 0
  v_mfma_f32_16x16x32_bf16 v[56:59], v[224:227], v[2:5], 0
  s_waitcnt lgkmcnt(0)
  v_mfma_f32_16x16x16_bf16 v[230:233], v[204:205], v[6:7], v[230:233]
  v_mfma_f32_16x16x16_bf16 v[234:237], v[210:211], v[6:7], v[234:237]
  s_add_u32 s10, s10, 5632
  buffer_load_dwordx4 v[70:73], v27, s[52:55], s10 offen sc1
  buffer_load_dwordx4 v[138:141], v28, s[52:55], s10 offen sc1
  v_mfma_f32_16x16x16_bf16 v[238:241], v[216:217], v[6:7], v[238:241]
  v_mfma_f32_16x16x16_bf16 v[242:245], v[222:223], v[6:7], v[242:245]
  v_mfma_f32_16x16x16_bf16 v[246:249], v[228:229], v[6:7], v[246:249]
  v_mfma_f32_16x16x16_bf16 v[40:43], v[204:205], v[8:9], v[40:43]
  v_mfma_f32_16x16x16_bf16 v[44:47], v[210:211], v[8:9], v[44:47]
  v_mfma_f32_16x16x16_bf16 v[48:51], v[216:217], v[8:9], v[48:51]
  v_mfma_f32_16x16x16_bf16 v[52:55], v[222:223], v[8:9], v[52:55]
  v_mfma_f32_16x16x16_bf16 v[56:59], v[228:229], v[8:9], v[56:59]
  v_max3_f32 v24, v230, v231, v232
  v_max3_f32 v25, v233, v234, v235
  v_max3_f32 v24, v236, v237, v24
  s_add_u32 s10, s10, 5632
  buffer_load_dwordx4 v[74:77], v27, s[52:55], s10 offen sc1
  buffer_load_dwordx4 v[142:145], v28, s[52:55], s10 offen sc1
  v_max3_f32 v25, v238, v239, v25
  v_max3_f32 v24, v240, v241, v24
  v_max3_f32 v25, v242, v243, v25
  v_max3_f32 v24, v244, v245, v24
  v_max3_f32 v25, v246, v247, v25
  v_max_f32 v24, v24, v25
  v_mul_f32 v24, s76, v24
  v_fma_f32 v230, v230, s76, -v24
  v_fma_f32 v231, v231, s76, -v24
  v_fma_f32 v232, v232, s76, -v24
  v_fma_f32 v233, v233, s76, -v24
  s_add_u32 s10, s10, 5632
  buffer_load_dwordx4 v[78:81], v27, s[52:55], s10 offen sc1
  buffer_load_dwordx4 v[146:149], v28, s[52:55], s10 offen sc1
  v_fma_f32 v234, v234, s76, -v24
  v_fma_f32 v235, v235, s76, -v24
  v_fma_f32 v236, v236, s76, -v24
  v_fma_f32 v237, v237, s76, -v24
  v_fma_f32 v238, v238, s76, -v24
  v_fma_f32 v239, v239, s76, -v24
  v_fma_f32 v240, v240, s76, -v24
  v_fma_f32 v241, v241, s76, -v24
  v_fma_f32 v242, v242, s76, -v24
  v_fma_f32 v243, v243, s76, -v24
  v_fma_f32 v244, v244, s76, -v24
  s_add_u32 s69, s69, 4
  s_and_b32 s69, s69, 15
  s_mul_i32 s10, s69, 5632
  s_add_u32 s10, s10, s26
  buffer_load_dwordx4 v[82:85], v27, s[52:55], s10 offen sc1
  buffer_load_dwordx4 v[150:153], v28, s[52:55], s10 offen sc1
  v_fma_f32 v245, v245, s76, -v24
  v_fma_f32 v246, v246, s76, -v24
  v_fma_f32 v247, v247, s76, -v24
  v_exp_f32 v230, v230
  v_exp_f32 v231, v231
  v_exp_f32 v232, v232
  v_exp_f32 v233, v233
  v_exp_f32 v234, v234
  v_exp_f32 v235, v235
  v_exp_f32 v236, v236
  v_exp_f32 v237, v237
  s_add_u32 s10, s10, 5632
  buffer_load_dwordx4 v[86:89], v27, s[52:55], s10 offen sc1
  buffer_load_dwordx4 v[154:157], v28, s[52:55], s10 offen sc1
  v_exp_f32 v238, v238
  v_exp_f32 v239, v239
  v_exp_f32 v240, v240
  v_exp_f32 v241, v241
  v_exp_f32 v242, v242
  v_exp_f32 v243, v243
  v_exp_f32 v244, v244
  v_exp_f32 v245, v245
  v_exp_f32 v246, v246
  v_exp_f32 v247, v247
  v_add_f32 v24, v230, v232
  s_add_u32 s10, s10, 5632
  buffer_load_dwordx4 v[90:93], v27, s[52:55], s10 offen sc1
  buffer_load_dwordx4 v[158:161], v28, s[52:55], s10 offen sc1
  v_add_f32 v25, v231, v233
  v_add_f32 v24, v24, v234
  v_add_f32 v25, v25, v235
  v_add_f32 v24, v24, v236
  v_add_f32 v25, v25, v237
  v_add_f32 v24, v24, v238
  v_add_f32 v25, v25, v239
  v_add_f32 v24, v24, v240
  v_add_f32 v25, v25, v241
  v_add_f32 v24, v24, v242
  v_add_f32 v25, v25, v243
  s_add_u32 s10, s10, 5632
  buffer_load_dwordx4 v[94:97], v27, s[52:55], s10 offen sc1
  buffer_load_dwordx4 v[162:165], v28, s[52:55], s10 offen sc1
  v_add_f32 v24, v24, v244
  v_add_f32 v25, v25, v245
  v_add_f32 v24, v24, v246
  v_add_f32 v25, v25, v247
  v_add_f32 v24, v24, v25
  v_rcp_f32 v24, v24
  s_nop 0
  v_mul_f32 v230, v230, v24
  v_mul_f32 v231, v231, v24
  v_mul_f32 v232, v232, v24
  v_mul_f32 v233, v233, v24
  v_mul_f32 v234, v234, v24
  s_add_u32 s69, s69, 4
  s_and_b32 s69, s69, 15
  s_mul_i32 s10, s69, 5632
  s_add_u32 s10, s10, s26
  buffer_load_dwordx4 v[98:101], v27, s[52:55], s10 offen sc1
  buffer_load_dwordx4 v[166:169], v28, s[52:55], s10 offen sc1
  v_mul_f32 v235, v235, v24
  v_mul_f32 v236, v236, v24
  v_mul_f32 v237, v237, v24
  v_mul_f32 v238, v238, v24
  v_mul_f32 v239, v239, v24
  v_mul_f32 v240, v240, v24
  v_mul_f32 v241, v241, v24
  v_mul_f32 v242, v242, v24
  v_mul_f32 v243, v243, v24
  v_mul_f32 v244, v244, v24
  v_mul_f32 v245, v245, v24
  v_mul_f32 v246, v246, v24
  s_add_u32 s10, s10, 5632
  buffer_load_dwordx4 v[102:105], v27, s[52:55], s10 offen sc1
  buffer_load_dwordx4 v[170:173], v28, s[52:55], s10 offen sc1
  v_mul_f32 v247, v247, v24
  v_cvt_pk_bf16_f32 v230, v230, v231
  v_cvt_pk_bf16_f32 v231, v232, v233
  v_cvt_pk_bf16_f32 v232, v234, v235
  v_cvt_pk_bf16_f32 v233, v236, v237
  v_cvt_pk_bf16_f32 v234, v238, v239
  v_cvt_pk_bf16_f32 v235, v240, v241
  v_cvt_pk_bf16_f32 v236, v242, v243
  v_cvt_pk_bf16_f32 v237, v244, v245
  v_cvt_pk_bf16_f32 v238, v246, v247
  v_mov_b32 v239, 0
  s_add_u32 s10, s10, 5632
  buffer_load_dwordx4 v[106:109], v27, s[52:55], s10 offen sc1
  buffer_load_dwordx4 v[174:177], v28, s[52:55], s10 offen sc1
  v_max3_f32 v24, v40, v41, v42
  v_max3_f32 v25, v43, v44, v45
  v_max3_f32 v24, v46, v47, v24
  v_max3_f32 v25, v48, v49, v25
  v_max3_f32 v24, v50, v51, v24
  v_max3_f32 v25, v52, v53, v25
  v_max3_f32 v24, v54, v55, v24
  v_max3_f32 v25, v56, v57, v25
  v_max_f32 v24, v24, v25
  v_mul_f32 v24, s76, v24
  v_pk_fma_f32 v[40:41], v[40:41], s[76:77], v[24:25] op_sel_hi:[1,1,0] neg_lo:[0,0,1] neg_hi:[0,0,1]
  s_add_u32 s10, s10, 5632
  buffer_load_dwordx4 v[110:113], v27, s[52:55], s10 offen sc1
  buffer_load_dwordx4 v[178:181], v28, s[52:55], s10 offen sc1
  v_pk_fma_f32 v[42:43], v[42:43], s[76:77], v[24:25] op_sel_hi:[1,1,0] neg_lo:[0,0,1] neg_hi:[0,0,1]
  v_pk_fma_f32 v[44:45], v[44:45], s[76:77], v[24:25] op_sel_hi:[1,1,0] neg_lo:[0,0,1] neg_hi:[0,0,1]
  v_pk_fma_f32 v[46:47], v[46:47], s[76:77], v[24:25] op_sel_hi:[1,1,0] neg_lo:[0,0,1] neg_hi:[0,0,1]
  v_pk_fma_f32 v[48:49], v[48:49], s[76:77], v[24:25] op_sel_hi:[1,1,0] neg_lo:[0,0,1] neg_hi:[0,0,1]
  v_pk_fma_f32 v[50:51], v[50:51], s[76:77], v[24:25] op_sel_hi:[1,1,0] neg_lo:[0,0,1] neg_hi:[0,0,1]
  v_pk_fma_f32 v[52:53], v[52:53], s[76:77], v[24:25] op_sel_hi:[1,1,0] neg_lo:[0,0,1] neg_hi:[0,0,1]
  v_pk_fma_f32 v[54:55], v[54:55], s[76:77], v[24:25] op_sel_hi:[1,1,0] neg_lo:[0,0,1] neg_hi:[0,0,1]
  v_pk_fma_f32 v[56:57], v[56:57], s[76:77], v[24:25] op_sel_hi:[1,1,0] neg_lo:[0,0,1] neg_hi:[0,0,1]
  v_exp_f32 v40, v40
  v_exp_f32 v41, v41
  v_exp_f32 v42, v42
  s_add_u32 s69, s69, 4
  s_and_b32 s69, s69, 15
  s_mul_i32 s10, s69, 5632
  s_add_u32 s10, s10, s26
  buffer_load_dwordx4 v[114:117], v27, s[52:55], s10 offen sc1
  buffer_load_dwordx4 v[182:185], v28, s[52:55], s10 offen sc1
  v_exp_f32 v43, v43
  v_exp_f32 v44, v44
  v_exp_f32 v45, v45
  v_exp_f32 v46, v46
  v_exp_f32 v47, v47
  v_exp_f32 v48, v48
  v_exp_f32 v49, v49
  v_exp_f32 v50, v50
  v_exp_f32 v51, v51
  v_exp_f32 v52, v52
  v_exp_f32 v53, v53
  s_add_u32 s10, s10, 5632
  buffer_load_dwordx4 v[118:121], v27, s[52:55], s10 offen sc1
  buffer_load_dwordx4 v[186:189], v28, s[52:55], s10 offen sc1
  v_exp_f32 v54, v54
  v_exp_f32 v55, v55
  v_exp_f32 v56, v56
  v_exp_f32 v57, v57
  v_pk_add_f32 v[24:25], v[40:41], v[42:43]
  v_pk_add_f32 v[24:25], v[24:25], v[44:45]
  v_pk_add_f32 v[24:25], v[24:25], v[46:47]
  v_pk_add_f32 v[24:25], v[24:25], v[48:49]
  v_pk_add_f32 v[24:25], v[24:25], v[50:51]
  v_pk_add_f32 v[24:25], v[24:25], v[52:53]
  v_pk_add_f32 v[24:25], v[24:25], v[54:55]
  s_add_u32 s10, s10, 5632
  buffer_load_dwordx4 v[122:125], v27, s[52:55], s10 offen sc1
  buffer_load_dwordx4 v[190:193], v28, s[52:55], s10 offen sc1
  v_pk_add_f32 v[24:25], v[24:25], v[56:57]
  v_add_f32 v24, v24, v25
  v_rcp_f32 v24, v24
  s_nop 0
  v_pk_mul_f32 v[40:41], v[40:41], v[24:25] op_sel_hi:[1,0]
  v_pk_mul_f32 v[42:43], v[42:43], v[24:25] op_sel_hi:[1,0]
  v_pk_mul_f32 v[44:45], v[44:45], v[24:25] op_sel_hi:[1,0]
  v_pk_mul_f32 v[46:47], v[46:47], v[24:25] op_sel_hi:[1,0]
  v_pk_mul_f32 v[48:49], v[48:49], v[24:25] op_sel_hi:[1,0]
  v_pk_mul_f32 v[50:51], v[50:51], v[24:25] op_sel_hi:[1,0]
  v_pk_mul_f32 v[52:53], v[52:53], v[24:25] op_sel_hi:[1,0]
  v_pk_mul_f32 v[54:55], v[54:55], v[24:25] op_sel_hi:[1,0]
  s_add_u32 s10, s10, 5632
  buffer_load_dwordx4 v[126:129], v27, s[52:55], s10 offen sc1
  buffer_load_dwordx4 v[194:197], v28, s[52:55], s10 offen sc1
  v_pk_mul_f32 v[56:57], v[56:57], v[24:25] op_sel_hi:[1,0]
  v_cvt_pk_bf16_f32 v40, v40, v41
  v_cvt_pk_bf16_f32 v41, v42, v43
  v_cvt_pk_bf16_f32 v42, v44, v45
  v_cvt_pk_bf16_f32 v43, v46, v47
  v_cvt_pk_bf16_f32 v44, v48, v49
  v_cvt_pk_bf16_f32 v45, v50, v51
  v_cvt_pk_bf16_f32 v46, v52, v53
  v_cvt_pk_bf16_f32 v47, v54, v55
  v_cvt_pk_bf16_f32 v48, v56, v57
  v_mov_b32 v49, 0
  s_waitcnt vmcnt(31)
  v_mfma_f32_16x16x32_bf16 v[240:243], v[36:39], v[64:67], 0
  v_mov_b32 v200, 0
  s_waitcnt vmcnt(30)
  v_mfma_f32_16x16x32_bf16 v[50:53], v[36:39], v[132:135], 0
  v_mov_b32 v201, 0
  s_waitcnt vmcnt(29)
  v_mfma_f32_16x16x32_bf16 v[244:247], v[36:39], v[68:71], 0
  v_mov_b32 v202, 0
  s_waitcnt vmcnt(28)
  v_mfma_f32_16x16x32_bf16 v[54:57], v[36:39], v[136:139], 0
  v_mov_b32 v203, 0
  s_waitcnt vmcnt(27)
  v_mfma_f32_16x16x32_bf16 v[240:243], v[36:39], v[72:75], v[240:243]
  v_mov_b32 v204, 0
  s_waitcnt vmcnt(26)
  v_mfma_f32_16x16x32_bf16 v[50:53], v[36:39], v[140:143], v[50:53]
  v_mov_b32 v205, 0
  s_waitcnt vmcnt(25)
  v_mfma_f32_16x16x32_bf16 v[244:247], v[36:39], v[76:79], v[244:247]
  v_mov_b32 v206, 0
  s_waitcnt vmcnt(24)
  v_mfma_f32_16x16x32_bf16 v[54:57], v[36:39], v[144:147], v[54:57]
  v_mov_b32 v207, 0
  s_add_u32 m0, s68, 110592
  s_nop 0
  buffer_load_dwordx4 v10, s[44:47], s67 offen offset:0 lds
  s_waitcnt vmcnt(24)
  v_mfma_f32_16x16x32_bf16 v[240:243], v[36:39], v[80:83], v[240:243]
  v_mov_b32 v208, 0
  s_waitcnt vmcnt(23)
  v_mfma_f32_16x16x32_bf16 v[50:53], v[36:39], v[148:151], v[50:53]
  v_mov_b32 v209, 0
  s_waitcnt vmcnt(22)
  v_mfma_f32_16x16x32_bf16 v[244:247], v[36:39], v[84:87], v[244:247]
  v_mov_b32 v210, 0
  s_waitcnt vmcnt(21)
  v_mfma_f32_16x16x32_bf16 v[54:57], v[36:39], v[152:155], v[54:57]
  v_mov_b32 v211, 0
  s_waitcnt vmcnt(20)
  v_mfma_f32_16x16x32_bf16 v[240:243], v[36:39], v[88:91], v[240:243]
  v_mov_b32 v212, 0
  s_waitcnt vmcnt(19)
  v_mfma_f32_16x16x32_bf16 v[50:53], v[36:39], v[156:159], v[50:53]
  v_mov_b32 v213, 0
  s_waitcnt vmcnt(18)
  v_mfma_f32_16x16x32_bf16 v[244:247], v[36:39], v[92:95], v[244:247]
  v_mov_b32 v214, 0
  s_waitcnt vmcnt(17)
  v_mfma_f32_16x16x32_bf16 v[54:57], v[36:39], v[160:163], v[54:57]
  v_mov_b32 v215, 0
  buffer_load_dwordx4 v11, s[44:47], s67 offen offset:1024 lds
  s_waitcnt vmcnt(17)
  v_mfma_f32_16x16x32_bf16 v[240:243], v[36:39], v[96:99], v[240:243]
  v_mov_b32 v216, 0
  s_waitcnt vmcnt(16)
  v_mfma_f32_16x16x32_bf16 v[50:53], v[36:39], v[164:167], v[50:53]
  v_mov_b32 v217, 0
  s_waitcnt vmcnt(15)
  v_mfma_f32_16x16x32_bf16 v[244:247], v[36:39], v[100:103], v[244:247]
  v_mov_b32 v218, 0
  s_waitcnt vmcnt(14)
  v_mfma_f32_16x16x32_bf16 v[54:57], v[36:39], v[168:171], v[54:57]
  v_mov_b32 v219, 0
  s_waitcnt vmcnt(13)
  v_mfma_f32_16x16x32_bf16 v[240:243], v[36:39], v[104:107], v[240:243]
  v_mov_b32 v220, 0
  s_waitcnt vmcnt(12)
  v_mfma_f32_16x16x32_bf16 v[50:53], v[36:39], v[172:175], v[50:53]
  v_mov_b32 v221, 0
  s_waitcnt vmcnt(11)
  v_mfma_f32_16x16x32_bf16 v[244:247], v[36:39], v[108:111], v[244:247]
  v_mov_b32 v222, 0
  s_waitcnt vmcnt(10)
  v_mfma_f32_16x16x32_bf16 v[54:57], v[36:39], v[176:179], v[54:57]
  v_mov_b32 v223, 0
  s_mov_b64 exec, 0xffff
  buffer_load_dwordx4 v12, s[44:47], s67 offen offset:2048 lds
  s_mov_b64 exec, -1
  s_add_u32 s12, s12, 1
  s_cmp_eq_u32 s12, 8
  s_cselect_b32 s14, 663552, 0
  s_add_u32 s67, s67, 82944
  s_sub_u32 s67, s67, s14
  s_waitcnt vmcnt(10)
  v_mfma_f32_16x16x32_bf16 v[240:243], v[36:39], v[112:115], v[240:243]
  v_mov_b32 v224, 0
  s_waitcnt vmcnt(9)
  v_mfma_f32_16x16x32_bf16 v[50:53], v[36:39], v[180:183], v[50:53]
  v_mov_b32 v225, 0
  s_waitcnt vmcnt(8)
  v_mfma_f32_16x16x32_bf16 v[244:247], v[36:39], v[116:119], v[244:247]
  v_mov_b32 v226, 0
  s_waitcnt vmcnt(7)
  v_mfma_f32_16x16x32_bf16 v[54:57], v[36:39], v[184:187], v[54:57]
  v_mov_b32 v227, 0
  s_waitcnt vmcnt(6)
  v_mfma_f32_16x16x32_bf16 v[240:243], v[36:39], v[120:123], v[240:243]
  v_mov_b32 v228, 0
  s_waitcnt vmcnt(5)
  v_mfma_f32_16x16x32_bf16 v[50:53], v[36:39], v[188:191], v[50:53]
  v_mov_b32 v229, 0
  s_waitcnt vmcnt(4)
  v_mfma_f32_16x16x32_bf16 v[244:247], v[36:39], v[124:127], v[244:247]
  s_waitcnt vmcnt(3)
  v_mfma_f32_16x16x32_bf16 v[54:57], v[36:39], v[192:195], v[54:57]
  v_mfma_f32_16x16x32_bf16 v[240:243], v[36:39], v[128:131], v[240:243]
  v_mfma_f32_16x16x32_bf16 v[50:53], v[36:39], v[196:199], v[50:53]
  s_nop 6
  v_cmp_u_f32 vcc, v240, v244
  v_cmp_u_f32 s[72:73], v50, v54
  s_nop 0
  s_or_b64 vcc, vcc, s[72:73]
  s_nop 0
  s_cbranch_vccnz L_gB
L_g_okB:
  v_cvt_pk_bf16_f32 v64, v240, v241
  v_cvt_pk_bf16_f32 v65, v242, v243
  v_cvt_pk_bf16_f32 v66, v244, v245
  v_cvt_pk_bf16_f32 v67, v246, v247
  ds_write_b128 v29, v[64:67] offset:0
  v_cvt_pk_bf16_f32 v68, v50, v51
  v_cvt_pk_bf16_f32 v69, v52, v53
  v_cvt_pk_bf16_f32 v70, v54, v55
  v_cvt_pk_bf16_f32 v71, v56, v57
  s_mov_b64 exec, s[32:33]
  ds_write_b128 v29, v[68:71] offset:1024
  s_mov_b64 exec, -1
  s_add_u32 m0, s68, 119808
  s_nop 0
  buffer_load_dwordx4 v10, s[44:47], s67 offen offset:0 lds
  buffer_load_dwordx4 v11, s[44:47], s67 offen offset:1024 lds
  s_mov_b64 exec, 0xffff
  buffer_load_dwordx4 v12, s[44:47], s67 offen offset:2048 lds
  s_mov_b64 exec, -1
  s_add_u32 s12, s12, 1
  s_cmp_eq_u32 s12, 8
  s_cselect_b32 s14, 663552, 0
  s_add_u32 s67, s67, 82944
  s_sub_u32 s67, s67, s14
  s_add_u32 m0, s68, 129024
  s_nop 0
  buffer_load_dwordx4 v10, s[44:47], s67 offen offset:0 lds
  buffer_load_dwordx4 v11, s[44:47], s67 offen offset:1024 lds
  s_mov_b64 exec, 0xffff
  buffer_load_dwordx4 v12, s[44:47], s67 offen offset:2048 lds
  s_mov_b64 exec, -1
  s_add_u32 s12, s12, 1
  s_cmp_eq_u32 s12, 8
  s_cselect_b32 s14, 663552, 0
  s_add_u32 s67, s67, 82944
  s_sub_u32 s67, s67, s14
  buffer_load_dword v31, v32, s[52:55], s11 offen sc1
  s_waitcnt lgkmcnt(0)
  s_barrier
  s_mov_b64 exec, s[16:17]
  ds_read_b128 v[220:223], v61 offset:0
  ds_read_b128 v[200:203], v60 offset:0
  ds_read_b128 v[210:213], v60 offset:64
  ds_read_b128 v[224:227], v61 offset:304
  ds_read_b128 v[204:207], v60 offset:304
  ds_read_b128 v[214:217], v60 offset:368
  ds_read_b32 v228, v63 offset:0
  ds_read_b32 v208, v62 offset:0
  ds_read_b32 v218, v62 offset:32
  s_mov_b64 exec, -1
  s_add_u32 m0, s68, 0
  s_nop 0
  buffer_load_dwordx4 v10, s[44:47], s67 offen offset:0 lds
  buffer_load_dwordx4 v11, s[44:47], s67 offen offset:1024 lds
  s_mov_b64 exec, 0xffff
  buffer_load_dwordx4 v12, s[44:47], s67 offen offset:2048 lds
  s_mov_b64 exec, -1
  s_add_u32 s12, s12, 1
  s_cmp_eq_u32 s12, 8
  s_cselect_b32 s14, 663552, 0
  s_add_u32 s67, s67, 82944
  s_sub_u32 s67, s67, s14
  s_add_u32 m0, s68, 9216
  s_nop 0
  buffer_load_dwordx4 v10, s[44:47], s67 offen offset:0 lds
  buffer_load_dwordx4 v11, s[44:47], s67 offen offset:1024 lds
  s_mov_b64 exec, 0xffff
  buffer_load_dwordx4 v12, s[44:47], s67 offen offset:2048 lds
  s_mov_b64 exec, -1
  s_add_u32 s12, s12, 1
  s_cmp_eq_u32 s12, 8
  s_cselect_b32 s14, 663552, 0
  s_add_u32 s67, s67, 82944
  s_sub_u32 s67, s67, s14
  s_and_b32 s14, s8, 1
  s_mul_i32 s67, s14, 144
  s_and_b32 s14, s8, 2
  s_mul_i32 s14, s14, 18
  s_add_u32 s67, s67, s14
  s_add_u32 s67, s67, 16
  s_mul_i32 s67, s67, 1152
  s_mul_i32 s14, s6, 144
  s_add_u32 s67, s67, s14
  s_add_u32 m0, s68, 18432
  s_nop 0
  buffer_load_dwordx4 v13, s[44:47], s67 offen offset:0 lds
  buffer_load_dwordx4 v14, s[44:47], s67 offen offset:1024 lds
  s_mov_b64 exec, 0xffff
  buffer_load_dwordx4 v15, s[44:47], s67 offen offset:2048 lds
  s_mov_b64 exec, -1
  s_add_u32 s69, s29, 55296
  s_add_u32 s29, s29, 18432
  s_waitcnt lgkmcnt(8)
  v_mfma_f32_16x16x32_bf16 v[80:83], v[220:223], v[230:233], 0
  s_add_u32 s3, s6, 1
  s_and_b32 s3, s3, 7
  s_waitcnt lgkmcnt(7)
  v_mfma_f32_16x16x32_bf16 v[72:75], v[200:203], v[230:233], 0
  s_lshl_b32 s3, s3, 7
  s_add_u32 s37, s3, s28
  s_waitcnt lgkmcnt(6)
  v_mfma_f32_16x16x32_bf16 v[76:79], v[210:213], v[230:233], 0
  s_add_u32 s3, s6, 2
  s_and_b32 s3, s3, 7
  v_mfma_f32_16x16x32_bf16 v[92:95], v[220:223], v[40:43], 0
  s_lshl_b32 s3, s3, 7
  s_add_u32 s38, s3, s28
  v_mfma_f32_16x16x32_bf16 v[84:87], v[200:203], v[40:43], 0
  s_add_u32 s3, s6, 3
  s_and_b32 s3, s3, 7
  v_mfma_f32_16x16x32_bf16 v[88:91], v[210:213], v[40:43], 0
  s_lshl_b32 s3, s3, 7
  s_add_u32 s39, s3, s28
  s_waitcnt lgkmcnt(5)
  v_mfma_f32_16x16x32_bf16 v[80:83], v[224:227], v[234:237], v[80:83]
  s_add_u32 s3, s6, 4
  s_and_b32 s3, s3, 7
  s_waitcnt lgkmcnt(4)
  v_mfma_f32_16x16x32_bf16 v[72:75], v[204:207], v[234:237], v[72:75]
  s_lshl_b32 s3, s3, 7
  s_add_u32 s40, s3, s28
  s_waitcnt lgkmcnt(3)
  v_mfma_f32_16x16x32_bf16 v[76:79], v[214:217], v[234:237], v[76:79]
  s_add_u32 s3, s6, 5
  s_and_b32 s3, s3, 7
  v_mfma_f32_16x16x32_bf16 v[92:95], v[224:227], v[44:47], v[92:95]
  s_lshl_b32 s3, s3, 7
  s_add_u32 s41, s3, s28
  v_mfma_f32_16x16x32_bf16 v[84:87], v[204:207], v[44:47], v[84:87]
  s_add_u32 s3, s6, 6
  s_and_b32 s3, s3, 7
  v_mfma_f32_16x16x32_bf16 v[88:91], v[214:217], v[44:47], v[88:91]
  s_lshl_b32 s3, s3, 7
  s_add_u32 s42, s3, s28
  s_waitcnt lgkmcnt(2)
  v_mfma_f32_16x16x16_bf16 v[80:83], v[228:229], v[238:239], v[80:83]
  s_add_u32 s3, s6, 7
  s_and_b32 s3, s3, 7
  s_waitcnt lgkmcnt(1)
  v_mfma_f32_16x16x16_bf16 v[72:75], v[208:209], v[238:239], v[72:75]
  s_lshl_b32 s3, s3, 7
  s_add_u32 s43, s3, s28
  s_waitcnt lgkmcnt(0)
  v_mfma_f32_16x16x16_bf16 v[76:79], v[218:219], v[238:239], v[76:79]
  s_add_u32 s36, s28, 1024
  s_add_u32 s3, s64, 28672
  v_mfma_f32_16x16x16_bf16 v[92:95], v[228:229], v[48:49], v[92:95]
  v_bfe_u32 v3, v0, 3, 2
  v_lshl_add_u32 v3, v3, 2, v18
  v_mfma_f32_16x16x16_bf16 v[84:87], v[208:209], v[48:49], v[84:87]
  v_add_u32 v2, s3, v3
  v_add_u32 v3, 54272, v2
  v_mfma_f32_16x16x16_bf16 v[88:91], v[218:219], v[48:49], v[88:91]
  v_add_f32 v80, s78, v80
  v_rcp_f32 v80, v80
  s_nop 0
  v_pk_mul_f32 v[72:73], v[72:73], v[80:81] op_sel_hi:[1,0]
  v_pk_mul_f32 v[74:75], v[74:75], v[80:81] op_sel_hi:[1,0]
  v_pk_mul_f32 v[76:77], v[76:77], v[80:81] op_sel_hi:[1,0]
  v_pk_mul_f32 v[78:79], v[78:79], v[80:81] op_sel_hi:[1,0]
  v_pk_mul_f32 v[82:83], v[82:83], v[80:81] op_sel_hi:[1,0]
  v_cvt_pk_bf16_f32 v96, v72, v73
  v_cvt_pk_bf16_f32 v97, v74, v75
  v_cvt_pk_bf16_f32 v98, v76, v77
  v_cvt_pk_bf16_f32 v99, v78, v79
  s_cmp_eq_u32 s79, 0
  s_cbranch_scc1 L_dho0
  buffer_store_dwordx4 v[96:99], v255, s[56:59], s29 offen
L_d_okho0:
  ds_write_b128 v252, v[96:99] offset:0
  v_cvt_pk_bf16_f32 v104, v82, v83
  v_mov_b32 v105, v104
  v_add_f32 v92, s78, v92
  v_rcp_f32 v92, v92
  s_nop 0
  v_pk_mul_f32 v[84:85], v[84:85], v[92:93] op_sel_hi:[1,0]
  v_pk_mul_f32 v[86:87], v[86:87], v[92:93] op_sel_hi:[1,0]
  v_pk_mul_f32 v[88:89], v[88:89], v[92:93] op_sel_hi:[1,0]
  v_pk_mul_f32 v[90:91], v[90:91], v[92:93] op_sel_hi:[1,0]
  v_pk_mul_f32 v[94:95], v[94:95], v[92:93] op_sel_hi:[1,0]
  v_cvt_pk_bf16_f32 v100, v84, v85
  v_cvt_pk_bf16_f32 v101, v86, v87
  v_cvt_pk_bf16_f32 v102, v88, v89
  v_cvt_pk_bf16_f32 v103, v90, v91
  s_cmp_eq_u32 s79, 0
  s_cbranch_scc1 L_dho1
  buffer_store_dwordx4 v[100:103], v255, s[56:59], s69 offen
L_d_okho1:
  ds_write_b128 v252, v[100:103] offset:1024
  v_cvt_pk_bf16_f32 v106, v94, v95
  v_mov_b32 v107, v106
  v_permlane32_swap_b32 v104, v105
  s_nop 0
  v_permlane32_swap_b32 v106, v107
  s_mov_b64 exec, 0xffff
  ds_write_b128 v253, v[104:107]
  s_mov_b64 exec, -1
  s_setprio 2
  s_waitcnt vmcnt(11)
  v_cmp_ne_u32 vcc, 1, v31
  s_nop 0
  s_cbranch_vccnz L_ic2B
L_ic_ok2B:
  s_waitcnt lgkmcnt(0)
  s_barrier
  s_add_u32 m0, s64, 28672
  s_add_u32 s13, s37, 17408
  buffer_load_dwordx4 v255, s[56:59], s37 offen sc1 lds
  buffer_load_dwordx4 v255, s[56:59], s13 offen offset:1024 sc1 lds
  s_add_u32 s13, s13, 17408
  buffer_load_dwordx4 v255, s[56:59], s13 offen offset:2048 sc1 lds
  s_add_u32 s13, s13, 17408
  buffer_load_dwordx4 v255, s[56:59], s13 offen offset:3072 sc1 lds
  s_add_u32 m0, s64, 45056
  s_add_u32 s13, s38, 17408
  buffer_load_dwordx4 v255, s[56:59], s38 offen sc1 lds
  buffer_load_dwordx4 v255, s[56:59], s13 offen offset:1024 sc1 lds
  s_add_u32 s13, s13, 17408
  buffer_load_dwordx4 v255, s[56:59], s13 offen offset:2048 sc1 lds
  s_add_u32 s13, s13, 17408
  buffer_load_dwordx4 v255, s[56:59], s13 offen offset:3072 sc1 lds
  s_waitcnt vmcnt(4)
  ds_read2st64_b32 v[64:65], v2 offset0:0 offset1:4
  ds_read2st64_b32 v[66:67], v2 offset0:8 offset1:12
  s_waitcnt lgkmcnt(0)
  v_max3_u32 v60, v64, v65, v66
  v_max_u32 v60, v60, v67
  v_cmp_eq_u32 vcc, -1, v60
  s_nop 0
  s_cbranch_vccnz L_o1B
L_o_ok1B:
  s_barrier
  s_add_u32 m0, s64, 61440
  s_add_u32 s13, s39, 17408
  buffer_load_dwordx4 v255, s[56:59], s39 offen sc1 lds
  buffer_load_dwordx4 v255, s[56:59], s13 offen offset:1024 sc1 lds
  s_add_u32 s13, s13, 17408
  buffer_load_dwordx4 v255, s[56:59], s13 offen offset:2048 sc1 lds
  s_add_u32 s13, s13, 17408
  buffer_load_dwordx4 v255, s[56:59], s13 offen offset:3072 sc1 lds
  s_waitcnt vmcnt(4)
  ds_read2st64_b32 v[64:65], v2 offset0:64 offset1:68
  ds_read2st64_b32 v[66:67], v2 offset0:72 offset1:76
  s_add_u32 m0, s64, 139264
  s_add_u32 s13, s40, 17408
  buffer_load_dwordx4 v255, s[56:59], s40 offen sc1 lds
  buffer_load_dwordx4 v255, s[56:59], s13 offen offset:1024 sc1 lds
  s_add_u32 s13, s13, 17408
  buffer_load_dwordx4 v255, s[56:59], s13 offen offset:2048 sc1 lds
  s_add_u32 s13, s13, 17408
  buffer_load_dwordx4 v255, s[56:59], s13 offen offset:3072 sc1 lds
  s_waitcnt lgkmcnt(0)
  v_max3_u32 v60, v64, v65, v66
  v_max_u32 v60, v60, v67
  v_cmp_eq_u32 vcc, -1, v60
  s_nop 0
  s_cbranch_vccnz L_o2B
L_o_ok2B:
  s_barrier
  s_waitcnt vmcnt(4)
  ds_read2st64_b32 v[64:65], v2 offset0:128 offset1:132
  ds_read2st64_b32 v[66:67], v2 offset0:136 offset1:140
  s_add_u32 m0, s64, 82944
  s_add_u32 s13, s41, 17408
  buffer_load_dwordx4 v255, s[56:59], s41 offen sc1 lds
  buffer_load_dwordx4 v255, s[56:59], s13 offen offset:1024 sc1 lds
  s_add_u32 s13, s13, 17408
  buffer_load_dwordx4 v255, s[56:59], s13 offen offset:2048 sc1 lds
  s_add_u32 s13, s13, 17408
  buffer_load_dwordx4 v255, s[56:59], s13 offen offset:3072 sc1 lds
  s_waitcnt lgkmcnt(0)
  v_max3_u32 v60, v64, v65, v66
  v_max_u32 v60, v60, v67
  v_cmp_eq_u32 vcc, -1, v60
  s_nop 0
  s_cbranch_vccnz L_o3B
L_o_ok3B:
  s_barrier
  s_waitcnt vmcnt(4)
  ds_read2st64_b32 v[64:65], v3 offset0:220 offset1:224
  ds_read2st64_b32 v[66:67], v3 offset0:228 offset1:232
  s_add_u32 m0, s64, 99328
  s_add_u32 s13, s42, 17408
  buffer_load_dwordx4 v255, s[56:59], s42 offen sc1 lds
  buffer_load_dwordx4 v255, s[56:59], s13 offen offset:1024 sc1 lds
  s_add_u32 s13, s13, 17408
  buffer_load_dwordx4 v255, s[56:59], s13 offen offset:2048 sc1 lds
  s_add_u32 s13, s13, 17408
  buffer_load_dwordx4 v255, s[56:59], s13 offen offset:3072 sc1 lds
  s_waitcnt lgkmcnt(0)
  v_max3_u32 v60, v64, v65, v66
  v_max_u32 v60, v60, v67
  v_cmp_eq_u32 vcc, -1, v60
  s_nop 0
  s_cbranch_vccnz L_o4B
L_o_ok4B:
  s_barrier
  s_waitcnt vmcnt(4)
  ds_read2st64_b32 v[64:65], v3 offset0:0 offset1:4
  ds_read2st64_b32 v[66:67], v3 offset0:8 offset1:12
  s_add_u32 m0, s64, 28672
  s_add_u32 s13, s43, 17408
  buffer_load_dwordx4 v255, s[56:59], s43 offen sc1 lds
  buffer_load_dwordx4 v255, s[56:59], s13 offen offset:1024 sc1 lds
  s_add_u32 s13, s13, 17408
  buffer_load_dwordx4 v255, s[56:59], s13 offen offset:2048 sc1 lds
  s_add_u32 s13, s13, 17408
  buffer_load_dwordx4 v255, s[56:59], s13 offen offset:3072 sc1 lds
  s_waitcnt lgkmcnt(0)
  v_max3_u32 v60, v64, v65, v66
  v_max_u32 v60, v60, v67
  v_cmp_eq_u32 vcc, -1, v60
  s_nop 0
  s_cbranch_vccnz L_o5B
L_o_ok5B:
  s_barrier
  s_waitcnt vmcnt(4)
  ds_read2st64_b32 v[64:65], v3 offset0:64 offset1:68
  ds_read2st64_b32 v[66:67], v3 offset0:72 offset1:76
  s_add_u32 m0, s64, 45056
  s_add_u32 s13, s36, 17408
  buffer_load_dwordx4 v255, s[56:59], s36 offen sc1 lds
  buffer_load_dwordx4 v255, s[56:59], s13 offen offset:1024 sc1 lds
  s_add_u32 s13, s13, 17408
  buffer_load_dwordx4 v255, s[56:59], s13 offen offset:2048 sc1 lds
  s_add_u32 s13, s13, 17408
  buffer_load_dwordx4 v255, s[56:59], s13 offen offset:3072 sc1 lds
  s_waitcnt lgkmcnt(0)
  v_max3_u32 v60, v64, v65, v66
  v_max_u32 v60, v60, v67
  v_cmp_eq_u32 vcc, -1, v60
  s_nop 0
  s_cbranch_vccnz L_o6B
L_o_ok6B:
  s_barrier
  s_waitcnt vmcnt(4)
  ds_read2st64_b32 v[64:65], v2 offset0:0 offset1:4
  ds_read2st64_b32 v[66:67], v2 offset0:8 offset1:12
  s_waitcnt lgkmcnt(0)
  v_max3_u32 v60, v64, v65, v66
  v_max_u32 v60, v60, v67
  v_cmp_eq_u32 vcc, -1, v60
  s_nop 0
  s_cbranch_vccnz L_o7B
L_o_ok7B:
  s_barrier
  s_waitcnt vmcnt(0)
  ds_read2st64_b32 v[64:65], v2 offset0:64 offset1:68
  ds_read2st64_b32 v[66:67], v2 offset0:72 offset1:76
  s_waitcnt lgkmcnt(0)
  v_max3_u32 v60, v64, v65, v66
  v_max_u32 v60, v60, v67
  v_cmp_eq_u32 vcc, -1, v60
  s_nop 0
  s_cbranch_vccnz L_o8B
L_o_ok8B:
  v_mov_b32 v1, 1
  s_cmp_eq_u32 s79, 0
  s_cbranch_scc1 L_df3B
  s_mov_b64 exec, 1
  buffer_store_dword v1, v18, s[52:55], s66 offen offset:16
  s_mov_b64 exec, -1
L_d_okf3B:
  s_barrier
  s_waitcnt vmcnt(0)
  buffer_load_dword v31, v32, s[52:55], s11 offen offset:16 sc1
  s_waitcnt vmcnt(0)
  v_cmp_ne_u32 vcc, 1, v31
  s_nop 0
  s_cbranch_vccnz L_ic3B
L_ic_ok3B:
  s_barrier
  s_endpgm
  s_nop 0
L_CA:
  s_mov_b32 s48, s30
  s_mov_b32 s49, s31
  s_mov_b32 s50, 4718592
  s_mov_b32 s51, 0x20000
  v_lshlrev_b32 v14, 4, v0
  s_mov_b32 s52, s34
  s_mov_b32 s53, s35
  s_mov_b32 s54, 0x2000000
  s_mov_b32 s55, 0x20000
  s_mov_b32 s60, s32
  s_mov_b32 s61, s33
  s_mov_b32 s62, 256
  s_mov_b32 s63, 0x20000
  s_lshl_b32 s14, s4, 3
  s_add_u32 s14, s14, s6
  s_mul_i32 s26, s14, 90112
  s_mul_i32 s27, s5, 5632
  s_add_u32 s27, s27, s26
  s_lshl2_add_u32 s13, s5, s8
  s_mul_i32 s28, s13, 73728
  s_mul_i32 s13, s4, 1152
  s_add_u32 s28, s28, s13
  s_mov_b64 s[70:71], 0xffff
  s_mov_b32 s76, 1069066811
  s_mov_b32 s77, 1069066811
  s_mov_b32 s78, 897988541
  s_lshl_b32 s29, s6, 7
  s_add_u32 s29, s29, s28
  s_mul_i32 s30, s6, 4608
  s_add_u32 s30, s30, s28
  s_add_u32 s30, s30, 1024
  s_mov_b32 s31, 0
  v_mov_b32 v44, -1
  v_mov_b32 v45, -1
  v_mov_b32 v46, -1
  v_mov_b32 v47, -1
  s_lshl_b32 s13, s8, 10
  s_add_u32 s13, s13, s27
  s_cmp_lt_u32 s8, 3
  s_cselect_b32 s13, s13, 1073741824
  buffer_store_dwordx4 v[44:47], v14, s[52:55], s13 offen sc1
  s_lshl_b32 s13, s8, 9
  s_add_u32 s13, s13, s27
  s_add_u32 s13, s13, 4096
  s_cmp_eq_u32 s8, 2
  s_cselect_b32 s13, s13, 1073741824
  s_mov_b32 exec_hi, 0
  buffer_store_dwordx4 v[44:47], v14, s[52:55], s13 offen sc1
  s_mov_b64 exec, -1
  s_setprio 1
  s_mov_b32 s32, -1
  s_mov_b32 s33, 0
  v_lshrrev_b32 v60, 4, v0
  v_and_b32 v61, 15, v0
  s_lshl_b32 s13, s8, 12
  s_add_u32 s13, s13, 104448
  v_and_b32 v48, 7, v61
  v_xor_b32 v48, v48, v60
  v_lshlrev_b32 v48, 4, v48
  v_lshl_add_u32 v48, v61, 7, v48
  v_add_u32 v1, s13, v48
  v_xor_b32 v2, 64, v1
  v_lshrrev_b32 v49, 2, v0
  v_mul_u32_u24 v48, 288, v49
  v_add_u32 v48, 120832, v48
  v_and_b32 v50, 3, v0
  v_lshl_add_u32 v3, v50, 3, v48
  v_mul_u32_u24 v51, 72, v50
  v_add3_u32 v4, v48, v51, 64
  s_mul_i32 s13, s8, 9472
  s_add_u32 s13, s13, 82944
  v_mul_u32_u24 v48, 296, v61
  v_add_u32 v48, s13, v48
  v_lshl_add_u32 v5, v60, 3, v48
  v_mul_u32_u24 v51, 72, v60
  v_add_u32 v6, v48, v51
  v_lshrrev_b32 v48, 3, v61
  v_and_b32 v49, 4, v61
  v_and_b32 v50, 3, v61
  v_lshl_add_u32 v51, v49, 1, v50
  v_add_u32 v52, 14, v50
  v_cmp_gt_u32 s[72:73], 2, v50
  v_mul_u32_u24 v53, 760, v48
  v_add_u32 v53, 157440, v53
  v_cndmask_b32 v52, v52, 18, s[72:73]
  v_mul_u32_u24 v49, 152, v60
  v_add_u32 v49, v49, v53
  v_lshl_add_u32 v112, v51, 3, v49
  v_lshl_add_u32 v113, v52, 3, v49
  v_add_u32 v49, 608, v53
  v_lshl_add_u32 v114, v51, 3, v49
  v_lshl_add_u32 v115, v52, 3, v49
  v_cmp_eq_u32 s[16:17], 0, v48
  s_nop 1
  v_cndmask_b32 v116, v112, v114, s[16:17]
  v_cndmask_b32 v117, v113, v115, s[16:17]
  v_mul_u32_u24 v118, 144, v61
  v_lshl_add_u32 v118, v60, 3, v118
  s_lshl_b32 s11, s5, 2
  s_add_u32 s11, s11, s8
  s_mul_i32 s11, s11, 73728
  s_mul_i32 s14, s6, 144
  s_add_u32 s11, s11, s14
  s_add_u32 s11, s11, 0
  s_mul_i32 s10, s8, 4608
  s_add_u32 s10, s10, 61440
  s_lshl_b32 s66, s8, 12
  s_add_u32 s66, s66, 28672
  v_add_u32 v48, 0, v0
  v_mul_u32_u24 v49, 7282, v48
  v_lshrrev_b32 v49, 16, v49
  v_mul_u32_u24 v49, 2160, v49
  v_lshl_add_u32 v119, v48, 4, v49
  v_add_u32 v48, 64, v0
  v_mul_u32_u24 v49, 7282, v48
  v_lshrrev_b32 v49, 16, v49
  v_mul_u32_u24 v49, 2160, v49
  v_lshl_add_u32 v120, v48, 4, v49
  v_add_u32 v48, 128, v0
  v_mul_u32_u24 v49, 7282, v48
  v_lshrrev_b32 v49, 16, v49
  v_mul_u32_u24 v49, 2160, v49
  v_lshl_add_u32 v121, v48, 4, v49
  v_add_u32 v48, 192, v0
  v_mul_u32_u24 v49, 7282, v48
  v_lshrrev_b32 v49, 16, v49
  v_mul_u32_u24 v49, 2160, v49
  v_lshl_add_u32 v122, v48, 4, v49
  v_add_u32 v48, 256, v0
  v_mul_u32_u24 v49, 7282, v48
  v_lshrrev_b32 v49, 16, v49
  v_mul_u32_u24 v49, 2160, v49
  v_lshl_add_u32 v123, v48, 4, v49
  s_lshl_b32 s67, s8, 2
  s_add_u32 s67, s67, 163808
  v_mov_b32 v49, s67
  v_mov_b32 v50, 0
  ds_write_b32 v49, v50
  v_add_u32 v48, 154368, v14
  ds_write_b128 v48, v[112:115] offset:0
  ds_write_b128 v48, v[116:119] offset:1024
  ds_write_b128 v48, v[120:123] offset:2048
  s_waitcnt lgkmcnt(0)
  s_barrier
  ds_read_b64_tr_b16 v[16:17], v3 offset:72
  ds_read_b64_tr_b16 v[18:19], v3 offset:4680
  ds_read_b128 v[112:115], v1 offset:0
  ds_read_b64_tr_b16 v[20:21], v3 offset:104
  ds_read_b64_tr_b16 v[22:23], v3 offset:4712
  ds_read_b128 v[116:119], v1 offset:2048
  ds_read_b64_tr_b16 v[24:25], v4 offset:0
  ds_read_b64_tr_b16 v[26:27], v4 offset:4608
  ds_read_b64_tr_b16 v[28:29], v3 offset:0
  ds_read_b64_tr_b16 v[30:31], v3 offset:4608
  ds_read_b64_tr_b16 v[32:33], v3 offset:32
  ds_read_b64_tr_b16 v[34:35], v3 offset:4640
  s_waitcnt lgkmcnt(9)
  v_mfma_f32_16x16x32_bf16 v[56:59], v[16:19], v[112:115], 0
  ds_read_b64_tr_b16 v[36:37], v3 offset:144
  s_waitcnt lgkmcnt(7)
  v_mfma_f32_16x16x32_bf16 v[60:63], v[16:19], v[116:119], 0
  ds_read_b64_tr_b16 v[38:39], v3 offset:4752
  v_mfma_f32_16x16x32_bf16 v[64:67], v[20:23], v[112:115], 0
  ds_read_b64_tr_b16 v[16:17], v3 offset:176
  v_mfma_f32_16x16x32_bf16 v[68:71], v[20:23], v[116:119], 0
  ds_read_b64_tr_b16 v[18:19], v3 offset:4784
  s_waitcnt lgkmcnt(6)
  v_mfma_f32_16x16x32_bf16 v[104:107], v[24:27], v[112:115], 0
  ds_read_b64_tr_b16 v[20:21], v3 offset:216
  v_mfma_f32_16x16x32_bf16 v[108:111], v[24:27], v[116:119], 0
  ds_read_b64_tr_b16 v[22:23], v3 offset:4824
  v_mfma_f32_16x16x32_bf16 v[40:43], v[28:31], v[112:115], 0
  ds_read_b64_tr_b16 v[24:25], v3 offset:248
  v_mfma_f32_16x16x32_bf16 v[44:47], v[28:31], v[116:119], 0
  ds_read_b64_tr_b16 v[26:27], v3 offset:4856
  s_waitcnt lgkmcnt(6)
  v_mfma_f32_16x16x32_bf16 v[48:51], v[32:35], v[112:115], 0
  ds_read_b64_tr_b16 v[28:29], v3 offset:9288
  v_mfma_f32_16x16x32_bf16 v[52:55], v[32:35], v[116:119], 0
  ds_read_b64_tr_b16 v[30:31], v3 offset:13896
  ds_read_b128 v[120:123], v2 offset:0
  v_mfma_f32_16x16x32_bf16 v[72:75], v[36:39], v[112:115], 0
  ds_read_b64_tr_b16 v[32:33], v3 offset:9320
  v_mfma_f32_16x16x32_bf16 v[76:79], v[36:39], v[116:119], 0
  ds_read_b64_tr_b16 v[34:35], v3 offset:13928
  ds_read_b128 v[124:127], v2 offset:2048
  s_waitcnt lgkmcnt(8)
  v_mfma_f32_16x16x32_bf16 v[80:83], v[16:19], v[112:115], 0
  ds_read_b64_tr_b16 v[36:37], v4 offset:9216
  v_mfma_f32_16x16x32_bf16 v[84:87], v[16:19], v[116:119], 0
  ds_read_b64_tr_b16 v[38:39], v4 offset:13824
  v_mfma_f32_16x16x32_bf16 v[88:91], v[20:23], v[112:115], 0
  ds_read_b64_tr_b16 v[16:17], v3 offset:9216
  v_mfma_f32_16x16x32_bf16 v[92:95], v[20:23], v[116:119], 0
  ds_read_b64_tr_b16 v[18:19], v3 offset:13824
  s_waitcnt lgkmcnt(8)
  v_mfma_f32_16x16x32_bf16 v[96:99], v[24:27], v[112:115], 0
  ds_read_b64_tr_b16 v[20:21], v3 offset:9248
  v_mfma_f32_16x16x32_bf16 v[100:103], v[24:27], v[116:119], 0
  ds_read_b64_tr_b16 v[22:23], v3 offset:13856
  s_waitcnt lgkmcnt(9)
  v_mfma_f32_16x16x32_bf16 v[56:59], v[28:31], v[120:123], v[56:59]
  ds_read_b64_tr_b16 v[24:25], v3 offset:9360
  s_waitcnt lgkmcnt(7)
  v_mfma_f32_16x16x32_bf16 v[60:63], v[28:31], v[124:127], v[60:63]
  ds_read_b64_tr_b16 v[26:27], v3 offset:13968
  s_waitcnt lgkmcnt(6)
  v_mfma_f32_16x16x32_bf16 v[64:67], v[32:35], v[120:123], v[64:67]
  ds_read_b64_tr_b16 v[28:29], v3 offset:9392
  v_mfma_f32_16x16x32_bf16 v[68:71], v[32:35], v[124:127], v[68:71]
  ds_read_b64_tr_b16 v[30:31], v3 offset:14000
  v_mfma_f32_16x16x32_bf16 v[104:107], v[36:39], v[120:123], v[104:107]
  ds_read_b64_tr_b16 v[32:33], v3 offset:9432
  v_mfma_f32_16x16x32_bf16 v[108:111], v[36:39], v[124:127], v[108:111]
  ds_read_b64_tr_b16 v[34:35], v3 offset:14040
  s_waitcnt lgkmcnt(6)
  v_mfma_f32_16x16x32_bf16 v[40:43], v[16:19], v[120:123], v[40:43]
  ds_read_b64_tr_b16 v[36:37], v3 offset:9464
  v_mfma_f32_16x16x32_bf16 v[44:47], v[16:19], v[124:127], v[44:47]
  ds_read_b64_tr_b16 v[38:39], v3 offset:14072
  v_mfma_f32_16x16x32_bf16 v[48:51], v[20:23], v[120:123], v[48:51]
  v_add_u32 v1, 4294862848, v1
  v_add_u32 v2, 4294862848, v2
  v_add_u32 v3, 4294862848, v3
  v_add_u32 v4, 4294862848, v4
  s_waitcnt vmcnt(0)
  s_barrier
  s_getreg_b32 s15, hwreg(HW_REG_XCC_ID, 0, 4)
  s_or_b32 s15, s15, 0x80
  s_and_b32 s14, s6, 3
  s_lshl_b32 s14, s14, 3
  s_lshl_b32 s15, s15, s14
  v_mov_b32 v15, s15
  s_lshl_b32 s13, s5, 3
  s_and_b32 s14, s6, 4
  s_add_u32 s13, s13, s14
  s_cmp_eq_u32 s8, 0
  s_cselect_b32 s13, s13, 0x1000
  s_mov_b64 exec, 1
  buffer_atomic_or v15, v14, s[60:63], s13 offen offset:0 sc1
  s_mov_b64 exec, -1
  s_setprio 1
  ds_read_b64_tr_b16 v[16:17], v3 offset:72
  v_mfma_f32_16x16x32_bf16 v[52:55], v[20:23], v[124:127], v[52:55]
  ds_read_b64_tr_b16 v[18:19], v3 offset:4680
  ds_read_b128 v[128:131], v1 offset:0
  s_waitcnt lgkmcnt(7)
  v_mfma_f32_16x16x32_bf16 v[72:75], v[24:27], v[120:123], v[72:75]
  ds_read_b64_tr_b16 v[20:21], v3 offset:104
  v_mfma_f32_16x16x32_bf16 v[76:79], v[24:27], v[124:127], v[76:79]
  ds_read_b64_tr_b16 v[22:23], v3 offset:4712
  ds_read_b128 v[132:135], v1 offset:2048
  v_mfma_f32_16x16x32_bf16 v[80:83], v[28:31], v[120:123], v[80:83]
  ds_read_b64_tr_b16 v[24:25], v4 offset:0
  v_mfma_f32_16x16x32_bf16 v[84:87], v[28:31], v[124:127], v[84:87]
  ds_read_b64_tr_b16 v[26:27], v4 offset:4608
  s_waitcnt lgkmcnt(8)
  v_mfma_f32_16x16x32_bf16 v[88:91], v[32:35], v[120:123], v[88:91]
  ds_read_b64_tr_b16 v[28:29], v3 offset:0
  v_mfma_f32_16x16x32_bf16 v[92:95], v[32:35], v[124:127], v[92:95]
  ds_read_b64_tr_b16 v[30:31], v3 offset:4608
  v_mfma_f32_16x16x32_bf16 v[96:99], v[36:39], v[120:123], v[96:99]
  ds_read_b64_tr_b16 v[32:33], v3 offset:32
  v_mfma_f32_16x16x32_bf16 v[100:103], v[36:39], v[124:127], v[100:103]
  ds_read_b64_tr_b16 v[34:35], v3 offset:4640
  s_waitcnt lgkmcnt(7)
  v_mfma_f32_16x16x32_bf16 v[56:59], v[16:19], v[128:131], v[56:59]
  ds_read_b64_tr_b16 v[36:37], v3 offset:144
  s_waitcnt lgkmcnt(7)
  v_mfma_f32_16x16x32_bf16 v[60:63], v[16:19], v[132:135], v[60:63]
  ds_read_b64_tr_b16 v[38:39], v3 offset:4752
  v_mfma_f32_16x16x32_bf16 v[64:67], v[20:23], v[128:131], v[64:67]
  ds_read_b64_tr_b16 v[16:17], v3 offset:176
  v_mfma_f32_16x16x32_bf16 v[68:71], v[20:23], v[132:135], v[68:71]
  ds_read_b64_tr_b16 v[18:19], v3 offset:4784
  s_waitcnt lgkmcnt(6)
  v_mfma_f32_16x16x32_bf16 v[104:107], v[24:27], v[128:131], v[104:107]
  ds_read_b64_tr_b16 v[20:21], v3 offset:216
  v_mfma_f32_16x16x32_bf16 v[108:111], v[24:27], v[132:135], v[108:111]
  ds_read_b64_tr_b16 v[22:23], v3 offset:4824
  v_mfma_f32_16x16x32_bf16 v[40:43], v[28:31], v[128:131], v[40:43]
  ds_read_b64_tr_b16 v[24:25], v3 offset:248
  v_mfma_f32_16x16x32_bf16 v[44:47], v[28:31], v[132:135], v[44:47]
  ds_read_b64_tr_b16 v[26:27], v3 offset:4856
  s_waitcnt lgkmcnt(6)
  v_mfma_f32_16x16x32_bf16 v[48:51], v[32:35], v[128:131], v[48:51]
  ds_read_b64_tr_b16 v[28:29], v3 offset:9288
  v_mfma_f32_16x16x32_bf16 v[52:55], v[32:35], v[132:135], v[52:55]
  ds_read_b64_tr_b16 v[30:31], v3 offset:13896
  ds_read_b128 v[136:139], v2 offset:0
  v_mfma_f32_16x16x32_bf16 v[72:75], v[36:39], v[128:131], v[72:75]
  ds_read_b64_tr_b16 v[32:33], v3 offset:9320
  v_mfma_f32_16x16x32_bf16 v[76:79], v[36:39], v[132:135], v[76:79]
  ds_read_b64_tr_b16 v[34:35], v3 offset:13928
  ds_read_b128 v[140:143], v2 offset:2048
  s_waitcnt lgkmcnt(8)
  v_mfma_f32_16x16x32_bf16 v[80:83], v[16:19], v[128:131], v[80:83]
  ds_read_b64_tr_b16 v[36:37], v4 offset:9216
  v_mfma_f32_16x16x32_bf16 v[84:87], v[16:19], v[132:135], v[84:87]
  ds_read_b64_tr_b16 v[38:39], v4 offset:13824
  v_mfma_f32_16x16x32_bf16 v[88:91], v[20:23], v[128:131], v[88:91]
  ds_read_b64_tr_b16 v[16:17], v3 offset:9216
  v_mfma_f32_16x16x32_bf16 v[92:95], v[20:23], v[132:135], v[92:95]
  ds_read_b64_tr_b16 v[18:19], v3 offset:13824
  s_waitcnt lgkmcnt(8)
  v_mfma_f32_16x16x32_bf16 v[96:99], v[24:27], v[128:131], v[96:99]
  ds_read_b64_tr_b16 v[20:21], v3 offset:9248
  v_mfma_f32_16x16x32_bf16 v[100:103], v[24:27], v[132:135], v[100:103]
  ds_read_b64_tr_b16 v[22:23], v3 offset:13856
  s_waitcnt lgkmcnt(9)
  v_mfma_f32_16x16x32_bf16 v[56:59], v[28:31], v[136:139], v[56:59]
  ds_read_b64_tr_b16 v[24:25], v3 offset:9360
  s_waitcnt lgkmcnt(7)
  v_mfma_f32_16x16x32_bf16 v[60:63], v[28:31], v[140:143], v[60:63]
  ds_read_b64_tr_b16 v[26:27], v3 offset:13968
  s_waitcnt lgkmcnt(6)
  v_mfma_f32_16x16x32_bf16 v[64:67], v[32:35], v[136:139], v[64:67]
  ds_read_b64_tr_b16 v[28:29], v3 offset:9392
  v_mfma_f32_16x16x32_bf16 v[68:71], v[32:35], v[140:143], v[68:71]
  ds_read_b64_tr_b16 v[30:31], v3 offset:14000
  v_mfma_f32_16x16x32_bf16 v[104:107], v[36:39], v[136:139], v[104:107]
  ds_read_b64_tr_b16 v[32:33], v3 offset:9432
  v_mfma_f32_16x16x32_bf16 v[108:111], v[36:39], v[140:143], v[108:111]
  ds_read_b64_tr_b16 v[34:35], v3 offset:14040
  s_waitcnt lgkmcnt(6)
  v_mfma_f32_16x16x32_bf16 v[40:43], v[16:19], v[136:139], v[40:43]
  ds_read_b64_tr_b16 v[36:37], v3 offset:9464
  v_mfma_f32_16x16x32_bf16 v[44:47], v[16:19], v[140:143], v[44:47]
  ds_read_b64_tr_b16 v[38:39], v3 offset:14072
  v_mfma_f32_16x16x32_bf16 v[48:51], v[20:23], v[136:139], v[48:51]
  v_add_u32 v1, 34816, v1
  v_add_u32 v2, 34816, v2
  v_add_u32 v3, 34816, v3
  v_add_u32 v4, 34816, v4
  s_barrier
  ds_read_b64_tr_b16 v[16:17], v3 offset:72
  v_mfma_f32_16x16x32_bf16 v[52:55], v[20:23], v[140:143], v[52:55]
  ds_read_b64_tr_b16 v[18:19], v3 offset:4680
  ds_read_b128 v[144:147], v1 offset:0
  s_waitcnt lgkmcnt(7)
  v_mfma_f32_16x16x32_bf16 v[72:75], v[24:27], v[136:139], v[72:75]
  ds_read_b64_tr_b16 v[20:21], v3 offset:104
  v_mfma_f32_16x16x32_bf16 v[76:79], v[24:27], v[140:143], v[76:79]
  ds_read_b64_tr_b16 v[22:23], v3 offset:4712
  ds_read_b128 v[148:151], v1 offset:2048
  v_mfma_f32_16x16x32_bf16 v[80:83], v[28:31], v[136:139], v[80:83]
  ds_read_b64_tr_b16 v[24:25], v4 offset:0
  v_mfma_f32_16x16x32_bf16 v[84:87], v[28:31], v[140:143], v[84:87]
  ds_read_b64_tr_b16 v[26:27], v4 offset:4608
  s_waitcnt lgkmcnt(8)
  v_mfma_f32_16x16x32_bf16 v[88:91], v[32:35], v[136:139], v[88:91]
  ds_read_b64_tr_b16 v[28:29], v3 offset:0
  v_mfma_f32_16x16x32_bf16 v[92:95], v[32:35], v[140:143], v[92:95]
  ds_read_b64_tr_b16 v[30:31], v3 offset:4608
  v_mfma_f32_16x16x32_bf16 v[96:99], v[36:39], v[136:139], v[96:99]
  ds_read_b64_tr_b16 v[32:33], v3 offset:32
  v_mfma_f32_16x16x32_bf16 v[100:103], v[36:39], v[140:143], v[100:103]
  ds_read_b64_tr_b16 v[34:35], v3 offset:4640
  s_waitcnt lgkmcnt(7)
  v_mfma_f32_16x16x32_bf16 v[56:59], v[16:19], v[144:147], v[56:59]
  ds_read_b64_tr_b16 v[36:37], v3 offset:144
  s_waitcnt lgkmcnt(7)
  v_mfma_f32_16x16x32_bf16 v[60:63], v[16:19], v[148:151], v[60:63]
  ds_read_b64_tr_b16 v[38:39], v3 offset:4752
  v_mfma_f32_16x16x32_bf16 v[64:67], v[20:23], v[144:147], v[64:67]
  ds_read_b64_tr_b16 v[16:17], v3 offset:176
  v_mfma_f32_16x16x32_bf16 v[68:71], v[20:23], v[148:151], v[68:71]
  ds_read_b64_tr_b16 v[18:19], v3 offset:4784
  s_waitcnt lgkmcnt(6)
  v_mfma_f32_16x16x32_bf16 v[104:107], v[24:27], v[144:147], v[104:107]
  ds_read_b64_tr_b16 v[20:21], v3 offset:216
  v_mfma_f32_16x16x32_bf16 v[108:111], v[24:27], v[148:151], v[108:111]
  ds_read_b64_tr_b16 v[22:23], v3 offset:4824
  v_mfma_f32_16x16x32_bf16 v[40:43], v[28:31], v[144:147], v[40:43]
  ds_read_b64_tr_b16 v[24:25], v3 offset:248
  v_mfma_f32_16x16x32_bf16 v[44:47], v[28:31], v[148:151], v[44:47]
  ds_read_b64_tr_b16 v[26:27], v3 offset:4856
  s_waitcnt lgkmcnt(6)
  v_mfma_f32_16x16x32_bf16 v[48:51], v[32:35], v[144:147], v[48:51]
  ds_read_b64_tr_b16 v[28:29], v3 offset:9288
  v_mfma_f32_16x16x32_bf16 v[52:55], v[32:35], v[148:151], v[52:55]
  ds_read_b64_tr_b16 v[30:31], v3 offset:13896
  ds_read_b128 v[152:155], v2 offset:0
  v_mfma_f32_16x16x32_bf16 v[72:75], v[36:39], v[144:147], v[72:75]
  ds_read_b64_tr_b16 v[32:33], v3 offset:9320
  v_mfma_f32_16x16x32_bf16 v[76:79], v[36:39], v[148:151], v[76:79]
  ds_read_b64_tr_b16 v[34:35], v3 offset:13928
  ds_read_b128 v[156:159], v2 offset:2048
  s_waitcnt lgkmcnt(8)
  v_mfma_f32_16x16x32_bf16 v[80:83], v[16:19], v[144:147], v[80:83]
  ds_read_b64_tr_b16 v[36:37], v4 offset:9216
  v_mfma_f32_16x16x32_bf16 v[84:87], v[16:19], v[148:151], v[84:87]
  ds_read_b64_tr_b16 v[38:39], v4 offset:13824
  v_mfma_f32_16x16x32_bf16 v[88:91], v[20:23], v[144:147], v[88:91]
  ds_read_b64_tr_b16 v[16:17], v3 offset:9216
  v_mfma_f32_16x16x32_bf16 v[92:95], v[20:23], v[148:151], v[92:95]
  ds_read_b64_tr_b16 v[18:19], v3 offset:13824
  s_waitcnt lgkmcnt(8)
  v_mfma_f32_16x16x32_bf16 v[96:99], v[24:27], v[144:147], v[96:99]
  ds_read_b64_tr_b16 v[20:21], v3 offset:9248
  v_mfma_f32_16x16x32_bf16 v[100:103], v[24:27], v[148:151], v[100:103]
  ds_read_b64_tr_b16 v[22:23], v3 offset:13856
  s_waitcnt lgkmcnt(9)
  v_mfma_f32_16x16x32_bf16 v[56:59], v[28:31], v[152:155], v[56:59]
  ds_read_b64_tr_b16 v[24:25], v3 offset:9360
  s_waitcnt lgkmcnt(7)
  v_mfma_f32_16x16x32_bf16 v[60:63], v[28:31], v[156:159], v[60:63]
  ds_read_b64_tr_b16 v[26:27], v3 offset:13968
  s_waitcnt lgkmcnt(6)
  v_mfma_f32_16x16x32_bf16 v[64:67], v[32:35], v[152:155], v[64:67]
  ds_read_b64_tr_b16 v[28:29], v3 offset:9392
  v_mfma_f32_16x16x32_bf16 v[68:71], v[32:35], v[156:159], v[68:71]
  ds_read_b64_tr_b16 v[30:31], v3 offset:14000
  v_mfma_f32_16x16x32_bf16 v[104:107], v[36:39], v[152:155], v[104:107]
  ds_read_b64_tr_b16 v[32:33], v3 offset:9432
  v_mfma_f32_16x16x32_bf16 v[108:111], v[36:39], v[156:159], v[108:111]
  ds_read_b64_tr_b16 v[34:35], v3 offset:14040
  s_waitcnt lgkmcnt(6)
  v_mfma_f32_16x16x32_bf16 v[40:43], v[16:19], v[152:155], v[40:43]
  ds_read_b64_tr_b16 v[36:37], v3 offset:9464
  v_mfma_f32_16x16x32_bf16 v[44:47], v[16:19], v[156:159], v[44:47]
  ds_read_b64_tr_b16 v[38:39], v3 offset:14072
  v_mfma_f32_16x16x32_bf16 v[48:51], v[20:23], v[152:155], v[48:51]
  v_add_u32 v1, 34816, v1
  v_add_u32 v2, 34816, v2
  v_add_u32 v3, 34816, v3
  v_add_u32 v4, 34816, v4
  s_barrier
  ds_read_b64_tr_b16 v[16:17], v3 offset:72
  v_mfma_f32_16x16x32_bf16 v[52:55], v[20:23], v[156:159], v[52:55]
  ds_read_b64_tr_b16 v[18:19], v3 offset:4680
  ds_read_b128 v[160:163], v1 offset:0
  s_waitcnt lgkmcnt(7)
  v_mfma_f32_16x16x32_bf16 v[72:75], v[24:27], v[152:155], v[72:75]
  ds_read_b64_tr_b16 v[20:21], v3 offset:104
  v_mfma_f32_16x16x32_bf16 v[76:79], v[24:27], v[156:159], v[76:79]
  ds_read_b64_tr_b16 v[22:23], v3 offset:4712
  ds_read_b128 v[164:167], v1 offset:2048
  v_mfma_f32_16x16x32_bf16 v[80:83], v[28:31], v[152:155], v[80:83]
  ds_read_b64_tr_b16 v[24:25], v4 offset:0
  v_mfma_f32_16x16x32_bf16 v[84:87], v[28:31], v[156:159], v[84:87]
  ds_read_b64_tr_b16 v[26:27], v4 offset:4608
  s_waitcnt lgkmcnt(8)
  v_mfma_f32_16x16x32_bf16 v[88:91], v[32:35], v[152:155], v[88:91]
  ds_read_b64_tr_b16 v[28:29], v3 offset:0
  v_mfma_f32_16x16x32_bf16 v[92:95], v[32:35], v[156:159], v[92:95]
  ds_read_b64_tr_b16 v[30:31], v3 offset:4608
  v_mfma_f32_16x16x32_bf16 v[96:99], v[36:39], v[152:155], v[96:99]
  ds_read_b64_tr_b16 v[32:33], v3 offset:32
  v_mfma_f32_16x16x32_bf16 v[100:103], v[36:39], v[156:159], v[100:103]
  ds_read_b64_tr_b16 v[34:35], v3 offset:4640
  s_waitcnt lgkmcnt(7)
  v_mfma_f32_16x16x32_bf16 v[56:59], v[16:19], v[160:163], v[56:59]
  ds_read_b64_tr_b16 v[36:37], v3 offset:144
  s_waitcnt lgkmcnt(7)
  v_mfma_f32_16x16x32_bf16 v[60:63], v[16:19], v[164:167], v[60:63]
  ds_read_b64_tr_b16 v[38:39], v3 offset:4752
  v_mfma_f32_16x16x32_bf16 v[64:67], v[20:23], v[160:163], v[64:67]
  ds_read_b64_tr_b16 v[16:17], v3 offset:176
  v_mfma_f32_16x16x32_bf16 v[68:71], v[20:23], v[164:167], v[68:71]
  ds_read_b64_tr_b16 v[18:19], v3 offset:4784
  s_waitcnt lgkmcnt(6)
  v_mfma_f32_16x16x32_bf16 v[104:107], v[24:27], v[160:163], v[104:107]
  ds_read_b64_tr_b16 v[20:21], v3 offset:216
  v_mfma_f32_16x16x32_bf16 v[108:111], v[24:27], v[164:167], v[108:111]
  ds_read_b64_tr_b16 v[22:23], v3 offset:4824
  v_mfma_f32_16x16x32_bf16 v[40:43], v[28:31], v[160:163], v[40:43]
  ds_read_b64_tr_b16 v[24:25], v3 offset:248
  v_mfma_f32_16x16x32_bf16 v[44:47], v[28:31], v[164:167], v[44:47]
  ds_read_b64_tr_b16 v[26:27], v3 offset:4856
  s_waitcnt lgkmcnt(6)
  v_mfma_f32_16x16x32_bf16 v[48:51], v[32:35], v[160:163], v[48:51]
  ds_read_b64_tr_b16 v[28:29], v3 offset:9288
  v_mfma_f32_16x16x32_bf16 v[52:55], v[32:35], v[164:167], v[52:55]
  ds_read_b64_tr_b16 v[30:31], v3 offset:13896
  ds_read_b128 v[168:171], v2 offset:0
  v_mfma_f32_16x16x32_bf16 v[72:75], v[36:39], v[160:163], v[72:75]
  ds_read_b64_tr_b16 v[32:33], v3 offset:9320
  v_mfma_f32_16x16x32_bf16 v[76:79], v[36:39], v[164:167], v[76:79]
  ds_read_b64_tr_b16 v[34:35], v3 offset:13928
  ds_read_b128 v[172:175], v2 offset:2048
  s_waitcnt lgkmcnt(8)
  v_mfma_f32_16x16x32_bf16 v[80:83], v[16:19], v[160:163], v[80:83]
  ds_read_b64_tr_b16 v[36:37], v4 offset:9216
  v_mfma_f32_16x16x32_bf16 v[84:87], v[16:19], v[164:167], v[84:87]
  ds_read_b64_tr_b16 v[38:39], v4 offset:13824
  v_mfma_f32_16x16x32_bf16 v[88:91], v[20:23], v[160:163], v[88:91]
  ds_read_b64_tr_b16 v[16:17], v3 offset:9216
  v_mfma_f32_16x16x32_bf16 v[92:95], v[20:23], v[164:167], v[92:95]
  ds_read_b64_tr_b16 v[18:19], v3 offset:13824
  s_waitcnt lgkmcnt(8)
  v_mfma_f32_16x16x32_bf16 v[96:99], v[24:27], v[160:163], v[96:99]
  ds_read_b64_tr_b16 v[20:21], v3 offset:9248
  v_mfma_f32_16x16x32_bf16 v[100:103], v[24:27], v[164:167], v[100:103]
  ds_read_b64_tr_b16 v[22:23], v3 offset:13856
  s_waitcnt lgkmcnt(9)
  v_mfma_f32_16x16x32_bf16 v[56:59], v[28:31], v[168:171], v[56:59]
  ds_read_b64_tr_b16 v[24:25], v3 offset:9360
  s_waitcnt lgkmcnt(7)
  v_mfma_f32_16x16x32_bf16 v[60:63], v[28:31], v[172:175], v[60:63]
  ds_read_b64_tr_b16 v[26:27], v3 offset:13968
  s_waitcnt lgkmcnt(6)
  v_mfma_f32_16x16x32_bf16 v[64:67], v[32:35], v[168:171], v[64:67]
  ds_read_b64_tr_b16 v[28:29], v3 offset:9392
  v_mfma_f32_16x16x32_bf16 v[68:71], v[32:35], v[172:175], v[68:71]
  ds_read_b64_tr_b16 v[30:31], v3 offset:14000
  v_mfma_f32_16x16x32_bf16 v[104:107], v[36:39], v[168:171], v[104:107]
  ds_read_b64_tr_b16 v[32:33], v3 offset:9432
  v_mfma_f32_16x16x32_bf16 v[108:111], v[36:39], v[172:175], v[108:111]
  ds_read_b64_tr_b16 v[34:35], v3 offset:14040
  s_waitcnt lgkmcnt(6)
  v_mfma_f32_16x16x32_bf16 v[40:43], v[16:19], v[168:171], v[40:43]
  ds_read_b64_tr_b16 v[36:37], v3 offset:9464
  v_mfma_f32_16x16x32_bf16 v[44:47], v[16:19], v[172:175], v[44:47]
  ds_read_b64_tr_b16 v[38:39], v3 offset:14072
  v_mfma_f32_16x16x32_bf16 v[48:51], v[20:23], v[168:171], v[48:51]
  v_add_u32 v1, 34816, v1
  v_add_u32 v2, 34816, v2
  v_add_u32 v3, 34816, v3
  v_add_u32 v4, 34816, v4
  s_mov_b64 s[56:57], s[36:37]
  s_mov_b32 s58, 1990656
  s_mov_b32 s15, 0
  s_mov_b32 exec_lo, 2047
  s_mov_b32 exec_hi, 0
  buffer_load_dword v250, v250, s[56:59], s15 offen
  s_mov_b64 s[56:57], s[38:39]
  s_mov_b32 s58, 663552
  s_mov_b32 s15, 0
  s_mov_b32 exec_lo, 2047
  s_mov_b32 exec_hi, 0
  buffer_load_dword v251, v251, s[56:59], s15 offen
  s_mov_b64 s[56:57], s[40:41]
  s_mov_b32 s58, 1990656
  s_mov_b32 s15, 0
  s_mov_b32 exec_lo, 2047
  s_mov_b32 exec_hi, 0
  buffer_load_dword v252, v252, s[56:59], s15 offen
  s_mov_b64 s[56:57], s[42:43]
  s_mov_b32 s58, 663552
  s_mov_b32 s15, 0
  s_mov_b32 exec_lo, 2047
  s_mov_b32 exec_hi, 0
  buffer_load_dword v253, v253, s[56:59], s15 offen
  s_mov_b64 exec, -1
  s_setprio 1
  s_barrier
  ds_read_b64_tr_b16 v[16:17], v3 offset:72
  v_mfma_f32_16x16x32_bf16 v[52:55], v[20:23], v[172:175], v[52:55]
  ds_read_b64_tr_b16 v[18:19], v3 offset:4680
  ds_read_b128 v[176:179], v1 offset:0
  s_waitcnt lgkmcnt(7)
  v_mfma_f32_16x16x32_bf16 v[72:75], v[24:27], v[168:171], v[72:75]
  ds_read_b64_tr_b16 v[20:21], v3 offset:104
  v_mfma_f32_16x16x32_bf16 v[76:79], v[24:27], v[172:175], v[76:79]
  ds_read_b64_tr_b16 v[22:23], v3 offset:4712
  ds_read_b128 v[180:183], v1 offset:2048
  v_mfma_f32_16x16x32_bf16 v[80:83], v[28:31], v[168:171], v[80:83]
  ds_read_b64_tr_b16 v[24:25], v4 offset:0
  v_mfma_f32_16x16x32_bf16 v[84:87], v[28:31], v[172:175], v[84:87]
  ds_read_b64_tr_b16 v[26:27], v4 offset:4608
  s_waitcnt lgkmcnt(8)
  v_mfma_f32_16x16x32_bf16 v[88:91], v[32:35], v[168:171], v[88:91]
  ds_read_b64_tr_b16 v[28:29], v3 offset:0
  v_mfma_f32_16x16x32_bf16 v[92:95], v[32:35], v[172:175], v[92:95]
  ds_read_b64_tr_b16 v[30:31], v3 offset:4608
  v_mfma_f32_16x16x32_bf16 v[96:99], v[36:39], v[168:171], v[96:99]
  ds_read_b64_tr_b16 v[32:33], v3 offset:32
  v_mfma_f32_16x16x32_bf16 v[100:103], v[36:39], v[172:175], v[100:103]
  ds_read_b64_tr_b16 v[34:35], v3 offset:4640
  s_waitcnt lgkmcnt(7)
  v_mfma_f32_16x16x32_bf16 v[56:59], v[16:19], v[176:179], v[56:59]
  ds_read_b64_tr_b16 v[36:37], v3 offset:144
  s_waitcnt lgkmcnt(7)
  v_mfma_f32_16x16x32_bf16 v[60:63], v[16:19], v[180:183], v[60:63]
  ds_read_b64_tr_b16 v[38:39], v3 offset:4752
  v_mfma_f32_16x16x32_bf16 v[64:67], v[20:23], v[176:179], v[64:67]
  ds_read_b64_tr_b16 v[16:17], v3 offset:176
  v_mfma_f32_16x16x32_bf16 v[68:71], v[20:23], v[180:183], v[68:71]
  ds_read_b64_tr_b16 v[18:19], v3 offset:4784
  s_waitcnt lgkmcnt(6)
  v_mfma_f32_16x16x32_bf16 v[104:107], v[24:27], v[176:179], v[104:107]
  ds_read_b64_tr_b16 v[20:21], v3 offset:216
  v_mfma_f32_16x16x32_bf16 v[108:111], v[24:27], v[180:183], v[108:111]
  ds_read_b64_tr_b16 v[22:23], v3 offset:4824
  v_mfma_f32_16x16x32_bf16 v[40:43], v[28:31], v[176:179], v[40:43]
  ds_read_b64_tr_b16 v[24:25], v3 offset:248
  v_mfma_f32_16x16x32_bf16 v[44:47], v[28:31], v[180:183], v[44:47]
  ds_read_b64_tr_b16 v[26:27], v3 offset:4856
  s_waitcnt lgkmcnt(6)
  v_mfma_f32_16x16x32_bf16 v[48:51], v[32:35], v[176:179], v[48:51]
  ds_read_b64_tr_b16 v[28:29], v3 offset:9288
  v_mfma_f32_16x16x32_bf16 v[52:55], v[32:35], v[180:183], v[52:55]
  ds_read_b64_tr_b16 v[30:31], v3 offset:13896
  ds_read_b128 v[184:187], v2 offset:0
  v_mfma_f32_16x16x32_bf16 v[72:75], v[36:39], v[176:179], v[72:75]
  ds_read_b64_tr_b16 v[32:33], v3 offset:9320
  v_mfma_f32_16x16x32_bf16 v[76:79], v[36:39], v[180:183], v[76:79]
  ds_read_b64_tr_b16 v[34:35], v3 offset:13928
  ds_read_b128 v[188:191], v2 offset:2048
  s_waitcnt lgkmcnt(8)
  v_mfma_f32_16x16x32_bf16 v[80:83], v[16:19], v[176:179], v[80:83]
  ds_read_b64_tr_b16 v[36:37], v4 offset:9216
  v_mfma_f32_16x16x32_bf16 v[84:87], v[16:19], v[180:183], v[84:87]
  ds_read_b64_tr_b16 v[38:39], v4 offset:13824
  v_mfma_f32_16x16x32_bf16 v[88:91], v[20:23], v[176:179], v[88:91]
  ds_read_b64_tr_b16 v[16:17], v3 offset:9216
  v_mfma_f32_16x16x32_bf16 v[92:95], v[20:23], v[180:183], v[92:95]
  ds_read_b64_tr_b16 v[18:19], v3 offset:13824
  s_waitcnt lgkmcnt(8)
  v_mfma_f32_16x16x32_bf16 v[96:99], v[24:27], v[176:179], v[96:99]
  ds_read_b64_tr_b16 v[20:21], v3 offset:9248
  v_mfma_f32_16x16x32_bf16 v[100:103], v[24:27], v[180:183], v[100:103]
  ds_read_b64_tr_b16 v[22:23], v3 offset:13856
  s_waitcnt lgkmcnt(9)
  v_mfma_f32_16x16x32_bf16 v[56:59], v[28:31], v[184:187], v[56:59]
  ds_read_b64_tr_b16 v[24:25], v3 offset:9360
  s_waitcnt lgkmcnt(7)
  v_mfma_f32_16x16x32_bf16 v[60:63], v[28:31], v[188:191], v[60:63]
  ds_read_b64_tr_b16 v[26:27], v3 offset:13968
  s_waitcnt lgkmcnt(6)
  v_mfma_f32_16x16x32_bf16 v[64:67], v[32:35], v[184:187], v[64:67]
  ds_read_b64_tr_b16 v[28:29], v3 offset:9392
  v_mfma_f32_16x16x32_bf16 v[68:71], v[32:35], v[188:191], v[68:71]
  ds_read_b64_tr_b16 v[30:31], v3 offset:14000
  v_mfma_f32_16x16x32_bf16 v[104:107], v[36:39], v[184:187], v[104:107]
  ds_read_b64_tr_b16 v[32:33], v3 offset:9432
  v_mfma_f32_16x16x32_bf16 v[108:111], v[36:39], v[188:191], v[108:111]
  ds_read_b64_tr_b16 v[34:35], v3 offset:14040
  s_waitcnt lgkmcnt(6)
  v_mfma_f32_16x16x32_bf16 v[40:43], v[16:19], v[184:187], v[40:43]
  ds_read_b64_tr_b16 v[36:37], v3 offset:9464
  v_mfma_f32_16x16x32_bf16 v[44:47], v[16:19], v[188:191], v[44:47]
  ds_read_b64_tr_b16 v[38:39], v3 offset:14072
  v_mfma_f32_16x16x32_bf16 v[48:51], v[20:23], v[184:187], v[48:51]
  v_add_u32 v1, 4294862848, v1
  v_add_u32 v2, 4294862848, v2
  v_add_u32 v3, 4294862848, v3
  v_add_u32 v4, 4294862848, v4
  s_barrier
  ds_read_b64_tr_b16 v[16:17], v3 offset:72
  v_mfma_f32_16x16x32_bf16 v[52:55], v[20:23], v[188:191], v[52:55]
  ds_read_b64_tr_b16 v[18:19], v3 offset:4680
  ds_read_b128 v[192:195], v1 offset:0
  s_waitcnt lgkmcnt(7)
  v_mfma_f32_16x16x32_bf16 v[72:75], v[24:27], v[184:187], v[72:75]
  ds_read_b64_tr_b16 v[20:21], v3 offset:104
  v_mfma_f32_16x16x32_bf16 v[76:79], v[24:27], v[188:191], v[76:79]
  ds_read_b64_tr_b16 v[22:23], v3 offset:4712
  ds_read_b128 v[196:199], v1 offset:2048
  v_mfma_f32_16x16x32_bf16 v[80:83], v[28:31], v[184:187], v[80:83]
  ds_read_b64_tr_b16 v[24:25], v4 offset:0
  v_mfma_f32_16x16x32_bf16 v[84:87], v[28:31], v[188:191], v[84:87]
  ds_read_b64_tr_b16 v[26:27], v4 offset:4608
  s_waitcnt lgkmcnt(8)
  v_mfma_f32_16x16x32_bf16 v[88:91], v[32:35], v[184:187], v[88:91]
  ds_read_b64_tr_b16 v[28:29], v3 offset:0
  v_mfma_f32_16x16x32_bf16 v[92:95], v[32:35], v[188:191], v[92:95]
  ds_read_b64_tr_b16 v[30:31], v3 offset:4608
  v_mfma_f32_16x16x32_bf16 v[96:99], v[36:39], v[184:187], v[96:99]
  ds_read_b64_tr_b16 v[32:33], v3 offset:32
  v_mfma_f32_16x16x32_bf16 v[100:103], v[36:39], v[188:191], v[100:103]
  ds_read_b64_tr_b16 v[34:35], v3 offset:4640
  s_waitcnt lgkmcnt(7)
  v_mfma_f32_16x16x32_bf16 v[56:59], v[16:19], v[192:195], v[56:59]
  ds_read_b64_tr_b16 v[36:37], v3 offset:144
  s_waitcnt lgkmcnt(7)
  v_mfma_f32_16x16x32_bf16 v[60:63], v[16:19], v[196:199], v[60:63]
  ds_read_b64_tr_b16 v[38:39], v3 offset:4752
  v_mfma_f32_16x16x32_bf16 v[64:67], v[20:23], v[192:195], v[64:67]
  ds_read_b64_tr_b16 v[16:17], v3 offset:176
  v_mfma_f32_16x16x32_bf16 v[68:71], v[20:23], v[196:199], v[68:71]
  ds_read_b64_tr_b16 v[18:19], v3 offset:4784
  s_waitcnt lgkmcnt(6)
  v_mfma_f32_16x16x32_bf16 v[104:107], v[24:27], v[192:195], v[104:107]
  ds_read_b64_tr_b16 v[20:21], v3 offset:216
  v_mfma_f32_16x16x32_bf16 v[108:111], v[24:27], v[196:199], v[108:111]
  ds_read_b64_tr_b16 v[22:23], v3 offset:4824
  v_mfma_f32_16x16x32_bf16 v[40:43], v[28:31], v[192:195], v[40:43]
  ds_read_b64_tr_b16 v[24:25], v3 offset:248
  v_mfma_f32_16x16x32_bf16 v[44:47], v[28:31], v[196:199], v[44:47]
  ds_read_b64_tr_b16 v[26:27], v3 offset:4856
  s_waitcnt lgkmcnt(6)
  v_mfma_f32_16x16x32_bf16 v[48:51], v[32:35], v[192:195], v[48:51]
  ds_read_b64_tr_b16 v[28:29], v3 offset:9288
  v_mfma_f32_16x16x32_bf16 v[52:55], v[32:35], v[196:199], v[52:55]
  ds_read_b64_tr_b16 v[30:31], v3 offset:13896
  ds_read_b128 v[200:203], v2 offset:0
  v_mfma_f32_16x16x32_bf16 v[72:75], v[36:39], v[192:195], v[72:75]
  ds_read_b64_tr_b16 v[32:33], v3 offset:9320
  v_mfma_f32_16x16x32_bf16 v[76:79], v[36:39], v[196:199], v[76:79]
  ds_read_b64_tr_b16 v[34:35], v3 offset:13928
  ds_read_b128 v[204:207], v2 offset:2048
  s_waitcnt lgkmcnt(8)
  v_mfma_f32_16x16x32_bf16 v[80:83], v[16:19], v[192:195], v[80:83]
  ds_read_b64_tr_b16 v[36:37], v4 offset:9216
  v_mfma_f32_16x16x32_bf16 v[84:87], v[16:19], v[196:199], v[84:87]
  ds_read_b64_tr_b16 v[38:39], v4 offset:13824
  v_mfma_f32_16x16x32_bf16 v[88:91], v[20:23], v[192:195], v[88:91]
  ds_read_b64_tr_b16 v[16:17], v3 offset:9216
  v_mfma_f32_16x16x32_bf16 v[92:95], v[20:23], v[196:199], v[92:95]
  ds_read_b64_tr_b16 v[18:19], v3 offset:13824
  s_waitcnt lgkmcnt(8)
  v_mfma_f32_16x16x32_bf16 v[96:99], v[24:27], v[192:195], v[96:99]
  ds_read_b64_tr_b16 v[20:21], v3 offset:9248
  v_mfma_f32_16x16x32_bf16 v[100:103], v[24:27], v[196:199], v[100:103]
  ds_read_b64_tr_b16 v[22:23], v3 offset:13856
  s_waitcnt lgkmcnt(9)
  v_mfma_f32_16x16x32_bf16 v[56:59], v[28:31], v[200:203], v[56:59]
  ds_read_b64_tr_b16 v[24:25], v3 offset:9360
  s_waitcnt lgkmcnt(7)
  v_mfma_f32_16x16x32_bf16 v[60:63], v[28:31], v[204:207], v[60:63]
  ds_read_b64_tr_b16 v[26:27], v3 offset:13968
  s_waitcnt lgkmcnt(6)
  v_mfma_f32_16x16x32_bf16 v[64:67], v[32:35], v[200:203], v[64:67]
  ds_read_b64_tr_b16 v[28:29], v3 offset:9392
  v_mfma_f32_16x16x32_bf16 v[68:71], v[32:35], v[204:207], v[68:71]
  ds_read_b64_tr_b16 v[30:31], v3 offset:14000
  v_mfma_f32_16x16x32_bf16 v[104:107], v[36:39], v[200:203], v[104:107]
  ds_read_b64_tr_b16 v[32:33], v3 offset:9432
  v_mfma_f32_16x16x32_bf16 v[108:111], v[36:39], v[204:207], v[108:111]
  ds_read_b64_tr_b16 v[34:35], v3 offset:14040
  s_waitcnt lgkmcnt(6)
  v_mfma_f32_16x16x32_bf16 v[40:43], v[16:19], v[200:203], v[40:43]
  ds_read_b64_tr_b16 v[36:37], v3 offset:9464
  v_mfma_f32_16x16x32_bf16 v[44:47], v[16:19], v[204:207], v[44:47]
  ds_read_b64_tr_b16 v[38:39], v3 offset:14072
  v_mfma_f32_16x16x32_bf16 v[48:51], v[20:23], v[200:203], v[48:51]
  v_add_u32 v1, 34816, v1
  v_add_u32 v2, 34816, v2
  v_add_u32 v3, 34816, v3
  v_add_u32 v4, 34816, v4
  s_barrier
  ds_read_b64_tr_b16 v[16:17], v3 offset:72
  v_mfma_f32_16x16x32_bf16 v[52:55], v[20:23], v[204:207], v[52:55]
  ds_read_b64_tr_b16 v[18:19], v3 offset:4680
  ds_read_b128 v[208:211], v1 offset:0
  s_waitcnt lgkmcnt(7)
  v_mfma_f32_16x16x32_bf16 v[72:75], v[24:27], v[200:203], v[72:75]
  ds_read_b64_tr_b16 v[20:21], v3 offset:104
  v_mfma_f32_16x16x32_bf16 v[76:79], v[24:27], v[204:207], v[76:79]
  ds_read_b64_tr_b16 v[22:23], v3 offset:4712
  ds_read_b128 v[212:215], v1 offset:2048
  v_mfma_f32_16x16x32_bf16 v[80:83], v[28:31], v[200:203], v[80:83]
  ds_read_b64_tr_b16 v[24:25], v4 offset:0
  v_mfma_f32_16x16x32_bf16 v[84:87], v[28:31], v[204:207], v[84:87]
  ds_read_b64_tr_b16 v[26:27], v4 offset:4608
  s_waitcnt lgkmcnt(8)
  v_mfma_f32_16x16x32_bf16 v[88:91], v[32:35], v[200:203], v[88:91]
  ds_read_b64_tr_b16 v[28:29], v3 offset:0
  v_mfma_f32_16x16x32_bf16 v[92:95], v[32:35], v[204:207], v[92:95]
  ds_read_b64_tr_b16 v[30:31], v3 offset:4608
  v_mfma_f32_16x16x32_bf16 v[96:99], v[36:39], v[200:203], v[96:99]
  ds_read_b64_tr_b16 v[32:33], v3 offset:32
  v_mfma_f32_16x16x32_bf16 v[100:103], v[36:39], v[204:207], v[100:103]
  ds_read_b64_tr_b16 v[34:35], v3 offset:4640
  s_waitcnt lgkmcnt(7)
  v_mfma_f32_16x16x32_bf16 v[56:59], v[16:19], v[208:211], v[56:59]
  ds_read_b64_tr_b16 v[36:37], v3 offset:144
  s_waitcnt lgkmcnt(7)
  v_mfma_f32_16x16x32_bf16 v[60:63], v[16:19], v[212:215], v[60:63]
  ds_read_b64_tr_b16 v[38:39], v3 offset:4752
  v_mfma_f32_16x16x32_bf16 v[64:67], v[20:23], v[208:211], v[64:67]
  ds_read_b64_tr_b16 v[16:17], v3 offset:176
  v_mfma_f32_16x16x32_bf16 v[68:71], v[20:23], v[212:215], v[68:71]
  ds_read_b64_tr_b16 v[18:19], v3 offset:4784
  s_waitcnt lgkmcnt(6)
  v_mfma_f32_16x16x32_bf16 v[104:107], v[24:27], v[208:211], v[104:107]
  ds_read_b64_tr_b16 v[20:21], v3 offset:216
  v_mfma_f32_16x16x32_bf16 v[108:111], v[24:27], v[212:215], v[108:111]
  ds_read_b64_tr_b16 v[22:23], v3 offset:4824
  v_mfma_f32_16x16x32_bf16 v[40:43], v[28:31], v[208:211], v[40:43]
  ds_read_b64_tr_b16 v[24:25], v3 offset:248
  v_mfma_f32_16x16x32_bf16 v[44:47], v[28:31], v[212:215], v[44:47]
  ds_read_b64_tr_b16 v[26:27], v3 offset:4856
  s_waitcnt lgkmcnt(6)
  v_mfma_f32_16x16x32_bf16 v[48:51], v[32:35], v[208:211], v[48:51]
  ds_read_b64_tr_b16 v[28:29], v3 offset:9288
  v_mfma_f32_16x16x32_bf16 v[52:55], v[32:35], v[212:215], v[52:55]
  ds_read_b64_tr_b16 v[30:31], v3 offset:13896
  ds_read_b128 v[216:219], v2 offset:0
  v_mfma_f32_16x16x32_bf16 v[72:75], v[36:39], v[208:211], v[72:75]
  ds_read_b64_tr_b16 v[32:33], v3 offset:9320
  v_mfma_f32_16x16x32_bf16 v[76:79], v[36:39], v[212:215], v[76:79]
  ds_read_b64_tr_b16 v[34:35], v3 offset:13928
  ds_read_b128 v[220:223], v2 offset:2048
  s_waitcnt lgkmcnt(8)
  v_mfma_f32_16x16x32_bf16 v[80:83], v[16:19], v[208:211], v[80:83]
  ds_read_b64_tr_b16 v[36:37], v4 offset:9216
  v_mfma_f32_16x16x32_bf16 v[84:87], v[16:19], v[212:215], v[84:87]
  ds_read_b64_tr_b16 v[38:39], v4 offset:13824
  v_mfma_f32_16x16x32_bf16 v[88:91], v[20:23], v[208:211], v[88:91]
  ds_read_b64_tr_b16 v[16:17], v3 offset:9216
  v_mfma_f32_16x16x32_bf16 v[92:95], v[20:23], v[212:215], v[92:95]
  ds_read_b64_tr_b16 v[18:19], v3 offset:13824
  s_waitcnt lgkmcnt(8)
  v_mfma_f32_16x16x32_bf16 v[96:99], v[24:27], v[208:211], v[96:99]
  ds_read_b64_tr_b16 v[20:21], v3 offset:9248
  v_mfma_f32_16x16x32_bf16 v[100:103], v[24:27], v[212:215], v[100:103]
  ds_read_b64_tr_b16 v[22:23], v3 offset:13856
  s_waitcnt lgkmcnt(9)
  v_mfma_f32_16x16x32_bf16 v[56:59], v[28:31], v[216:219], v[56:59]
  ds_read_b64_tr_b16 v[24:25], v3 offset:9360
  s_waitcnt lgkmcnt(7)
  v_mfma_f32_16x16x32_bf16 v[60:63], v[28:31], v[220:223], v[60:63]
  ds_read_b64_tr_b16 v[26:27], v3 offset:13968
  s_waitcnt lgkmcnt(6)
  v_mfma_f32_16x16x32_bf16 v[64:67], v[32:35], v[216:219], v[64:67]
  ds_read_b64_tr_b16 v[28:29], v3 offset:9392
  v_mfma_f32_16x16x32_bf16 v[68:71], v[32:35], v[220:223], v[68:71]
  ds_read_b64_tr_b16 v[30:31], v3 offset:14000
  v_mfma_f32_16x16x32_bf16 v[104:107], v[36:39], v[216:219], v[104:107]
  ds_read_b64_tr_b16 v[32:33], v3 offset:9432
  v_mfma_f32_16x16x32_bf16 v[108:111], v[36:39], v[220:223], v[108:111]
  ds_read_b64_tr_b16 v[34:35], v3 offset:14040
  s_waitcnt lgkmcnt(6)
  v_mfma_f32_16x16x32_bf16 v[40:43], v[16:19], v[216:219], v[40:43]
  ds_read_b64_tr_b16 v[36:37], v3 offset:9464
  v_mfma_f32_16x16x32_bf16 v[44:47], v[16:19], v[220:223], v[44:47]
  ds_read_b64_tr_b16 v[38:39], v3 offset:14072
  v_mfma_f32_16x16x32_bf16 v[48:51], v[20:23], v[216:219], v[48:51]
  v_add_u32 v1, 34816, v1
  v_add_u32 v2, 34816, v2
  v_add_u32 v3, 34816, v3
  v_add_u32 v4, 34816, v4
  s_barrier
  ds_read_b64_tr_b16 v[16:17], v3 offset:72
  v_mfma_f32_16x16x32_bf16 v[52:55], v[20:23], v[220:223], v[52:55]
  ds_read_b64_tr_b16 v[18:19], v3 offset:4680
  ds_read_b128 v[224:227], v1 offset:0
  s_waitcnt lgkmcnt(7)
  v_mfma_f32_16x16x32_bf16 v[72:75], v[24:27], v[216:219], v[72:75]
  ds_read_b64_tr_b16 v[20:21], v3 offset:104
  v_mfma_f32_16x16x32_bf16 v[76:79], v[24:27], v[220:223], v[76:79]
  ds_read_b64_tr_b16 v[22:23], v3 offset:4712
  ds_read_b128 v[228:231], v1 offset:2048
  v_mfma_f32_16x16x32_bf16 v[80:83], v[28:31], v[216:219], v[80:83]
  ds_read_b64_tr_b16 v[24:25], v4 offset:0
  v_mfma_f32_16x16x32_bf16 v[84:87], v[28:31], v[220:223], v[84:87]
  ds_read_b64_tr_b16 v[26:27], v4 offset:4608
  s_waitcnt lgkmcnt(8)
  v_mfma_f32_16x16x32_bf16 v[88:91], v[32:35], v[216:219], v[88:91]
  ds_read_b64_tr_b16 v[28:29], v3 offset:0
  v_mfma_f32_16x16x32_bf16 v[92:95], v[32:35], v[220:223], v[92:95]
  ds_read_b64_tr_b16 v[30:31], v3 offset:4608
  v_mfma_f32_16x16x32_bf16 v[96:99], v[36:39], v[216:219], v[96:99]
  ds_read_b64_tr_b16 v[32:33], v3 offset:32
  v_mfma_f32_16x16x32_bf16 v[100:103], v[36:39], v[220:223], v[100:103]
  ds_read_b64_tr_b16 v[34:35], v3 offset:4640
  s_waitcnt lgkmcnt(7)
  v_mfma_f32_16x16x32_bf16 v[56:59], v[16:19], v[224:227], v[56:59]
  ds_read_b64_tr_b16 v[36:37], v3 offset:144
  s_waitcnt lgkmcnt(7)
  v_mfma_f32_16x16x32_bf16 v[60:63], v[16:19], v[228:231], v[60:63]
  ds_read_b64_tr_b16 v[38:39], v3 offset:4752
  v_mfma_f32_16x16x32_bf16 v[64:67], v[20:23], v[224:227], v[64:67]
  ds_read_b64_tr_b16 v[16:17], v3 offset:176
  v_mfma_f32_16x16x32_bf16 v[68:71], v[20:23], v[228:231], v[68:71]
  ds_read_b64_tr_b16 v[18:19], v3 offset:4784
  s_waitcnt lgkmcnt(6)
  v_mfma_f32_16x16x32_bf16 v[104:107], v[24:27], v[224:227], v[104:107]
  ds_read_b64_tr_b16 v[20:21], v3 offset:216
  v_mfma_f32_16x16x32_bf16 v[108:111], v[24:27], v[228:231], v[108:111]
  ds_read_b64_tr_b16 v[22:23], v3 offset:4824
  v_mfma_f32_16x16x32_bf16 v[40:43], v[28:31], v[224:227], v[40:43]
  ds_read_b64_tr_b16 v[24:25], v3 offset:248
  v_mfma_f32_16x16x32_bf16 v[44:47], v[28:31], v[228:231], v[44:47]
  ds_read_b64_tr_b16 v[26:27], v3 offset:4856
  s_waitcnt lgkmcnt(6)
  v_mfma_f32_16x16x32_bf16 v[48:51], v[32:35], v[224:227], v[48:51]
  ds_read_b64_tr_b16 v[28:29], v3 offset:9288
  v_mfma_f32_16x16x32_bf16 v[52:55], v[32:35], v[228:231], v[52:55]
  ds_read_b64_tr_b16 v[30:31], v3 offset:13896
  ds_read_b128 v[232:235], v2 offset:0
  v_mfma_f32_16x16x32_bf16 v[72:75], v[36:39], v[224:227], v[72:75]
  ds_read_b64_tr_b16 v[32:33], v3 offset:9320
  v_mfma_f32_16x16x32_bf16 v[76:79], v[36:39], v[228:231], v[76:79]
  ds_read_b64_tr_b16 v[34:35], v3 offset:13928
  ds_read_b128 v[236:239], v2 offset:2048
  s_waitcnt lgkmcnt(8)
  v_mfma_f32_16x16x32_bf16 v[80:83], v[16:19], v[224:227], v[80:83]
  ds_read_b64_tr_b16 v[36:37], v4 offset:9216
  v_mfma_f32_16x16x32_bf16 v[84:87], v[16:19], v[228:231], v[84:87]
  ds_read_b64_tr_b16 v[38:39], v4 offset:13824
  v_mfma_f32_16x16x32_bf16 v[88:91], v[20:23], v[224:227], v[88:91]
  ds_read_b64_tr_b16 v[16:17], v3 offset:9216
  v_mfma_f32_16x16x32_bf16 v[92:95], v[20:23], v[228:231], v[92:95]
  ds_read_b64_tr_b16 v[18:19], v3 offset:13824
  s_waitcnt lgkmcnt(8)
  v_mfma_f32_16x16x32_bf16 v[96:99], v[24:27], v[224:227], v[96:99]
  ds_read_b64_tr_b16 v[20:21], v3 offset:9248
  v_mfma_f32_16x16x32_bf16 v[100:103], v[24:27], v[228:231], v[100:103]
  ds_read_b64_tr_b16 v[22:23], v3 offset:13856
  s_waitcnt lgkmcnt(9)
  v_mfma_f32_16x16x32_bf16 v[56:59], v[28:31], v[232:235], v[56:59]
  ds_read_b64_tr_b16 v[24:25], v3 offset:9360
  s_waitcnt lgkmcnt(7)
  v_mfma_f32_16x16x32_bf16 v[60:63], v[28:31], v[236:239], v[60:63]
  ds_read_b64_tr_b16 v[26:27], v3 offset:13968
  s_waitcnt lgkmcnt(6)
  v_mfma_f32_16x16x32_bf16 v[64:67], v[32:35], v[232:235], v[64:67]
  ds_read_b64_tr_b16 v[28:29], v3 offset:9392
  v_mfma_f32_16x16x32_bf16 v[68:71], v[32:35], v[236:239], v[68:71]
  ds_read_b64_tr_b16 v[30:31], v3 offset:14000
  v_mfma_f32_16x16x32_bf16 v[104:107], v[36:39], v[232:235], v[104:107]
  ds_read_b64_tr_b16 v[32:33], v3 offset:9432
  v_mfma_f32_16x16x32_bf16 v[108:111], v[36:39], v[236:239], v[108:111]
  ds_read_b64_tr_b16 v[34:35], v3 offset:14040
  s_waitcnt lgkmcnt(6)
  v_mfma_f32_16x16x32_bf16 v[40:43], v[16:19], v[232:235], v[40:43]
  ds_read_b64_tr_b16 v[36:37], v3 offset:9464
  v_mfma_f32_16x16x32_bf16 v[44:47], v[16:19], v[236:239], v[44:47]
  ds_read_b64_tr_b16 v[38:39], v3 offset:14072
  v_mfma_f32_16x16x32_bf16 v[48:51], v[20:23], v[232:235], v[48:51]
  v_add_u32 v1, 34816, v1
  v_add_u32 v2, 34816, v2
  v_add_u32 v3, 34816, v3
  v_add_u32 v4, 34816, v4
  s_waitcnt vmcnt(0)
  s_barrier
  ds_read_b64_tr_b16 v[16:17], v3 offset:72
  v_mfma_f32_16x16x32_bf16 v[52:55], v[20:23], v[236:239], v[52:55]
  ds_read_b64_tr_b16 v[18:19], v3 offset:4680
  ds_read_b128 v[240:243], v1 offset:0
  s_waitcnt lgkmcnt(7)
  v_mfma_f32_16x16x32_bf16 v[72:75], v[24:27], v[232:235], v[72:75]
  ds_read_b64_tr_b16 v[20:21], v3 offset:104
  v_mfma_f32_16x16x32_bf16 v[76:79], v[24:27], v[236:239], v[76:79]
  ds_read_b64_tr_b16 v[22:23], v3 offset:4712
  ds_read_b128 v[244:247], v1 offset:2048
  v_mfma_f32_16x16x32_bf16 v[80:83], v[28:31], v[232:235], v[80:83]
  ds_read_b64_tr_b16 v[24:25], v4 offset:0
  v_mfma_f32_16x16x32_bf16 v[84:87], v[28:31], v[236:239], v[84:87]
  ds_read_b64_tr_b16 v[26:27], v4 offset:4608
  s_waitcnt lgkmcnt(8)
  v_mfma_f32_16x16x32_bf16 v[88:91], v[32:35], v[232:235], v[88:91]
  ds_read_b64_tr_b16 v[28:29], v3 offset:0
  v_mfma_f32_16x16x32_bf16 v[92:95], v[32:35], v[236:239], v[92:95]
  ds_read_b64_tr_b16 v[30:31], v3 offset:4608
  v_mfma_f32_16x16x32_bf16 v[96:99], v[36:39], v[232:235], v[96:99]
  ds_read_b64_tr_b16 v[32:33], v3 offset:32
  v_mfma_f32_16x16x32_bf16 v[100:103], v[36:39], v[236:239], v[100:103]
  ds_read_b64_tr_b16 v[34:35], v3 offset:4640
  s_waitcnt lgkmcnt(7)
  v_mfma_f32_16x16x32_bf16 v[56:59], v[16:19], v[240:243], v[56:59]
  ds_read_b64_tr_b16 v[36:37], v3 offset:144
  s_waitcnt lgkmcnt(7)
  v_mfma_f32_16x16x32_bf16 v[60:63], v[16:19], v[244:247], v[60:63]
  ds_read_b64_tr_b16 v[38:39], v3 offset:4752
  v_mfma_f32_16x16x32_bf16 v[64:67], v[20:23], v[240:243], v[64:67]
  ds_read_b64_tr_b16 v[16:17], v3 offset:176
  v_mfma_f32_16x16x32_bf16 v[68:71], v[20:23], v[244:247], v[68:71]
  ds_read_b64_tr_b16 v[18:19], v3 offset:4784
  s_waitcnt lgkmcnt(6)
  v_mfma_f32_16x16x32_bf16 v[104:107], v[24:27], v[240:243], v[104:107]
  ds_read_b64_tr_b16 v[20:21], v3 offset:216
  v_mfma_f32_16x16x32_bf16 v[108:111], v[24:27], v[244:247], v[108:111]
  ds_read_b64_tr_b16 v[22:23], v3 offset:4824
  v_mfma_f32_16x16x32_bf16 v[40:43], v[28:31], v[240:243], v[40:43]
  ds_read_b64_tr_b16 v[24:25], v3 offset:248
  v_mfma_f32_16x16x32_bf16 v[44:47], v[28:31], v[244:247], v[44:47]
  ds_read_b64_tr_b16 v[26:27], v3 offset:4856
  s_waitcnt lgkmcnt(6)
  v_mfma_f32_16x16x32_bf16 v[48:51], v[32:35], v[240:243], v[48:51]
  ds_read_b64_tr_b16 v[28:29], v3 offset:9288
  v_mfma_f32_16x16x32_bf16 v[52:55], v[32:35], v[244:247], v[52:55]
  ds_read_b64_tr_b16 v[30:31], v3 offset:13896
  ds_read_b128 v[248:251], v2 offset:0
  v_mfma_f32_16x16x32_bf16 v[72:75], v[36:39], v[240:243], v[72:75]
  ds_read_b64_tr_b16 v[32:33], v3 offset:9320
  v_mfma_f32_16x16x32_bf16 v[76:79], v[36:39], v[244:247], v[76:79]
  ds_read_b64_tr_b16 v[34:35], v3 offset:13928
  ds_read_b128 v[252:255], v2 offset:2048
  s_waitcnt lgkmcnt(8)
  v_mfma_f32_16x16x32_bf16 v[80:83], v[16:19], v[240:243], v[80:83]
  ds_read_b64_tr_b16 v[36:37], v4 offset:9216
  v_mfma_f32_16x16x32_bf16 v[84:87], v[16:19], v[244:247], v[84:87]
  ds_read_b64_tr_b16 v[38:39], v4 offset:13824
  v_mfma_f32_16x16x32_bf16 v[88:91], v[20:23], v[240:243], v[88:91]
  ds_read_b64_tr_b16 v[16:17], v3 offset:9216
  v_mfma_f32_16x16x32_bf16 v[92:95], v[20:23], v[244:247], v[92:95]
  ds_read_b64_tr_b16 v[18:19], v3 offset:13824
  s_waitcnt lgkmcnt(8)
  v_mfma_f32_16x16x32_bf16 v[96:99], v[24:27], v[240:243], v[96:99]
  ds_read_b64_tr_b16 v[20:21], v3 offset:9248
  v_mfma_f32_16x16x32_bf16 v[100:103], v[24:27], v[244:247], v[100:103]
  ds_read_b64_tr_b16 v[22:23], v3 offset:13856
  s_waitcnt lgkmcnt(9)
  v_mfma_f32_16x16x32_bf16 v[56:59], v[28:31], v[248:251], v[56:59]
  ds_read_b64_tr_b16 v[24:25], v3 offset:9360
  s_waitcnt lgkmcnt(7)
  v_mfma_f32_16x16x32_bf16 v[60:63], v[28:31], v[252:255], v[60:63]
  ds_read_b64_tr_b16 v[26:27], v3 offset:13968
  s_waitcnt lgkmcnt(6)
  v_mfma_f32_16x16x32_bf16 v[64:67], v[32:35], v[248:251], v[64:67]
  ds_read_b64_tr_b16 v[28:29], v3 offset:9392
  v_mfma_f32_16x16x32_bf16 v[68:71], v[32:35], v[252:255], v[68:71]
  ds_read_b64_tr_b16 v[30:31], v3 offset:14000
  v_mfma_f32_16x16x32_bf16 v[104:107], v[36:39], v[248:251], v[104:107]
  ds_read_b64_tr_b16 v[32:33], v3 offset:9432
  v_mfma_f32_16x16x32_bf16 v[108:111], v[36:39], v[252:255], v[108:111]
  ds_read_b64_tr_b16 v[34:35], v3 offset:14040
  s_waitcnt lgkmcnt(6)
  v_mfma_f32_16x16x32_bf16 v[40:43], v[16:19], v[248:251], v[40:43]
  ds_read_b64_tr_b16 v[36:37], v3 offset:9464
  v_mfma_f32_16x16x32_bf16 v[44:47], v[16:19], v[252:255], v[44:47]
  ds_read_b64_tr_b16 v[38:39], v3 offset:14072
  v_mfma_f32_16x16x32_bf16 v[48:51], v[20:23], v[248:251], v[48:51]
  v_mfma_f32_16x16x32_bf16 v[52:55], v[20:23], v[252:255], v[52:55]
  s_waitcnt lgkmcnt(4)
  v_mfma_f32_16x16x32_bf16 v[72:75], v[24:27], v[248:251], v[72:75]
  v_mfma_f32_16x16x32_bf16 v[76:79], v[24:27], v[252:255], v[76:79]
  v_mfma_f32_16x16x32_bf16 v[80:83], v[28:31], v[248:251], v[80:83]
  v_add_u32 v3, 4294846464, v3
  v_add_u32 v4, 4294846464, v4
  s_waitcnt lgkmcnt(0)
  s_barrier
  v_mfma_f32_16x16x32_bf16 v[84:87], v[28:31], v[252:255], v[84:87]
  v_mfma_f32_16x16x32_bf16 v[88:91], v[32:35], v[248:251], v[88:91]
  v_mfma_f32_16x16x32_bf16 v[92:95], v[32:35], v[252:255], v[92:95]
  v_mfma_f32_16x16x32_bf16 v[96:99], v[36:39], v[248:251], v[96:99]
  v_mfma_f32_16x16x32_bf16 v[100:103], v[36:39], v[252:255], v[100:103]
  v_cvt_pk_bf16_f32 v36, v104, v105
  v_cvt_pk_bf16_f32 v37, v106, v107
  v_pk_mul_f32 v[16:17], v[40:41], s[76:77]
  v_pk_mul_f32 v[18:19], v[42:43], s[76:77]
  v_pk_mul_f32 v[20:21], v[48:49], s[76:77]
  v_pk_mul_f32 v[22:23], v[50:51], s[76:77]
  v_pk_mul_f32 v[24:25], v[56:57], s[76:77]
  v_pk_mul_f32 v[26:27], v[58:59], s[76:77]
  v_pk_mul_f32 v[28:29], v[64:65], s[76:77]
  v_pk_mul_f32 v[30:31], v[66:67], s[76:77]
  v_pk_mul_f32 v[32:33], v[104:105], s[76:77]
  v_pk_mul_f32 v[34:35], v[106:107], s[76:77]
  v_exp_f32 v16, v16 clamp
  v_exp_f32 v17, v17 clamp
  v_exp_f32 v18, v18 clamp
  v_exp_f32 v19, v19 clamp
  v_exp_f32 v20, v20 clamp
  v_exp_f32 v21, v21 clamp
  v_exp_f32 v22, v22 clamp
  v_exp_f32 v23, v23 clamp
  v_exp_f32 v24, v24 clamp
  v_exp_f32 v25, v25 clamp
  v_exp_f32 v26, v26 clamp
  v_exp_f32 v27, v27 clamp
  v_exp_f32 v28, v28 clamp
  v_exp_f32 v29, v29 clamp
  v_exp_f32 v30, v30 clamp
  v_exp_f32 v31, v31 clamp
  v_exp_f32 v32, v32 clamp
  v_exp_f32 v33, v33 clamp
  v_exp_f32 v34, v34 clamp
  v_exp_f32 v35, v35 clamp
  v_max_f32 v40, s78, v40
  v_max_f32 v41, s78, v41
  v_max_f32 v42, s78, v42
  v_max_f32 v43, s78, v43
  v_max_f32 v48, s78, v48
  v_max_f32 v49, s78, v49
  v_max_f32 v50, s78, v50
  v_max_f32 v51, s78, v51
  v_max_f32 v56, s78, v56
  v_max_f32 v57, s78, v57
  v_max_f32 v58, s78, v58
  v_max_f32 v59, s78, v59
  v_max_f32 v64, s78, v64
  v_max_f32 v65, s78, v65
  v_max_f32 v66, s78, v66
  v_max_f32 v67, s78, v67
  v_max_f32 v104, s78, v104
  v_max_f32 v105, s78, v105
  v_max_f32 v106, s78, v106
  v_max_f32 v107, s78, v107
  v_pk_add_f32 v[40:41], v[40:41], v[16:17]
  v_pk_add_f32 v[42:43], v[42:43], v[18:19]
  v_pk_add_f32 v[48:49], v[48:49], v[20:21]
  v_pk_add_f32 v[50:51], v[50:51], v[22:23]
  v_pk_add_f32 v[56:57], v[56:57], v[24:25]
  v_pk_add_f32 v[58:59], v[58:59], v[26:27]
  v_pk_add_f32 v[64:65], v[64:65], v[28:29]
  v_pk_add_f32 v[66:67], v[66:67], v[30:31]
  v_pk_add_f32 v[104:105], v[104:105], v[32:33]
  v_pk_add_f32 v[106:107], v[106:107], v[34:35]
  v_cvt_pk_bf16_f32 v40, v40, v41
  v_cvt_pk_bf16_f32 v41, v42, v43
  ds_write_b64 v5, v[40:41] offset:0
  v_cvt_pk_bf16_f32 v48, v48, v49
  v_cvt_pk_bf16_f32 v49, v50, v51
  ds_write_b64 v5, v[48:49] offset:32
  v_cvt_pk_bf16_f32 v56, v56, v57
  v_cvt_pk_bf16_f32 v57, v58, v59
  ds_write_b64 v5, v[56:57] offset:72
  v_cvt_pk_bf16_f32 v64, v64, v65
  v_cvt_pk_bf16_f32 v65, v66, v67
  ds_write_b64 v5, v[64:65] offset:104
  v_cvt_pk_bf16_f32 v72, v72, v73
  v_cvt_pk_bf16_f32 v73, v74, v75
  ds_write_b64 v5, v[72:73] offset:144
  v_cvt_pk_bf16_f32 v80, v80, v81
  v_cvt_pk_bf16_f32 v81, v82, v83
  ds_write_b64 v5, v[80:81] offset:176
  v_cvt_pk_bf16_f32 v88, v88, v89
  v_cvt_pk_bf16_f32 v89, v90, v91
  ds_write_b64 v5, v[88:89] offset:216
  v_cvt_pk_bf16_f32 v96, v96, v97
  v_cvt_pk_bf16_f32 v97, v98, v99
  ds_write_b64 v5, v[96:97] offset:248
  v_cvt_pk_bf16_f32 v104, v104, v105
  v_cvt_pk_bf16_f32 v105, v106, v107
  v_cndmask_b32 v104, v36, v104, s[32:33]
  v_cndmask_b32 v105, v37, v105, s[32:33]
  ds_write_b64 v6, v[104:105] offset:64
  v_cvt_pk_bf16_f32 v38, v108, v109
  v_cvt_pk_bf16_f32 v39, v110, v111
  v_pk_mul_f32 v[16:17], v[44:45], s[76:77]
  v_pk_mul_f32 v[18:19], v[46:47], s[76:77]
  v_pk_mul_f32 v[20:21], v[52:53], s[76:77]
  v_pk_mul_f32 v[22:23], v[54:55], s[76:77]
  v_pk_mul_f32 v[24:25], v[60:61], s[76:77]
  v_pk_mul_f32 v[26:27], v[62:63], s[76:77]
  v_pk_mul_f32 v[28:29], v[68:69], s[76:77]
  v_pk_mul_f32 v[30:31], v[70:71], s[76:77]
  v_pk_mul_f32 v[32:33], v[108:109], s[76:77]
  v_pk_mul_f32 v[34:35], v[110:111], s[76:77]
  v_exp_f32 v16, v16 clamp
  v_exp_f32 v17, v17 clamp
  v_exp_f32 v18, v18 clamp
  v_exp_f32 v19, v19 clamp
  v_exp_f32 v20, v20 clamp
  v_exp_f32 v21, v21 clamp
  v_exp_f32 v22, v22 clamp
  v_exp_f32 v23, v23 clamp
  v_exp_f32 v24, v24 clamp
  v_exp_f32 v25, v25 clamp
  v_exp_f32 v26, v26 clamp
  v_exp_f32 v27, v27 clamp
  v_exp_f32 v28, v28 clamp
  v_exp_f32 v29, v29 clamp
  v_exp_f32 v30, v30 clamp
  v_exp_f32 v31, v31 clamp
  v_exp_f32 v32, v32 clamp
  v_exp_f32 v33, v33 clamp
  v_exp_f32 v34, v34 clamp
  v_exp_f32 v35, v35 clamp
  v_max_f32 v44, s78, v44
  v_max_f32 v45, s78, v45
  v_max_f32 v46, s78, v46
  v_max_f32 v47, s78, v47
  v_max_f32 v52, s78, v52
  v_max_f32 v53, s78, v53
  v_max_f32 v54, s78, v54
  v_max_f32 v55, s78, v55
  v_max_f32 v60, s78, v60
  v_max_f32 v61, s78, v61
  v_max_f32 v62, s78, v62
  v_max_f32 v63, s78, v63
  v_max_f32 v68, s78, v68
  v_max_f32 v69, s78, v69
  v_max_f32 v70, s78, v70
  v_max_f32 v71, s78, v71
  v_max_f32 v108, s78, v108
  v_max_f32 v109, s78, v109
  v_max_f32 v110, s78, v110
  v_max_f32 v111, s78, v111
  v_pk_add_f32 v[44:45], v[44:45], v[16:17]
  v_pk_add_f32 v[46:47], v[46:47], v[18:19]
  v_pk_add_f32 v[52:53], v[52:53], v[20:21]
  v_pk_add_f32 v[54:55], v[54:55], v[22:23]
  v_pk_add_f32 v[60:61], v[60:61], v[24:25]
  v_pk_add_f32 v[62:63], v[62:63], v[26:27]
  v_pk_add_f32 v[68:69], v[68:69], v[28:29]
  v_pk_add_f32 v[70:71], v[70:71], v[30:31]
  v_pk_add_f32 v[108:109], v[108:109], v[32:33]
  v_pk_add_f32 v[110:111], v[110:111], v[34:35]
  v_cvt_pk_bf16_f32 v44, v44, v45
  v_cvt_pk_bf16_f32 v45, v46, v47
  ds_write_b64 v5, v[44:45] offset:4736
  v_cvt_pk_bf16_f32 v52, v52, v53
  v_cvt_pk_bf16_f32 v53, v54, v55
  ds_write_b64 v5, v[52:53] offset:4768
  v_cvt_pk_bf16_f32 v60, v60, v61
  v_cvt_pk_bf16_f32 v61, v62, v63
  ds_write_b64 v5, v[60:61] offset:4808
  v_cvt_pk_bf16_f32 v68, v68, v69
  v_cvt_pk_bf16_f32 v69, v70, v71
  ds_write_b64 v5, v[68:69] offset:4840
  v_cvt_pk_bf16_f32 v76, v76, v77
  v_cvt_pk_bf16_f32 v77, v78, v79
  ds_write_b64 v5, v[76:77] offset:4880
  v_cvt_pk_bf16_f32 v84, v84, v85
  v_cvt_pk_bf16_f32 v85, v86, v87
  ds_write_b64 v5, v[84:85] offset:4912
  v_cvt_pk_bf16_f32 v92, v92, v93
  v_cvt_pk_bf16_f32 v93, v94, v95
  ds_write_b64 v5, v[92:93] offset:4952
  v_cvt_pk_bf16_f32 v100, v100, v101
  v_cvt_pk_bf16_f32 v101, v102, v103
  ds_write_b64 v5, v[100:101] offset:4984
  v_cvt_pk_bf16_f32 v108, v108, v109
  v_cvt_pk_bf16_f32 v109, v110, v111
  v_cndmask_b32 v108, v38, v108, s[32:33]
  v_cndmask_b32 v109, v39, v109, s[32:33]
  ds_write_b64 v6, v[108:109] offset:4800
  v_add_u32 v1, 55296, v3
  v_add_u32 v2, 55296, v4
  v_add_u32 v5, 154368, v14
  v_mov_b32 v6, 163832
  ds_read_b64_tr_b16 v[16:17], v3 offset:72
  ds_read_b64_tr_b16 v[18:19], v3 offset:4680
  ds_read_b64_tr_b16 v[20:21], v3 offset:104
  ds_read_b64_tr_b16 v[22:23], v3 offset:4712
  ds_read_b64_tr_b16 v[24:25], v4 offset:0
  ds_read_b64_tr_b16 v[26:27], v4 offset:4608
  ds_read_b64_tr_b16 v[28:29], v3 offset:0
  ds_read_b64_tr_b16 v[30:31], v3 offset:4608
  ds_read_b64_tr_b16 v[32:33], v3 offset:32
  ds_read_b64_tr_b16 v[34:35], v3 offset:4640
  s_waitcnt lgkmcnt(10)
  s_barrier
  s_waitcnt lgkmcnt(8)
  v_mfma_f32_16x16x32_bf16 v[56:59], v[16:19], v[112:115], 0
  ds_read_b64_tr_b16 v[36:37], v3 offset:216
  v_mfma_f32_16x16x32_bf16 v[60:63], v[16:19], v[116:119], 0
  ds_read_b64_tr_b16 v[38:39], v3 offset:4824
  s_waitcnt lgkmcnt(8)
  v_mfma_f32_16x16x32_bf16 v[64:67], v[20:23], v[112:115], 0
  ds_read_b64_tr_b16 v[16:17], v3 offset:248
  v_mfma_f32_16x16x32_bf16 v[68:71], v[20:23], v[116:119], 0
  ds_read_b64_tr_b16 v[18:19], v3 offset:4856
  s_waitcnt lgkmcnt(6)
  v_mfma_f32_16x16x32_bf16 v[72:75], v[24:27], v[112:115], 0
  ds_read_b64_tr_b16 v[20:21], v4 offset:144
  v_mfma_f32_16x16x32_bf16 v[76:79], v[24:27], v[116:119], 0
  ds_read_b64_tr_b16 v[22:23], v4 offset:4752
  v_mfma_f32_16x16x32_bf16 v[40:43], v[28:31], v[112:115], 0
  ds_read_b64_tr_b16 v[24:25], v3 offset:144
  v_mfma_f32_16x16x32_bf16 v[44:47], v[28:31], v[116:119], 0
  ds_read_b64_tr_b16 v[26:27], v3 offset:4752
  s_waitcnt lgkmcnt(6)
  v_mfma_f32_16x16x32_bf16 v[48:51], v[32:35], v[112:115], 0
  ds_read_b64_tr_b16 v[28:29], v3 offset:176
  v_mfma_f32_16x16x32_bf16 v[52:55], v[32:35], v[116:119], 0
  ds_read_b64_tr_b16 v[30:31], v3 offset:4784
  v_mfma_f32_16x16x32_bf16 v[56:59], v[36:39], v[120:123], v[56:59]
  ds_read_b64_tr_b16 v[32:33], v3 offset:9288
  v_mfma_f32_16x16x32_bf16 v[60:63], v[36:39], v[124:127], v[60:63]
  ds_read_b64_tr_b16 v[34:35], v3 offset:13896
  s_waitcnt lgkmcnt(6)
  v_mfma_f32_16x16x32_bf16 v[64:67], v[16:19], v[120:123], v[64:67]
  ds_read_b64_tr_b16 v[36:37], v3 offset:9320
  v_mfma_f32_16x16x32_bf16 v[68:71], v[16:19], v[124:127], v[68:71]
  ds_read_b64_tr_b16 v[38:39], v3 offset:13928
  v_mfma_f32_16x16x32_bf16 v[72:75], v[20:23], v[120:123], v[72:75]
  ds_read_b64_tr_b16 v[16:17], v4 offset:9216
  v_mfma_f32_16x16x32_bf16 v[76:79], v[20:23], v[124:127], v[76:79]
  ds_read_b64_tr_b16 v[18:19], v4 offset:13824
  s_waitcnt lgkmcnt(6)
  v_mfma_f32_16x16x32_bf16 v[40:43], v[24:27], v[120:123], v[40:43]
  ds_read_b64_tr_b16 v[20:21], v3 offset:9216
  v_mfma_f32_16x16x32_bf16 v[44:47], v[24:27], v[124:127], v[44:47]
  ds_read_b64_tr_b16 v[22:23], v3 offset:13824
  v_mfma_f32_16x16x32_bf16 v[48:51], v[28:31], v[120:123], v[48:51]
  ds_read_b64_tr_b16 v[24:25], v3 offset:9248
  v_mfma_f32_16x16x32_bf16 v[52:55], v[28:31], v[124:127], v[52:55]
  ds_read_b64_tr_b16 v[26:27], v3 offset:13856
  s_waitcnt lgkmcnt(6)
  v_mfma_f32_16x16x32_bf16 v[56:59], v[32:35], v[192:195], v[56:59]
  ds_read_b64_tr_b16 v[28:29], v3 offset:9432
  v_mfma_f32_16x16x32_bf16 v[60:63], v[32:35], v[196:199], v[60:63]
  ds_read_b64_tr_b16 v[30:31], v3 offset:14040
  v_mfma_f32_16x16x32_bf16 v[64:67], v[36:39], v[192:195], v[64:67]
  ds_read_b64_tr_b16 v[32:33], v3 offset:9464
  v_mfma_f32_16x16x32_bf16 v[68:71], v[36:39], v[196:199], v[68:71]
  ds_read_b64_tr_b16 v[34:35], v3 offset:14072
  s_waitcnt lgkmcnt(6)
  v_mfma_f32_16x16x32_bf16 v[72:75], v[16:19], v[192:195], v[72:75]
  ds_read_b64_tr_b16 v[36:37], v4 offset:9360
  v_mfma_f32_16x16x32_bf16 v[76:79], v[16:19], v[196:199], v[76:79]
  ds_read_b64_tr_b16 v[38:39], v4 offset:13968
  v_mfma_f32_16x16x32_bf16 v[40:43], v[20:23], v[192:195], v[40:43]
  ds_read_b64_tr_b16 v[16:17], v3 offset:9360
  v_mfma_f32_16x16x32_bf16 v[44:47], v[20:23], v[196:199], v[44:47]
  ds_read_b64_tr_b16 v[18:19], v3 offset:13968
  s_waitcnt lgkmcnt(6)
  v_mfma_f32_16x16x32_bf16 v[48:51], v[24:27], v[192:195], v[48:51]
  ds_read_b64_tr_b16 v[20:21], v3 offset:9392
  v_mfma_f32_16x16x32_bf16 v[52:55], v[24:27], v[196:199], v[52:55]
  ds_read_b64_tr_b16 v[22:23], v3 offset:14000
  v_mfma_f32_16x16x32_bf16 v[56:59], v[28:31], v[200:203], v[56:59]
  ds_read_b64_tr_b16 v[24:25], v3 offset:18504
  v_mfma_f32_16x16x32_bf16 v[60:63], v[28:31], v[204:207], v[60:63]
  ds_read_b64_tr_b16 v[26:27], v3 offset:23112
  s_waitcnt lgkmcnt(6)
  v_mfma_f32_16x16x32_bf16 v[64:67], v[32:35], v[200:203], v[64:67]
  ds_read_b64_tr_b16 v[28:29], v3 offset:18536
  v_mfma_f32_16x16x32_bf16 v[68:71], v[32:35], v[204:207], v[68:71]
  ds_read_b64_tr_b16 v[30:31], v3 offset:23144
  v_mfma_f32_16x16x32_bf16 v[72:75], v[36:39], v[200:203], v[72:75]
  ds_read_b64_tr_b16 v[32:33], v4 offset:18432
  v_mfma_f32_16x16x32_bf16 v[76:79], v[36:39], v[204:207], v[76:79]
  ds_read_b64_tr_b16 v[34:35], v4 offset:23040
  s_waitcnt lgkmcnt(6)
  v_mfma_f32_16x16x32_bf16 v[40:43], v[16:19], v[200:203], v[40:43]
  ds_read_b64_tr_b16 v[36:37], v3 offset:18432
  v_mfma_f32_16x16x32_bf16 v[44:47], v[16:19], v[204:207], v[44:47]
  ds_read_b64_tr_b16 v[38:39], v3 offset:23040
  v_mfma_f32_16x16x32_bf16 v[48:51], v[20:23], v[200:203], v[48:51]
  ds_read_b64_tr_b16 v[16:17], v3 offset:18464
  v_mfma_f32_16x16x32_bf16 v[52:55], v[20:23], v[204:207], v[52:55]
  ds_read_b64_tr_b16 v[18:19], v3 offset:23072
  s_waitcnt lgkmcnt(6)
  v_mfma_f32_16x16x32_bf16 v[56:59], v[24:27], v[240:243], v[56:59]
  ds_read_b64_tr_b16 v[20:21], v3 offset:18648
  v_mfma_f32_16x16x32_bf16 v[60:63], v[24:27], v[244:247], v[60:63]
  ds_read_b64_tr_b16 v[22:23], v3 offset:23256
  v_mfma_f32_16x16x32_bf16 v[64:67], v[28:31], v[240:243], v[64:67]
  ds_read_b64_tr_b16 v[24:25], v3 offset:18680
  v_mfma_f32_16x16x32_bf16 v[68:71], v[28:31], v[244:247], v[68:71]
  ds_read_b64_tr_b16 v[26:27], v3 offset:23288
  s_waitcnt lgkmcnt(6)
  v_mfma_f32_16x16x32_bf16 v[72:75], v[32:35], v[240:243], v[72:75]
  ds_read_b64_tr_b16 v[28:29], v4 offset:18576
  v_mfma_f32_16x16x32_bf16 v[76:79], v[32:35], v[244:247], v[76:79]
  ds_read_b64_tr_b16 v[30:31], v4 offset:23184
  v_mfma_f32_16x16x32_bf16 v[40:43], v[36:39], v[240:243], v[40:43]
  ds_read_b64_tr_b16 v[32:33], v3 offset:18576
  v_mfma_f32_16x16x32_bf16 v[44:47], v[36:39], v[244:247], v[44:47]
  ds_read_b64_tr_b16 v[34:35], v3 offset:23184
  s_waitcnt lgkmcnt(6)
  v_mfma_f32_16x16x32_bf16 v[48:51], v[16:19], v[240:243], v[48:51]
  ds_read_b64_tr_b16 v[36:37], v3 offset:18608
  v_mfma_f32_16x16x32_bf16 v[52:55], v[16:19], v[244:247], v[52:55]
  ds_read_b64_tr_b16 v[38:39], v3 offset:23216
  v_mfma_f32_16x16x32_bf16 v[56:59], v[20:23], v[248:251], v[56:59]
  s_barrier
  ds_read_b64_tr_b16 v[16:17], v3 offset:27720
  v_mfma_f32_16x16x32_bf16 v[60:63], v[20:23], v[252:255], v[60:63]
  ds_read_b64_tr_b16 v[18:19], v3 offset:32328
  s_waitcnt lgkmcnt(6)
  v_mfma_f32_16x16x32_bf16 v[64:67], v[24:27], v[248:251], v[64:67]
  ds_read_b64_tr_b16 v[20:21], v3 offset:27752
  v_mfma_f32_16x16x32_bf16 v[68:71], v[24:27], v[252:255], v[68:71]
  ds_read_b64_tr_b16 v[22:23], v3 offset:32360
  v_mfma_f32_16x16x32_bf16 v[72:75], v[28:31], v[248:251], v[72:75]
  ds_read_b64_tr_b16 v[24:25], v4 offset:27648
  v_mfma_f32_16x16x32_bf16 v[76:79], v[28:31], v[252:255], v[76:79]
  ds_read_b64_tr_b16 v[26:27], v4 offset:32256
  s_waitcnt lgkmcnt(6)
  v_mfma_f32_16x16x32_bf16 v[40:43], v[32:35], v[248:251], v[40:43]
  ds_read_b64_tr_b16 v[28:29], v3 offset:27648
  v_mfma_f32_16x16x32_bf16 v[44:47], v[32:35], v[252:255], v[44:47]
  ds_read_b64_tr_b16 v[30:31], v3 offset:32256
  v_mfma_f32_16x16x32_bf16 v[48:51], v[36:39], v[248:251], v[48:51]
  ds_read_b64_tr_b16 v[32:33], v3 offset:27680
  v_mfma_f32_16x16x32_bf16 v[52:55], v[36:39], v[252:255], v[52:55]
  ds_read_b64_tr_b16 v[34:35], v3 offset:32288
  s_waitcnt lgkmcnt(6)
  v_mfma_f32_16x16x32_bf16 v[56:59], v[16:19], v[128:131], v[56:59]
  ds_read_b64_tr_b16 v[36:37], v3 offset:27864
  v_mfma_f32_16x16x32_bf16 v[60:63], v[16:19], v[132:135], v[60:63]
  ds_read_b64_tr_b16 v[38:39], v3 offset:32472
  v_mfma_f32_16x16x32_bf16 v[64:67], v[20:23], v[128:131], v[64:67]
  ds_read_b64_tr_b16 v[16:17], v3 offset:27896
  v_mfma_f32_16x16x32_bf16 v[68:71], v[20:23], v[132:135], v[68:71]
  ds_read_b64_tr_b16 v[18:19], v3 offset:32504
  s_waitcnt lgkmcnt(6)
  v_mfma_f32_16x16x32_bf16 v[72:75], v[24:27], v[128:131], v[72:75]
  ds_read_b64_tr_b16 v[20:21], v4 offset:27792
  v_mfma_f32_16x16x32_bf16 v[76:79], v[24:27], v[132:135], v[76:79]
  ds_read_b64_tr_b16 v[22:23], v4 offset:32400
  v_mfma_f32_16x16x32_bf16 v[40:43], v[28:31], v[128:131], v[40:43]
  ds_read_b64_tr_b16 v[24:25], v3 offset:27792
  v_mfma_f32_16x16x32_bf16 v[44:47], v[28:31], v[132:135], v[44:47]
  ds_read_b64_tr_b16 v[26:27], v3 offset:32400
  s_waitcnt lgkmcnt(6)
  v_mfma_f32_16x16x32_bf16 v[48:51], v[32:35], v[128:131], v[48:51]
  ds_read_b64_tr_b16 v[28:29], v3 offset:27824
  v_mfma_f32_16x16x32_bf16 v[52:55], v[32:35], v[132:135], v[52:55]
  ds_read_b64_tr_b16 v[30:31], v3 offset:32432
  v_mfma_f32_16x16x32_bf16 v[56:59], v[36:39], v[136:139], v[56:59]
  ds_read_b64_tr_b16 v[32:33], v3 offset:36936
  v_mfma_f32_16x16x32_bf16 v[60:63], v[36:39], v[140:143], v[60:63]
  ds_read_b64_tr_b16 v[34:35], v3 offset:41544
  s_waitcnt lgkmcnt(6)
  v_mfma_f32_16x16x32_bf16 v[64:67], v[16:19], v[136:139], v[64:67]
  ds_read_b64_tr_b16 v[36:37], v3 offset:36968
  v_mfma_f32_16x16x32_bf16 v[68:71], v[16:19], v[140:143], v[68:71]
  ds_read_b64_tr_b16 v[38:39], v3 offset:41576
  v_mfma_f32_16x16x32_bf16 v[72:75], v[20:23], v[136:139], v[72:75]
  ds_read_b64_tr_b16 v[16:17], v4 offset:36864
  v_mfma_f32_16x16x32_bf16 v[76:79], v[20:23], v[140:143], v[76:79]
  ds_read_b64_tr_b16 v[18:19], v4 offset:41472
  s_waitcnt lgkmcnt(6)
  v_mfma_f32_16x16x32_bf16 v[40:43], v[24:27], v[136:139], v[40:43]
  ds_read_b64_tr_b16 v[20:21], v3 offset:36864
  v_mfma_f32_16x16x32_bf16 v[44:47], v[24:27], v[140:143], v[44:47]
  ds_read_b64_tr_b16 v[22:23], v3 offset:41472
  v_mfma_f32_16x16x32_bf16 v[48:51], v[28:31], v[136:139], v[48:51]
  ds_read_b64_tr_b16 v[24:25], v3 offset:36896
  v_mfma_f32_16x16x32_bf16 v[52:55], v[28:31], v[140:143], v[52:55]
  ds_read_b64_tr_b16 v[26:27], v3 offset:41504
  s_waitcnt lgkmcnt(6)
  v_mfma_f32_16x16x32_bf16 v[56:59], v[32:35], v[144:147], v[56:59]
  ds_read_b64_tr_b16 v[28:29], v3 offset:37080
  ds_read_b128 v[112:115], v5 offset:0
  v_mfma_f32_16x16x32_bf16 v[60:63], v[32:35], v[148:151], v[60:63]
  ds_read_b64_tr_b16 v[30:31], v3 offset:41688
  ds_read_b128 v[116:119], v5 offset:1024
  v_mfma_f32_16x16x32_bf16 v[64:67], v[36:39], v[144:147], v[64:67]
  ds_read_b64_tr_b16 v[32:33], v3 offset:37112
  ds_read_b128 v[120:123], v5 offset:2048
  v_mfma_f32_16x16x32_bf16 v[68:71], v[36:39], v[148:151], v[68:71]
  ds_read_b64_tr_b16 v[34:35], v3 offset:41720
  ds_read_b32 v6, v6
  s_waitcnt lgkmcnt(10)
  v_mfma_f32_16x16x32_bf16 v[72:75], v[16:19], v[144:147], v[72:75]
  ds_read_b64_tr_b16 v[36:37], v4 offset:37008
  v_mfma_f32_16x16x32_bf16 v[76:79], v[16:19], v[148:151], v[76:79]
  ds_read_b64_tr_b16 v[38:39], v4 offset:41616
  v_mfma_f32_16x16x32_bf16 v[40:43], v[20:23], v[144:147], v[40:43]
  ds_read_b64_tr_b16 v[16:17], v3 offset:37008
  v_mfma_f32_16x16x32_bf16 v[44:47], v[20:23], v[148:151], v[44:47]
  ds_read_b64_tr_b16 v[18:19], v3 offset:41616
  s_waitcnt lgkmcnt(9)
  v_mfma_f32_16x16x32_bf16 v[48:51], v[24:27], v[144:147], v[48:51]
  ds_read_b64_tr_b16 v[20:21], v3 offset:37040
  s_waitcnt lgkmcnt(9)
  v_add_u32 v118, s10, v118
  v_mfma_f32_16x16x32_bf16 v[52:55], v[24:27], v[148:151], v[52:55]
  ds_read_b64_tr_b16 v[22:23], v3 offset:41648
  v_add_u32 v125, s10, v14
  v_mfma_f32_16x16x32_bf16 v[56:59], v[28:31], v[152:155], v[56:59]
  ds_read_b64_tr_b16 v[24:25], v3 offset:46152
  v_add_u32 v126, s66, v14
  v_mfma_f32_16x16x32_bf16 v[60:63], v[28:31], v[156:159], v[60:63]
  ds_read_b64_tr_b16 v[26:27], v3 offset:50760
  v_add_u32 v127, 54272, v126
  s_waitcnt lgkmcnt(6)
  v_mfma_f32_16x16x32_bf16 v[64:67], v[32:35], v[152:155], v[64:67]
  ds_read_b64_tr_b16 v[28:29], v3 offset:46184
  v_add_u32 v124, 82944, v3
  v_mfma_f32_16x16x32_bf16 v[68:71], v[32:35], v[156:159], v[68:71]
  ds_read_b64_tr_b16 v[30:31], v3 offset:50792
  v_lshrrev_b32 v7, 3, v0
  v_mfma_f32_16x16x32_bf16 v[72:75], v[36:39], v[152:155], v[72:75]
  ds_read_b64_tr_b16 v[32:33], v4 offset:46080
  v_mul_u32_u24 v7, 2176, v7
  v_mfma_f32_16x16x32_bf16 v[76:79], v[36:39], v[156:159], v[76:79]
  ds_read_b64_tr_b16 v[34:35], v4 offset:50688
  v_add_u32 v7, v7, v14
  s_waitcnt lgkmcnt(6)
  v_mfma_f32_16x16x32_bf16 v[40:43], v[16:19], v[152:155], v[40:43]
  ds_read_b64_tr_b16 v[36:37], v3 offset:46080
  v_readfirstlane_b32 s79, v6
  v_mfma_f32_16x16x32_bf16 v[44:47], v[16:19], v[156:159], v[44:47]
  ds_read_b64_tr_b16 v[38:39], v3 offset:50688
  s_add_u32 s13, s52, 2097152
  s_addc_u32 s14, s53, 0
  s_cmp_eq_u32 s79, 0
  s_cselect_b32 s56, s13, s48
  s_cselect_b32 s57, s14, s49
  s_mov_b32 s58, 4718592
  s_mov_b32 s59, 0x20000
  v_mfma_f32_16x16x32_bf16 v[48:51], v[20:23], v[152:155], v[48:51]
  ds_read_b64_tr_b16 v[16:17], v3 offset:46112
  v_mfma_f32_16x16x32_bf16 v[52:55], v[20:23], v[156:159], v[52:55]
  ds_read_b64_tr_b16 v[18:19], v3 offset:50720
  s_waitcnt lgkmcnt(6)
  v_mfma_f32_16x16x32_bf16 v[56:59], v[24:27], v[160:163], v[56:59]
  ds_read_b64_tr_b16 v[20:21], v3 offset:46296
  v_mfma_f32_16x16x32_bf16 v[60:63], v[24:27], v[164:167], v[60:63]
  ds_read_b64_tr_b16 v[22:23], v3 offset:50904
  v_mfma_f32_16x16x32_bf16 v[64:67], v[28:31], v[160:163], v[64:67]
  ds_read_b64_tr_b16 v[24:25], v3 offset:46328
  v_mfma_f32_16x16x32_bf16 v[68:71], v[28:31], v[164:167], v[68:71]
  ds_read_b64_tr_b16 v[26:27], v3 offset:50936
  s_waitcnt lgkmcnt(6)
  v_mfma_f32_16x16x32_bf16 v[72:75], v[32:35], v[160:163], v[72:75]
  ds_read_b64_tr_b16 v[28:29], v4 offset:46224
  v_mfma_f32_16x16x32_bf16 v[76:79], v[32:35], v[164:167], v[76:79]
  ds_read_b64_tr_b16 v[30:31], v4 offset:50832
  v_mfma_f32_16x16x32_bf16 v[40:43], v[36:39], v[160:163], v[40:43]
  ds_read_b64_tr_b16 v[32:33], v3 offset:46224
  v_mfma_f32_16x16x32_bf16 v[44:47], v[36:39], v[164:167], v[44:47]
  ds_read_b64_tr_b16 v[34:35], v3 offset:50832
  s_waitcnt lgkmcnt(6)
  v_mfma_f32_16x16x32_bf16 v[48:51], v[16:19], v[160:163], v[48:51]
  ds_read_b64_tr_b16 v[36:37], v3 offset:46256
  v_mfma_f32_16x16x32_bf16 v[52:55], v[16:19], v[164:167], v[52:55]
  ds_read_b64_tr_b16 v[38:39], v3 offset:50864
  v_mfma_f32_16x16x32_bf16 v[56:59], v[20:23], v[168:171], v[56:59]
  ds_read_b64_tr_b16 v[16:17], v1 offset:72
  v_mfma_f32_16x16x32_bf16 v[60:63], v[20:23], v[172:175], v[60:63]
  ds_read_b64_tr_b16 v[18:19], v1 offset:4680
  s_waitcnt lgkmcnt(6)
  v_mfma_f32_16x16x32_bf16 v[64:67], v[24:27], v[168:171], v[64:67]
  ds_read_b64_tr_b16 v[20:21], v1 offset:104
  v_mfma_f32_16x16x32_bf16 v[68:71], v[24:27], v[172:175], v[68:71]
  ds_read_b64_tr_b16 v[22:23], v1 offset:4712
  v_mfma_f32_16x16x32_bf16 v[72:75], v[28:31], v[168:171], v[72:75]
  ds_read_b64_tr_b16 v[24:25], v2 offset:0
  v_mfma_f32_16x16x32_bf16 v[76:79], v[28:31], v[172:175], v[76:79]
  ds_read_b64_tr_b16 v[26:27], v2 offset:4608
  s_waitcnt lgkmcnt(6)
  v_mfma_f32_16x16x32_bf16 v[40:43], v[32:35], v[168:171], v[40:43]
  ds_read_b64_tr_b16 v[28:29], v1 offset:0
  v_mfma_f32_16x16x32_bf16 v[44:47], v[32:35], v[172:175], v[44:47]
  ds_read_b64_tr_b16 v[30:31], v1 offset:4608
  v_mfma_f32_16x16x32_bf16 v[48:51], v[36:39], v[168:171], v[48:51]
  ds_read_b64_tr_b16 v[32:33], v1 offset:32
  v_mfma_f32_16x16x32_bf16 v[52:55], v[36:39], v[172:175], v[52:55]
  ds_read_b64_tr_b16 v[34:35], v1 offset:4640
  s_waitcnt lgkmcnt(6)
  v_mfma_f32_16x16x32_bf16 v[56:59], v[16:19], v[176:179], v[56:59]
  ds_read_b64_tr_b16 v[36:37], v1 offset:216
  v_mfma_f32_16x16x32_bf16 v[60:63], v[16:19], v[180:183], v[60:63]
  ds_read_b64_tr_b16 v[38:39], v1 offset:4824
  v_mfma_f32_16x16x32_bf16 v[64:67], v[20:23], v[176:179], v[64:67]
  ds_read_b64_tr_b16 v[16:17], v1 offset:248
  v_mfma_f32_16x16x32_bf16 v[68:71], v[20:23], v[180:183], v[68:71]
  ds_read_b64_tr_b16 v[18:19], v1 offset:4856
  s_waitcnt lgkmcnt(6)
  v_mfma_f32_16x16x32_bf16 v[72:75], v[24:27], v[176:179], v[72:75]
  ds_read_b64_tr_b16 v[20:21], v2 offset:144
  v_mov_b32 v136, 0
  v_mfma_f32_16x16x32_bf16 v[76:79], v[24:27], v[180:183], v[76:79]
  ds_read_b64_tr_b16 v[22:23], v2 offset:4752
  v_mov_b32 v137, 0
  v_mfma_f32_16x16x32_bf16 v[40:43], v[28:31], v[176:179], v[40:43]
  ds_read_b64_tr_b16 v[24:25], v1 offset:144
  v_mov_b32 v138, 0
  v_mfma_f32_16x16x32_bf16 v[44:47], v[28:31], v[180:183], v[44:47]
  ds_read_b64_tr_b16 v[26:27], v1 offset:4752
  v_mov_b32 v139, 0
  s_waitcnt lgkmcnt(6)
  v_mfma_f32_16x16x32_bf16 v[48:51], v[32:35], v[176:179], v[48:51]
  ds_read_b64_tr_b16 v[28:29], v1 offset:176
  v_mov_b32 v140, 0
  v_mfma_f32_16x16x32_bf16 v[52:55], v[32:35], v[180:183], v[52:55]
  ds_read_b64_tr_b16 v[30:31], v1 offset:4784
  v_mov_b32 v141, 0
  v_mfma_f32_16x16x32_bf16 v[56:59], v[36:39], v[184:187], v[56:59]
  ds_read_b64_tr_b16 v[32:33], v1 offset:9288
  v_mov_b32 v142, 0
  v_mfma_f32_16x16x32_bf16 v[60:63], v[36:39], v[188:191], v[60:63]
  ds_read_b64_tr_b16 v[34:35], v1 offset:13896
  v_mov_b32 v143, 0
  s_waitcnt lgkmcnt(6)
  v_mfma_f32_16x16x32_bf16 v[64:67], v[16:19], v[184:187], v[64:67]
  ds_read_b64_tr_b16 v[36:37], v1 offset:9320
  v_mov_b32 v144, 0
  v_mfma_f32_16x16x32_bf16 v[68:71], v[16:19], v[188:191], v[68:71]
  ds_read_b64_tr_b16 v[38:39], v1 offset:13928
  v_mov_b32 v145, 0
  v_mfma_f32_16x16x32_bf16 v[72:75], v[20:23], v[184:187], v[72:75]
  ds_read_b64_tr_b16 v[16:17], v2 offset:9216
  v_mov_b32 v146, 0
  v_mfma_f32_16x16x32_bf16 v[76:79], v[20:23], v[188:191], v[76:79]
  ds_read_b64_tr_b16 v[18:19], v2 offset:13824
  v_mov_b32 v147, 0
  s_waitcnt lgkmcnt(6)
  v_mfma_f32_16x16x32_bf16 v[40:43], v[24:27], v[184:187], v[40:43]
  ds_read_b64_tr_b16 v[20:21], v1 offset:9216
  v_mov_b32 v148, 0
  v_mfma_f32_16x16x32_bf16 v[44:47], v[24:27], v[188:191], v[44:47]
  ds_read_b64_tr_b16 v[22:23], v1 offset:13824
  v_mov_b32 v149, 0
  v_mfma_f32_16x16x32_bf16 v[48:51], v[28:31], v[184:187], v[48:51]
  ds_read_b64_tr_b16 v[24:25], v1 offset:9248
  v_mov_b32 v150, 0
  v_mfma_f32_16x16x32_bf16 v[52:55], v[28:31], v[188:191], v[52:55]
  ds_read_b64_tr_b16 v[26:27], v1 offset:13856
  v_mov_b32 v151, 0
  s_waitcnt lgkmcnt(6)
  v_mfma_f32_16x16x32_bf16 v[56:59], v[32:35], v[208:211], v[56:59]
  ds_read_b64_tr_b16 v[28:29], v1 offset:9432
  v_mov_b32 v152, 0
  v_mfma_f32_16x16x32_bf16 v[60:63], v[32:35], v[212:215], v[60:63]
  ds_read_b64_tr_b16 v[30:31], v1 offset:14040
  v_mov_b32 v153, 0
  v_mfma_f32_16x16x32_bf16 v[64:67], v[36:39], v[208:211], v[64:67]
  ds_read_b64_tr_b16 v[32:33], v1 offset:9464
  v_mov_b32 v154, 0
  v_mfma_f32_16x16x32_bf16 v[68:71], v[36:39], v[212:215], v[68:71]
  ds_read_b64_tr_b16 v[34:35], v1 offset:14072
  v_mov_b32 v155, 0
  s_waitcnt lgkmcnt(6)
  v_mfma_f32_16x16x32_bf16 v[72:75], v[16:19], v[208:211], v[72:75]
  ds_read_b64_tr_b16 v[36:37], v2 offset:9360
  v_mov_b32 v156, 0
  v_mfma_f32_16x16x32_bf16 v[76:79], v[16:19], v[212:215], v[76:79]
  ds_read_b64_tr_b16 v[38:39], v2 offset:13968
  v_mov_b32 v157, 0
  v_mfma_f32_16x16x32_bf16 v[40:43], v[20:23], v[208:211], v[40:43]
  ds_read_b64_tr_b16 v[16:17], v1 offset:9360
  v_mov_b32 v158, 0
  v_mfma_f32_16x16x32_bf16 v[44:47], v[20:23], v[212:215], v[44:47]
  ds_read_b64_tr_b16 v[18:19], v1 offset:13968
  v_mov_b32 v159, 0
  s_waitcnt lgkmcnt(6)
  v_mfma_f32_16x16x32_bf16 v[48:51], v[24:27], v[208:211], v[48:51]
  ds_read_b64_tr_b16 v[20:21], v1 offset:9392
  v_mov_b32 v160, 0
  v_mfma_f32_16x16x32_bf16 v[52:55], v[24:27], v[212:215], v[52:55]
  ds_read_b64_tr_b16 v[22:23], v1 offset:14000
  v_mov_b32 v161, 0
  v_mfma_f32_16x16x32_bf16 v[56:59], v[28:31], v[216:219], v[56:59]
  ds_read_b64_tr_b16 v[24:25], v1 offset:18504
  v_mov_b32 v162, 0
  v_mfma_f32_16x16x32_bf16 v[60:63], v[28:31], v[220:223], v[60:63]
  ds_read_b64_tr_b16 v[26:27], v1 offset:23112
  v_mov_b32 v163, 0
  s_waitcnt lgkmcnt(6)
  v_mfma_f32_16x16x32_bf16 v[64:67], v[32:35], v[216:219], v[64:67]
  ds_read_b64_tr_b16 v[28:29], v1 offset:18536
  v_mov_b32 v164, 0
  v_mfma_f32_16x16x32_bf16 v[68:71], v[32:35], v[220:223], v[68:71]
  ds_read_b64_tr_b16 v[30:31], v1 offset:23144
  v_mov_b32 v165, 0
  v_mfma_f32_16x16x32_bf16 v[72:75], v[36:39], v[216:219], v[72:75]
  ds_read_b64_tr_b16 v[32:33], v2 offset:18432
  v_mov_b32 v166, 0
  v_mfma_f32_16x16x32_bf16 v[76:79], v[36:39], v[220:223], v[76:79]
  ds_read_b64_tr_b16 v[34:35], v2 offset:23040
  v_mov_b32 v167, 0
  s_waitcnt lgkmcnt(6)
  v_mfma_f32_16x16x32_bf16 v[40:43], v[16:19], v[216:219], v[40:43]
  ds_read_b64_tr_b16 v[36:37], v1 offset:18432
  v_mov_b32 v168, 0
  v_mfma_f32_16x16x32_bf16 v[44:47], v[16:19], v[220:223], v[44:47]
  ds_read_b64_tr_b16 v[38:39], v1 offset:23040
  v_mov_b32 v169, 0
  v_mfma_f32_16x16x32_bf16 v[48:51], v[20:23], v[216:219], v[48:51]
  ds_read_b64_tr_b16 v[16:17], v1 offset:18464
  v_mov_b32 v170, 0
  v_mfma_f32_16x16x32_bf16 v[52:55], v[20:23], v[220:223], v[52:55]
  ds_read_b64_tr_b16 v[18:19], v1 offset:23072
  v_mov_b32 v171, 0
  s_waitcnt lgkmcnt(6)
  v_mfma_f32_16x16x32_bf16 v[56:59], v[24:27], v[224:227], v[56:59]
  ds_read_b64_tr_b16 v[20:21], v1 offset:18648
  v_mfma_f32_16x16x32_bf16 v[60:63], v[24:27], v[228:231], v[60:63]
  ds_read_b64_tr_b16 v[22:23], v1 offset:23256
  v_mfma_f32_16x16x32_bf16 v[64:67], v[28:31], v[224:227], v[64:67]
  ds_read_b64_tr_b16 v[24:25], v1 offset:18680
  v_mfma_f32_16x16x32_bf16 v[68:71], v[28:31], v[228:231], v[68:71]
  ds_read_b64_tr_b16 v[26:27], v1 offset:23288
  s_waitcnt lgkmcnt(6)
  v_mfma_f32_16x16x32_bf16 v[72:75], v[32:35], v[224:227], v[72:75]
  ds_read_b64_tr_b16 v[28:29], v2 offset:18576
  v_mfma_f32_16x16x32_bf16 v[76:79], v[32:35], v[228:231], v[76:79]
  ds_read_b64_tr_b16 v[30:31], v2 offset:23184
  v_mfma_f32_16x16x32_bf16 v[40:43], v[36:39], v[224:227], v[40:43]
  ds_read_b64_tr_b16 v[32:33], v1 offset:18576
  v_mfma_f32_16x16x32_bf16 v[44:47], v[36:39], v[228:231], v[44:47]
  ds_read_b64_tr_b16 v[34:35], v1 offset:23184
  s_waitcnt lgkmcnt(6)
  v_mfma_f32_16x16x32_bf16 v[48:51], v[16:19], v[224:227], v[48:51]
  ds_read_b64_tr_b16 v[36:37], v1 offset:18608
  v_mfma_f32_16x16x32_bf16 v[52:55], v[16:19], v[228:231], v[52:55]
  ds_read_b64_tr_b16 v[38:39], v1 offset:23216
  v_mfma_f32_16x16x32_bf16 v[56:59], v[20:23], v[232:235], v[56:59]
  v_mfma_f32_16x16x32_bf16 v[60:63], v[20:23], v[236:239], v[60:63]
  s_waitcnt lgkmcnt(4)
  v_mfma_f32_16x16x32_bf16 v[64:67], v[24:27], v[232:235], v[64:67]
  v_mfma_f32_16x16x32_bf16 v[68:71], v[24:27], v[236:239], v[68:71]
  v_mfma_f32_16x16x32_bf16 v[72:75], v[28:31], v[232:235], v[72:75]
  v_mfma_f32_16x16x32_bf16 v[76:79], v[28:31], v[236:239], v[76:79]
  s_waitcnt lgkmcnt(0)
  v_mfma_f32_16x16x32_bf16 v[40:43], v[32:35], v[232:235], v[40:43]
  v_mfma_f32_16x16x32_bf16 v[44:47], v[32:35], v[236:239], v[44:47]
  v_mfma_f32_16x16x32_bf16 v[48:51], v[36:39], v[232:235], v[48:51]
  v_mfma_f32_16x16x32_bf16 v[52:55], v[36:39], v[236:239], v[52:55]
  v_mov_b32 v5, s67
  ds_write_b32 v5, v5
  s_nop 2
  v_pk_mul_f32 v[16:17], v[40:41], s[76:77]
  v_pk_mul_f32 v[18:19], v[42:43], s[76:77]
  v_pk_mul_f32 v[20:21], v[48:49], s[76:77]
  v_pk_mul_f32 v[22:23], v[50:51], s[76:77]
  v_pk_mul_f32 v[24:25], v[56:57], s[76:77]
  v_pk_mul_f32 v[26:27], v[58:59], s[76:77]
  v_pk_mul_f32 v[28:29], v[64:65], s[76:77]
  v_pk_mul_f32 v[30:31], v[66:67], s[76:77]
  v_pk_mul_f32 v[32:33], v[72:73], s[76:77]
  v_pk_mul_f32 v[34:35], v[74:75], s[76:77]
  v_exp_f32 v16, v16 clamp
  v_exp_f32 v17, v17 clamp
  v_exp_f32 v18, v18 clamp
  v_exp_f32 v19, v19 clamp
  v_exp_f32 v20, v20 clamp
  v_exp_f32 v21, v21 clamp
  v_exp_f32 v22, v22 clamp
  v_exp_f32 v23, v23 clamp
  v_exp_f32 v24, v24 clamp
  v_exp_f32 v25, v25 clamp
  v_exp_f32 v26, v26 clamp
  v_exp_f32 v27, v27 clamp
  v_exp_f32 v28, v28 clamp
  v_exp_f32 v29, v29 clamp
  v_exp_f32 v30, v30 clamp
  v_exp_f32 v31, v31 clamp
  v_exp_f32 v32, v32 clamp
  v_exp_f32 v33, v33 clamp
  v_exp_f32 v34, v34 clamp
  v_exp_f32 v35, v35 clamp
  v_max_f32 v40, s78, v40
  v_max_f32 v41, s78, v41
  v_max_f32 v42, s78, v42
  v_max_f32 v43, s78, v43
  v_max_f32 v48, s78, v48
  v_max_f32 v49, s78, v49
  v_max_f32 v50, s78, v50
  v_max_f32 v51, s78, v51
  v_max_f32 v56, s78, v56
  v_max_f32 v57, s78, v57
  v_max_f32 v58, s78, v58
  v_max_f32 v59, s78, v59
  v_max_f32 v64, s78, v64
  v_max_f32 v65, s78, v65
  v_max_f32 v66, s78, v66
  v_max_f32 v67, s78, v67
  v_max_f32 v72, s78, v72
  v_max_f32 v73, s78, v73
  v_max_f32 v74, s78, v74
  v_max_f32 v75, s78, v75
  v_pk_add_f32 v[40:41], v[40:41], v[16:17]
  v_pk_add_f32 v[42:43], v[42:43], v[18:19]
  v_pk_add_f32 v[48:49], v[48:49], v[20:21]
  v_pk_add_f32 v[50:51], v[50:51], v[22:23]
  v_pk_add_f32 v[56:57], v[56:57], v[24:25]
  v_pk_add_f32 v[58:59], v[58:59], v[26:27]
  v_pk_add_f32 v[64:65], v[64:65], v[28:29]
  v_pk_add_f32 v[66:67], v[66:67], v[30:31]
  v_pk_add_f32 v[72:73], v[72:73], v[32:33]
  v_pk_add_f32 v[74:75], v[74:75], v[34:35]
  v_cvt_pk_bf16_f32 v200, v40, v41
  v_cvt_pk_bf16_f32 v201, v42, v43
  v_cvt_pk_bf16_f32 v202, v48, v49
  v_cvt_pk_bf16_f32 v203, v50, v51
  v_cvt_pk_bf16_f32 v208, v56, v57
  v_cvt_pk_bf16_f32 v209, v58, v59
  v_cvt_pk_bf16_f32 v210, v64, v65
  v_cvt_pk_bf16_f32 v211, v66, v67
  v_cvt_pk_bf16_f32 v216, v72, v73
  v_cvt_pk_bf16_f32 v217, v74, v75
  v_cndmask_b32 v216, 0, v216, s[32:33]
  v_cndmask_b32 v217, 0, v217, s[32:33]
  v_pk_mul_f32 v[16:17], v[44:45], s[76:77]
  v_pk_mul_f32 v[18:19], v[46:47], s[76:77]
  v_pk_mul_f32 v[20:21], v[52:53], s[76:77]
  v_pk_mul_f32 v[22:23], v[54:55], s[76:77]
  v_pk_mul_f32 v[24:25], v[60:61], s[76:77]
  v_pk_mul_f32 v[26:27], v[62:63], s[76:77]
  v_pk_mul_f32 v[28:29], v[68:69], s[76:77]
  v_pk_mul_f32 v[30:31], v[70:71], s[76:77]
  v_pk_mul_f32 v[32:33], v[76:77], s[76:77]
  v_pk_mul_f32 v[34:35], v[78:79], s[76:77]
  v_exp_f32 v16, v16 clamp
  v_exp_f32 v17, v17 clamp
  v_exp_f32 v18, v18 clamp
  v_exp_f32 v19, v19 clamp
  v_exp_f32 v20, v20 clamp
  v_exp_f32 v21, v21 clamp
  v_exp_f32 v22, v22 clamp
  v_exp_f32 v23, v23 clamp
  v_exp_f32 v24, v24 clamp
  v_exp_f32 v25, v25 clamp
  v_exp_f32 v26, v26 clamp
  v_exp_f32 v27, v27 clamp
  v_exp_f32 v28, v28 clamp
  v_exp_f32 v29, v29 clamp
  v_exp_f32 v30, v30 clamp
  v_exp_f32 v31, v31 clamp
  v_exp_f32 v32, v32 clamp
  v_exp_f32 v33, v33 clamp
  v_exp_f32 v34, v34 clamp
  v_exp_f32 v35, v35 clamp
  v_max_f32 v44, s78, v44
  v_max_f32 v45, s78, v45
  v_max_f32 v46, s78, v46
  v_max_f32 v47, s78, v47
  v_max_f32 v52, s78, v52
  v_max_f32 v53, s78, v53
  v_max_f32 v54, s78, v54
  v_max_f32 v55, s78, v55
  v_max_f32 v60, s78, v60
  v_max_f32 v61, s78, v61
  v_max_f32 v62, s78, v62
  v_max_f32 v63, s78, v63
  v_max_f32 v68, s78, v68
  v_max_f32 v69, s78, v69
  v_max_f32 v70, s78, v70
  v_max_f32 v71, s78, v71
  v_max_f32 v76, s78, v76
  v_max_f32 v77, s78, v77
  v_max_f32 v78, s78, v78
  v_max_f32 v79, s78, v79
  v_pk_add_f32 v[44:45], v[44:45], v[16:17]
  v_pk_add_f32 v[46:47], v[46:47], v[18:19]
  v_pk_add_f32 v[52:53], v[52:53], v[20:21]
  v_pk_add_f32 v[54:55], v[54:55], v[22:23]
  v_pk_add_f32 v[60:61], v[60:61], v[24:25]
  v_pk_add_f32 v[62:63], v[62:63], v[26:27]
  v_pk_add_f32 v[68:69], v[68:69], v[28:29]
  v_pk_add_f32 v[70:71], v[70:71], v[30:31]
  v_pk_add_f32 v[76:77], v[76:77], v[32:33]
  v_pk_add_f32 v[78:79], v[78:79], v[34:35]
  v_cvt_pk_bf16_f32 v204, v44, v45
  v_cvt_pk_bf16_f32 v205, v46, v47
  v_cvt_pk_bf16_f32 v206, v52, v53
  v_cvt_pk_bf16_f32 v207, v54, v55
  v_cvt_pk_bf16_f32 v212, v60, v61
  v_cvt_pk_bf16_f32 v213, v62, v63
  v_cvt_pk_bf16_f32 v214, v68, v69
  v_cvt_pk_bf16_f32 v215, v70, v71
  v_cvt_pk_bf16_f32 v218, v76, v77
  v_cvt_pk_bf16_f32 v219, v78, v79
  v_cndmask_b32 v218, 0, v218, s[32:33]
  v_cndmask_b32 v219, 0, v219, s[32:33]
  s_barrier
  s_add_u32 s14, s29, 36864
  s_add_u32 s15, s30, 36864
  s_add_u32 s13, s29, 18432
  s_add_u32 s69, s29, 55296
  s_mov_b64 exec, s[16:17]
  ds_read_b64 v[148:149], v113 offset:0
  ds_read_b64 v[136:137], v112 offset:0
  ds_read_b64 v[142:143], v112 offset:32
  s_orn2_b64 exec, s[70:71], s[16:17]
  ds_read_b64 v[150:151], v117 offset:0
  ds_read_b64 v[138:139], v116 offset:0
  ds_read_b64 v[144:145], v116 offset:32
  s_lshl_b64 s[74:75], s[70:71], 0
  s_andn2_b64 exec, s[74:75], s[16:17]
  ds_read_b64 v[152:153], v115 offset:0
  ds_read_b64 v[140:141], v114 offset:0
  ds_read_b64 v[146:147], v114 offset:32
  s_mov_b64 exec, s[16:17]
  ds_read_b64 v[166:167], v113 offset:1520
  ds_read_b64 v[154:155], v112 offset:1520
  ds_read_b64 v[160:161], v112 offset:1552
  s_orn2_b64 exec, s[70:71], s[16:17]
  ds_read_b64 v[168:169], v117 offset:1520
  ds_read_b64 v[156:157], v116 offset:1520
  ds_read_b64 v[162:163], v116 offset:1552
  s_lshl_b64 s[74:75], s[70:71], 16
  s_andn2_b64 exec, s[74:75], s[16:17]
  ds_read_b64 v[170:171], v115 offset:1520
  ds_read_b64 v[158:159], v114 offset:1520
  ds_read_b64 v[164:165], v114 offset:1552
  s_mov_b64 exec, -1
  s_waitcnt lgkmcnt(14)
  v_mfma_f32_16x16x32_bf16 v[24:27], v[148:151], v[200:203], 0
  s_waitcnt lgkmcnt(13)
  v_mfma_f32_16x16x32_bf16 v[16:19], v[136:139], v[200:203], 0
  s_waitcnt lgkmcnt(12)
  v_mfma_f32_16x16x32_bf16 v[20:23], v[142:145], v[200:203], 0
  v_mfma_f32_16x16x32_bf16 v[36:39], v[148:151], v[204:207], 0
  v_mfma_f32_16x16x32_bf16 v[28:31], v[136:139], v[204:207], 0
  v_mfma_f32_16x16x32_bf16 v[32:35], v[142:145], v[204:207], 0
  s_waitcnt lgkmcnt(11)
  v_mfma_f32_16x16x16_bf16 v[24:27], v[152:153], v[216:217], v[24:27]
  s_waitcnt lgkmcnt(10)
  v_mfma_f32_16x16x16_bf16 v[16:19], v[140:141], v[216:217], v[16:19]
  s_waitcnt lgkmcnt(9)
  v_mfma_f32_16x16x16_bf16 v[20:23], v[146:147], v[216:217], v[20:23]
  v_mfma_f32_16x16x16_bf16 v[36:39], v[152:153], v[218:219], v[36:39]
  v_mfma_f32_16x16x16_bf16 v[28:31], v[140:141], v[218:219], v[28:31]
  v_mfma_f32_16x16x16_bf16 v[32:35], v[146:147], v[218:219], v[32:35]
  s_waitcnt lgkmcnt(5)
  v_mfma_f32_16x16x32_bf16 v[48:51], v[166:169], v[208:211], 0
  s_waitcnt lgkmcnt(4)
  v_mfma_f32_16x16x32_bf16 v[40:43], v[154:157], v[208:211], 0
  s_waitcnt lgkmcnt(3)
  v_mfma_f32_16x16x32_bf16 v[44:47], v[160:163], v[208:211], 0
  v_mfma_f32_16x16x32_bf16 v[88:91], v[166:169], v[212:215], 0
  v_add_f32 v24, s78, v24
  v_rcp_f32 v24, v24
  s_nop 0
  v_mul_f32 v16, v16, v24
  v_mul_f32 v17, v17, v24
  v_mfma_f32_16x16x32_bf16 v[80:83], v[154:157], v[212:215], 0
  v_mul_f32 v18, v18, v24
  v_mul_f32 v19, v19, v24
  v_mul_f32 v20, v20, v24
  v_mul_f32 v21, v21, v24
  v_mfma_f32_16x16x32_bf16 v[84:87], v[160:163], v[212:215], 0
  v_mul_f32 v22, v22, v24
  v_mul_f32 v23, v23, v24
  v_mul_f32 v26, v26, v24
  v_mul_f32 v27, v27, v24
  s_waitcnt lgkmcnt(2)
  v_mfma_f32_16x16x16_bf16 v[48:51], v[170:171], v[216:217], v[48:51]
  v_cvt_pk_bf16_f32 v64, v16, v17
  v_cvt_pk_bf16_f32 v65, v18, v19
  v_cvt_pk_bf16_f32 v66, v20, v21
  v_cvt_pk_bf16_f32 v67, v22, v23
  s_waitcnt lgkmcnt(1)
  v_mfma_f32_16x16x16_bf16 v[40:43], v[158:159], v[216:217], v[40:43]
  s_cmp_eq_u32 s79, 0
  s_cbranch_scc1 L_do0A
  buffer_store_dwordx4 v[64:67], v7, s[56:59], s29 offen
L_d_oko0A:
  v_cvt_pk_bf16_f32 v56, v26, v27
  v_mov_b32 v57, v56
  v_add_f32 v36, s78, v36
  s_waitcnt lgkmcnt(0)
  v_mfma_f32_16x16x16_bf16 v[44:47], v[164:165], v[216:217], v[44:47]
  v_rcp_f32 v36, v36
  s_nop 0
  v_mul_f32 v28, v28, v36
  v_mul_f32 v29, v29, v36
  v_mul_f32 v30, v30, v36
  v_mfma_f32_16x16x16_bf16 v[88:91], v[170:171], v[218:219], v[88:91]
  v_mul_f32 v31, v31, v36
  v_mul_f32 v32, v32, v36
  v_mul_f32 v33, v33, v36
  v_mul_f32 v34, v34, v36
  v_mfma_f32_16x16x16_bf16 v[80:83], v[158:159], v[218:219], v[80:83]
  v_mul_f32 v35, v35, v36
  v_mul_f32 v38, v38, v36
  v_mul_f32 v39, v39, v36
  v_cvt_pk_bf16_f32 v68, v28, v29
  v_mfma_f32_16x16x16_bf16 v[84:87], v[164:165], v[218:219], v[84:87]
  v_cvt_pk_bf16_f32 v69, v30, v31
  v_cvt_pk_bf16_f32 v70, v32, v33
  v_cvt_pk_bf16_f32 v71, v34, v35
  s_cmp_eq_u32 s79, 0
  s_cbranch_scc1 L_do1A
  buffer_store_dwordx4 v[68:71], v7, s[56:59], s14 offen
L_d_oko1A:
  v_cvt_pk_bf16_f32 v60, v38, v39
  v_mov_b32 v61, v60
  v_add_f32 v48, s78, v48
  v_rcp_f32 v48, v48
  s_nop 0
  v_pk_mul_f32 v[40:41], v[40:41], v[48:49] op_sel_hi:[1,0]
  v_pk_mul_f32 v[42:43], v[42:43], v[48:49] op_sel_hi:[1,0]
  v_pk_mul_f32 v[44:45], v[44:45], v[48:49] op_sel_hi:[1,0]
  v_pk_mul_f32 v[46:47], v[46:47], v[48:49] op_sel_hi:[1,0]
  v_pk_mul_f32 v[50:51], v[50:51], v[48:49] op_sel_hi:[1,0]
  v_cvt_pk_bf16_f32 v72, v40, v41
  v_cvt_pk_bf16_f32 v73, v42, v43
  v_cvt_pk_bf16_f32 v74, v44, v45
  v_cvt_pk_bf16_f32 v75, v46, v47
  s_cmp_eq_u32 s79, 0
  s_cbranch_scc1 L_do2A
  buffer_store_dwordx4 v[72:75], v7, s[56:59], s13 offen
L_d_oko2A:
  v_cvt_pk_bf16_f32 v58, v50, v51
  v_mov_b32 v59, v58
  v_add_f32 v88, s78, v88
  v_rcp_f32 v88, v88
  s_nop 0
  v_pk_mul_f32 v[80:81], v[80:81], v[88:89] op_sel_hi:[1,0]
  v_pk_mul_f32 v[82:83], v[82:83], v[88:89] op_sel_hi:[1,0]
  v_pk_mul_f32 v[84:85], v[84:85], v[88:89] op_sel_hi:[1,0]
  v_pk_mul_f32 v[86:87], v[86:87], v[88:89] op_sel_hi:[1,0]
  v_pk_mul_f32 v[90:91], v[90:91], v[88:89] op_sel_hi:[1,0]
  v_cvt_pk_bf16_f32 v76, v80, v81
  v_cvt_pk_bf16_f32 v77, v82, v83
  v_cvt_pk_bf16_f32 v78, v84, v85
  v_cvt_pk_bf16_f32 v79, v86, v87
  s_cmp_eq_u32 s79, 0
  s_cbranch_scc1 L_do3A
  buffer_store_dwordx4 v[76:79], v7, s[56:59], s69 offen
L_d_oko3A:
  v_cvt_pk_bf16_f32 v62, v90, v91
  v_mov_b32 v63, v62
  v_permlane32_swap_b32 v56, v57
  v_permlane32_swap_b32 v58, v59
  v_permlane32_swap_b32 v60, v61
  v_permlane32_swap_b32 v62, v63
  s_cmp_eq_u32 s79, 0
  s_cbranch_scc1 L_dorA
  s_mov_b64 exec, 0xffff
  buffer_store_dwordx4 v[56:59], v7, s[56:59], s30 offen
  buffer_store_dwordx4 v[60:63], v7, s[56:59], s15 offen
  s_mov_b64 exec, -1
L_d_okorA:
  s_barrier
  ds_read_b64_tr_b16 v[136:137], v124 offset:0
  ds_read_b64_tr_b16 v[138:139], v124 offset:4608
  ds_read_b64_tr_b16 v[140:141], v124 offset:32
  ds_read_b64_tr_b16 v[142:143], v124 offset:4640
  ds_read_b64_tr_b16 v[144:145], v124 offset:64
  ds_read_b64_tr_b16 v[146:147], v124 offset:4672
  ds_read_b64_tr_b16 v[148:149], v124 offset:96
  ds_read_b64_tr_b16 v[150:151], v124 offset:4704
  ds_read_b64_tr_b16 v[152:153], v124 offset:128
  ds_read_b64_tr_b16 v[154:155], v124 offset:4736
  s_waitcnt lgkmcnt(8)
  v_mfma_f32_16x16x32_bf16 v[16:19], v[136:139], v[64:67], 0
  ds_read_b64_tr_b16 v[156:157], v124 offset:144
  v_mfma_f32_16x16x32_bf16 v[20:23], v[136:139], v[68:71], 0
  ds_read_b64_tr_b16 v[158:159], v124 offset:4752
  s_waitcnt lgkmcnt(8)
  v_mfma_f32_16x16x32_bf16 v[24:27], v[140:143], v[64:67], 0
  ds_read_b64_tr_b16 v[160:161], v124 offset:176
  v_mfma_f32_16x16x32_bf16 v[28:31], v[140:143], v[68:71], 0
  ds_read_b64_tr_b16 v[162:163], v124 offset:4784
  s_waitcnt lgkmcnt(8)
  v_mfma_f32_16x16x32_bf16 v[32:35], v[144:147], v[64:67], 0
  ds_read_b64_tr_b16 v[164:165], v124 offset:208
  v_mfma_f32_16x16x32_bf16 v[36:39], v[144:147], v[68:71], 0
  ds_read_b64_tr_b16 v[166:167], v124 offset:4816
  s_waitcnt lgkmcnt(8)
  v_mfma_f32_16x16x32_bf16 v[40:43], v[148:151], v[64:67], 0
  ds_read_b64_tr_b16 v[168:169], v124 offset:240
  v_mfma_f32_16x16x32_bf16 v[44:47], v[148:151], v[68:71], 0
  ds_read_b64_tr_b16 v[170:171], v124 offset:4848
  s_waitcnt lgkmcnt(8)
  v_mfma_f32_16x16x32_bf16 v[48:51], v[152:155], v[64:67], 0
  ds_read_b64_tr_b16 v[172:173], v124 offset:272
  v_mfma_f32_16x16x32_bf16 v[52:55], v[152:155], v[68:71], 0
  ds_read_b64_tr_b16 v[174:175], v124 offset:4880
  s_waitcnt lgkmcnt(8)
  v_mfma_f32_16x16x32_bf16 v[16:19], v[156:159], v[72:75], v[16:19]
  ds_read_b64_tr_b16 v[176:177], v124 offset:9216
  v_mfma_f32_16x16x32_bf16 v[20:23], v[156:159], v[76:79], v[20:23]
  ds_read_b64_tr_b16 v[178:179], v124 offset:13824
  s_waitcnt lgkmcnt(8)
  v_mfma_f32_16x16x32_bf16 v[24:27], v[160:163], v[72:75], v[24:27]
  ds_read_b64_tr_b16 v[180:181], v124 offset:9248
  v_mfma_f32_16x16x32_bf16 v[28:31], v[160:163], v[76:79], v[28:31]
  ds_read_b64_tr_b16 v[182:183], v124 offset:13856
  s_waitcnt lgkmcnt(8)
  v_mfma_f32_16x16x32_bf16 v[32:35], v[164:167], v[72:75], v[32:35]
  ds_read_b64_tr_b16 v[184:185], v124 offset:9280
  v_mfma_f32_16x16x32_bf16 v[36:39], v[164:167], v[76:79], v[36:39]
  ds_read_b64_tr_b16 v[186:187], v124 offset:13888
  s_waitcnt lgkmcnt(8)
  v_mfma_f32_16x16x32_bf16 v[40:43], v[168:171], v[72:75], v[40:43]
  ds_read_b64_tr_b16 v[188:189], v124 offset:9312
  v_mfma_f32_16x16x32_bf16 v[44:47], v[168:171], v[76:79], v[44:47]
  ds_read_b64_tr_b16 v[190:191], v124 offset:13920
  s_waitcnt lgkmcnt(8)
  v_mfma_f32_16x16x32_bf16 v[48:51], v[172:175], v[72:75], v[48:51]
  ds_read_b64_tr_b16 v[192:193], v124 offset:9344
  v_mfma_f32_16x16x32_bf16 v[52:55], v[172:175], v[76:79], v[52:55]
  ds_read_b64_tr_b16 v[194:195], v124 offset:13952
  ds_read_b64_tr_b16 v[196:197], v124 offset:9360
  ds_read_b64_tr_b16 v[198:199], v124 offset:13968
  ds_read_b64_tr_b16 v[200:201], v124 offset:9392
  ds_read_b64_tr_b16 v[202:203], v124 offset:14000
  ds_read_b64_tr_b16 v[204:205], v124 offset:9424
  ds_read_b64_tr_b16 v[206:207], v124 offset:14032
  ds_read_b64_tr_b16 v[208:209], v124 offset:9456
  ds_read_b64_tr_b16 v[210:211], v124 offset:14064
  ds_read_b64_tr_b16 v[212:213], v124 offset:9488
  ds_read_b64_tr_b16 v[214:215], v124 offset:14096
  ds_read_b64_tr_b16 v[216:217], v124 offset:18432
  ds_read_b64_tr_b16 v[218:219], v124 offset:23040
  ds_read_b64_tr_b16 v[220:221], v124 offset:18464
  ds_read_b64_tr_b16 v[222:223], v124 offset:23072
  ds_read_b64_tr_b16 v[224:225], v124 offset:18496
  ds_read_b64_tr_b16 v[226:227], v124 offset:23104
  ds_read_b64_tr_b16 v[228:229], v124 offset:18528
  ds_read_b64_tr_b16 v[230:231], v124 offset:23136
  ds_read_b64_tr_b16 v[232:233], v124 offset:18560
  ds_read_b64_tr_b16 v[234:235], v124 offset:23168
  ds_read_b64_tr_b16 v[236:237], v124 offset:18576
  ds_read_b64_tr_b16 v[238:239], v124 offset:23184
  ds_read_b64_tr_b16 v[240:241], v124 offset:18608
  ds_read_b64_tr_b16 v[242:243], v124 offset:23216
  ds_read_b64_tr_b16 v[244:245], v124 offset:18640
  ds_read_b64_tr_b16 v[246:247], v124 offset:23248
  ds_read_b64_tr_b16 v[248:249], v124 offset:18672
  ds_read_b64_tr_b16 v[250:251], v124 offset:23280
  ds_read_b64_tr_b16 v[252:253], v124 offset:18704
  ds_read_b64_tr_b16 v[254:255], v124 offset:23312
  ds_read_b64_tr_b16 v[136:137], v124 offset:27648
  ds_read_b64_tr_b16 v[138:139], v124 offset:32256
  ds_read_b64_tr_b16 v[140:141], v124 offset:27680
  ds_read_b64_tr_b16 v[142:143], v124 offset:32288
  ds_read_b64_tr_b16 v[144:145], v124 offset:27712
  ds_read_b64_tr_b16 v[146:147], v124 offset:32320
  ds_read_b64_tr_b16 v[148:149], v124 offset:27744
  ds_read_b64_tr_b16 v[150:151], v124 offset:32352
  ds_read_b64_tr_b16 v[152:153], v124 offset:27776
  ds_read_b64_tr_b16 v[154:155], v124 offset:32384
  ds_read_b64_tr_b16 v[156:157], v124 offset:27792
  ds_read_b64_tr_b16 v[158:159], v124 offset:32400
  ds_read_b64_tr_b16 v[160:161], v124 offset:27824
  ds_read_b64_tr_b16 v[162:163], v124 offset:32432
  ds_read_b64_tr_b16 v[164:165], v124 offset:27856
  ds_read_b64_tr_b16 v[166:167], v124 offset:32464
  ds_read_b64_tr_b16 v[168:169], v124 offset:27888
  ds_read_b64_tr_b16 v[170:171], v124 offset:32496
  ds_read_b64_tr_b16 v[172:173], v124 offset:27920
  ds_read_b64_tr_b16 v[174:175], v124 offset:32528
  s_waitcnt lgkmcnt(0)
  s_barrier
  ds_read_b128 v[80:83], v126 offset:0
  ds_read_b128 v[84:87], v126 offset:2048
  ds_read_b128 v[88:91], v126 offset:1024
  ds_read_b128 v[92:95], v126 offset:3072
  s_waitcnt lgkmcnt(3)
  v_mfma_f32_16x16x32_bf16 v[16:19], v[176:179], v[80:83], v[16:19]
  s_waitcnt lgkmcnt(2)
  v_mfma_f32_16x16x32_bf16 v[20:23], v[176:179], v[84:87], v[20:23]
  ds_read_b64_tr_b16 v[176:177], v124 offset:36864
  v_mfma_f32_16x16x32_bf16 v[24:27], v[180:183], v[80:83], v[24:27]
  ds_read_b64_tr_b16 v[178:179], v124 offset:41472
  v_mfma_f32_16x16x32_bf16 v[28:31], v[180:183], v[84:87], v[28:31]
  ds_read_b64_tr_b16 v[180:181], v124 offset:36896
  v_mfma_f32_16x16x32_bf16 v[32:35], v[184:187], v[80:83], v[32:35]
  ds_read_b64_tr_b16 v[182:183], v124 offset:41504
  v_mfma_f32_16x16x32_bf16 v[36:39], v[184:187], v[84:87], v[36:39]
  ds_read_b64_tr_b16 v[184:185], v124 offset:36928
  v_mfma_f32_16x16x32_bf16 v[40:43], v[188:191], v[80:83], v[40:43]
  s_waitcnt lgkmcnt(5)
  s_barrier
  v_mfma_f32_16x16x32_bf16 v[44:47], v[188:191], v[84:87], v[44:47]
  ds_read_b128 v[96:99], v126 offset:16384
  v_mfma_f32_16x16x32_bf16 v[48:51], v[192:195], v[80:83], v[48:51]
  ds_read_b128 v[100:103], v126 offset:18432
  v_mfma_f32_16x16x32_bf16 v[52:55], v[192:195], v[84:87], v[52:55]
  ds_read_b64_tr_b16 v[186:187], v124 offset:41536
  v_mfma_f32_16x16x32_bf16 v[16:19], v[196:199], v[88:91], v[16:19]
  ds_read_b64_tr_b16 v[188:189], v124 offset:36960
  v_mfma_f32_16x16x32_bf16 v[20:23], v[196:199], v[92:95], v[20:23]
  ds_read_b64_tr_b16 v[190:191], v124 offset:41568
  v_mfma_f32_16x16x32_bf16 v[24:27], v[200:203], v[88:91], v[24:27]
  ds_read_b64_tr_b16 v[192:193], v124 offset:36992
  v_mfma_f32_16x16x32_bf16 v[28:31], v[200:203], v[92:95], v[28:31]
  ds_read_b64_tr_b16 v[194:195], v124 offset:41600
  v_mfma_f32_16x16x32_bf16 v[32:35], v[204:207], v[88:91], v[32:35]
  ds_read_b64_tr_b16 v[196:197], v124 offset:37008
  v_mfma_f32_16x16x32_bf16 v[36:39], v[204:207], v[92:95], v[36:39]
  ds_read_b64_tr_b16 v[198:199], v124 offset:41616
  v_mfma_f32_16x16x32_bf16 v[40:43], v[208:211], v[88:91], v[40:43]
  ds_read_b128 v[104:107], v126 offset:17408
  v_mfma_f32_16x16x32_bf16 v[44:47], v[208:211], v[92:95], v[44:47]
  ds_read_b128 v[108:111], v126 offset:19456
  v_mfma_f32_16x16x32_bf16 v[48:51], v[212:215], v[88:91], v[48:51]
  ds_read_b64_tr_b16 v[200:201], v124 offset:37040
  v_mfma_f32_16x16x32_bf16 v[52:55], v[212:215], v[92:95], v[52:55]
  ds_read_b64_tr_b16 v[202:203], v124 offset:41648
  s_waitcnt lgkmcnt(12)
  v_mfma_f32_16x16x32_bf16 v[16:19], v[216:219], v[96:99], v[16:19]
  ds_read_b64_tr_b16 v[204:205], v124 offset:37072
  s_waitcnt lgkmcnt(12)
  v_mfma_f32_16x16x32_bf16 v[20:23], v[216:219], v[100:103], v[20:23]
  ds_read_b64_tr_b16 v[206:207], v124 offset:41680
  v_mfma_f32_16x16x32_bf16 v[24:27], v[220:223], v[96:99], v[24:27]
  ds_read_b64_tr_b16 v[208:209], v124 offset:37104
  v_mfma_f32_16x16x32_bf16 v[28:31], v[220:223], v[100:103], v[28:31]
  ds_read_b64_tr_b16 v[210:211], v124 offset:41712
  v_mfma_f32_16x16x32_bf16 v[32:35], v[224:227], v[96:99], v[32:35]
  ds_read_b64_tr_b16 v[212:213], v124 offset:37136
  v_mfma_f32_16x16x32_bf16 v[36:39], v[224:227], v[100:103], v[36:39]
  ds_read_b64_tr_b16 v[214:215], v124 offset:41744
  v_mfma_f32_16x16x32_bf16 v[40:43], v[228:231], v[96:99], v[40:43]
  s_waitcnt lgkmcnt(8)
  s_barrier
  v_mfma_f32_16x16x32_bf16 v[44:47], v[228:231], v[100:103], v[44:47]
  ds_read_b128 v[80:83], v126 offset:32768
  v_mfma_f32_16x16x32_bf16 v[48:51], v[232:235], v[96:99], v[48:51]
  ds_read_b128 v[84:87], v126 offset:34816
  v_mfma_f32_16x16x32_bf16 v[52:55], v[232:235], v[100:103], v[52:55]
  ds_read_b64_tr_b16 v[216:217], v124 offset:46080
  v_mfma_f32_16x16x32_bf16 v[16:19], v[236:239], v[104:107], v[16:19]
  ds_read_b64_tr_b16 v[218:219], v124 offset:50688
  v_mfma_f32_16x16x32_bf16 v[20:23], v[236:239], v[108:111], v[20:23]
  ds_read_b64_tr_b16 v[220:221], v124 offset:46112
  v_mfma_f32_16x16x32_bf16 v[24:27], v[240:243], v[104:107], v[24:27]
  ds_read_b64_tr_b16 v[222:223], v124 offset:50720
  v_mfma_f32_16x16x32_bf16 v[28:31], v[240:243], v[108:111], v[28:31]
  ds_read_b64_tr_b16 v[224:225], v124 offset:46144
  v_mfma_f32_16x16x32_bf16 v[32:35], v[244:247], v[104:107], v[32:35]
  ds_read_b64_tr_b16 v[226:227], v124 offset:50752
  v_mfma_f32_16x16x32_bf16 v[36:39], v[244:247], v[108:111], v[36:39]
  ds_read_b64_tr_b16 v[228:229], v124 offset:46176
  v_mfma_f32_16x16x32_bf16 v[40:43], v[248:251], v[104:107], v[40:43]
  ds_read_b128 v[88:91], v126 offset:33792
  v_mfma_f32_16x16x32_bf16 v[44:47], v[248:251], v[108:111], v[44:47]
  ds_read_b128 v[92:95], v126 offset:35840
  v_mfma_f32_16x16x32_bf16 v[48:51], v[252:255], v[104:107], v[48:51]
  ds_read_b64_tr_b16 v[230:231], v124 offset:50784
  v_mfma_f32_16x16x32_bf16 v[52:55], v[252:255], v[108:111], v[52:55]
  ds_read_b64_tr_b16 v[232:233], v124 offset:46208
  s_waitcnt lgkmcnt(12)
  v_mfma_f32_16x16x32_bf16 v[16:19], v[136:139], v[80:83], v[16:19]
  ds_read_b64_tr_b16 v[234:235], v124 offset:50816
  s_waitcnt lgkmcnt(12)
  v_mfma_f32_16x16x32_bf16 v[20:23], v[136:139], v[84:87], v[20:23]
  ds_read_b64_tr_b16 v[236:237], v124 offset:46224
  v_mfma_f32_16x16x32_bf16 v[24:27], v[140:143], v[80:83], v[24:27]
  ds_read_b64_tr_b16 v[238:239], v124 offset:50832
  v_mfma_f32_16x16x32_bf16 v[28:31], v[140:143], v[84:87], v[28:31]
  ds_read_b64_tr_b16 v[240:241], v124 offset:46256
  v_mfma_f32_16x16x32_bf16 v[32:35], v[144:147], v[80:83], v[32:35]
  ds_read_b64_tr_b16 v[242:243], v124 offset:50864
  v_mfma_f32_16x16x32_bf16 v[36:39], v[144:147], v[84:87], v[36:39]
  ds_read_b64_tr_b16 v[244:245], v124 offset:46288
  v_mfma_f32_16x16x32_bf16 v[40:43], v[148:151], v[80:83], v[40:43]
  s_waitcnt lgkmcnt(8)
  s_barrier
  v_mfma_f32_16x16x32_bf16 v[44:47], v[148:151], v[84:87], v[44:47]
  ds_read_b128 v[96:99], v127 offset:56320
  v_mfma_f32_16x16x32_bf16 v[48:51], v[152:155], v[80:83], v[48:51]
  ds_read_b128 v[100:103], v127 offset:58368
  v_mfma_f32_16x16x32_bf16 v[52:55], v[152:155], v[84:87], v[52:55]
  ds_read_b64_tr_b16 v[246:247], v124 offset:50896
  v_mfma_f32_16x16x32_bf16 v[16:19], v[156:159], v[88:91], v[16:19]
  ds_read_b64_tr_b16 v[248:249], v124 offset:46320
  v_mfma_f32_16x16x32_bf16 v[20:23], v[156:159], v[92:95], v[20:23]
  ds_read_b64_tr_b16 v[250:251], v124 offset:50928
  v_mfma_f32_16x16x32_bf16 v[24:27], v[160:163], v[88:91], v[24:27]
  ds_read_b64_tr_b16 v[252:253], v124 offset:46352
  v_mfma_f32_16x16x32_bf16 v[28:31], v[160:163], v[92:95], v[28:31]
  ds_read_b64_tr_b16 v[254:255], v124 offset:50960
  v_mfma_f32_16x16x32_bf16 v[32:35], v[164:167], v[88:91], v[32:35]
  ds_read_b64_tr_b16 v[136:137], v3 offset:0
  v_mfma_f32_16x16x32_bf16 v[36:39], v[164:167], v[92:95], v[36:39]
  ds_read_b64_tr_b16 v[138:139], v3 offset:4608
  v_mfma_f32_16x16x32_bf16 v[40:43], v[168:171], v[88:91], v[40:43]
  ds_read_b128 v[104:107], v127 offset:57344
  v_mfma_f32_16x16x32_bf16 v[44:47], v[168:171], v[92:95], v[44:47]
  ds_read_b128 v[108:111], v127 offset:59392
  v_mfma_f32_16x16x32_bf16 v[48:51], v[172:175], v[88:91], v[48:51]
  ds_read_b64_tr_b16 v[140:141], v3 offset:32
  v_mfma_f32_16x16x32_bf16 v[52:55], v[172:175], v[92:95], v[52:55]
  ds_read_b64_tr_b16 v[142:143], v3 offset:4640
  s_waitcnt lgkmcnt(12)
  v_mfma_f32_16x16x32_bf16 v[16:19], v[176:179], v[96:99], v[16:19]
  ds_read_b64_tr_b16 v[144:145], v3 offset:64
  s_waitcnt lgkmcnt(12)
  v_mfma_f32_16x16x32_bf16 v[20:23], v[176:179], v[100:103], v[20:23]
  ds_read_b64_tr_b16 v[146:147], v3 offset:4672
  v_mfma_f32_16x16x32_bf16 v[24:27], v[180:183], v[96:99], v[24:27]
  ds_read_b64_tr_b16 v[148:149], v3 offset:96
  v_mfma_f32_16x16x32_bf16 v[28:31], v[180:183], v[100:103], v[28:31]
  ds_read_b64_tr_b16 v[150:151], v3 offset:4704
  v_mfma_f32_16x16x32_bf16 v[32:35], v[184:187], v[96:99], v[32:35]
  ds_read_b64_tr_b16 v[152:153], v3 offset:128
  v_mfma_f32_16x16x32_bf16 v[36:39], v[184:187], v[100:103], v[36:39]
  ds_read_b64_tr_b16 v[154:155], v3 offset:4736
  v_mfma_f32_16x16x32_bf16 v[40:43], v[188:191], v[96:99], v[40:43]
  s_waitcnt lgkmcnt(8)
  s_barrier
  v_mfma_f32_16x16x32_bf16 v[44:47], v[188:191], v[100:103], v[44:47]
  ds_read_b128 v[80:83], v127 offset:0
  v_mfma_f32_16x16x32_bf16 v[48:51], v[192:195], v[96:99], v[48:51]
  ds_read_b128 v[84:87], v127 offset:2048
  v_mfma_f32_16x16x32_bf16 v[52:55], v[192:195], v[100:103], v[52:55]
  ds_read_b64_tr_b16 v[156:157], v3 offset:144
  v_mfma_f32_16x16x32_bf16 v[16:19], v[196:199], v[104:107], v[16:19]
  ds_read_b64_tr_b16 v[158:159], v3 offset:4752
  v_mfma_f32_16x16x32_bf16 v[20:23], v[196:199], v[108:111], v[20:23]
  ds_read_b64_tr_b16 v[160:161], v3 offset:176
  v_mfma_f32_16x16x32_bf16 v[24:27], v[200:203], v[104:107], v[24:27]
  ds_read_b64_tr_b16 v[162:163], v3 offset:4784
  v_mfma_f32_16x16x32_bf16 v[28:31], v[200:203], v[108:111], v[28:31]
  ds_read_b64_tr_b16 v[164:165], v3 offset:208
  v_mfma_f32_16x16x32_bf16 v[32:35], v[204:207], v[104:107], v[32:35]
  ds_read_b64_tr_b16 v[166:167], v3 offset:4816
  v_mfma_f32_16x16x32_bf16 v[36:39], v[204:207], v[108:111], v[36:39]
  ds_read_b64_tr_b16 v[168:169], v3 offset:240
  v_mfma_f32_16x16x32_bf16 v[40:43], v[208:211], v[104:107], v[40:43]
  ds_read_b128 v[88:91], v127 offset:1024
  v_mfma_f32_16x16x32_bf16 v[44:47], v[208:211], v[108:111], v[44:47]
  ds_read_b128 v[92:95], v127 offset:3072
  v_mfma_f32_16x16x32_bf16 v[48:51], v[212:215], v[104:107], v[48:51]
  ds_read_b64_tr_b16 v[170:171], v3 offset:4848
  v_mfma_f32_16x16x32_bf16 v[52:55], v[212:215], v[108:111], v[52:55]
  ds_read_b64_tr_b16 v[172:173], v3 offset:272
  s_waitcnt lgkmcnt(12)
  v_mfma_f32_16x16x32_bf16 v[16:19], v[216:219], v[80:83], v[16:19]
  ds_read_b64_tr_b16 v[174:175], v3 offset:4880
  s_waitcnt lgkmcnt(12)
  v_mfma_f32_16x16x32_bf16 v[20:23], v[216:219], v[84:87], v[20:23]
  ds_read_b64_tr_b16 v[176:177], v3 offset:9216
  v_mfma_f32_16x16x32_bf16 v[24:27], v[220:223], v[80:83], v[24:27]
  ds_read_b64_tr_b16 v[178:179], v3 offset:13824
  v_mfma_f32_16x16x32_bf16 v[28:31], v[220:223], v[84:87], v[28:31]
  ds_read_b64_tr_b16 v[180:181], v3 offset:9248
  v_mfma_f32_16x16x32_bf16 v[32:35], v[224:227], v[80:83], v[32:35]
  ds_read_b64_tr_b16 v[182:183], v3 offset:13856
  v_mfma_f32_16x16x32_bf16 v[36:39], v[224:227], v[84:87], v[36:39]
  ds_read_b64_tr_b16 v[184:185], v3 offset:9280
  v_mfma_f32_16x16x32_bf16 v[40:43], v[228:231], v[80:83], v[40:43]
  s_waitcnt lgkmcnt(8)
  s_barrier
  v_mfma_f32_16x16x32_bf16 v[44:47], v[228:231], v[84:87], v[44:47]
  ds_read_b128 v[96:99], v127 offset:16384
  v_mfma_f32_16x16x32_bf16 v[48:51], v[232:235], v[80:83], v[48:51]
  ds_read_b128 v[100:103], v127 offset:18432
  v_mfma_f32_16x16x32_bf16 v[52:55], v[232:235], v[84:87], v[52:55]
  ds_read_b64_tr_b16 v[186:187], v3 offset:13888
  v_mfma_f32_16x16x32_bf16 v[16:19], v[236:239], v[88:91], v[16:19]
  ds_read_b64_tr_b16 v[188:189], v3 offset:9312
  v_mfma_f32_16x16x32_bf16 v[20:23], v[236:239], v[92:95], v[20:23]
  ds_read_b64_tr_b16 v[190:191], v3 offset:13920
  v_mfma_f32_16x16x32_bf16 v[24:27], v[240:243], v[88:91], v[24:27]
  ds_read_b64_tr_b16 v[192:193], v3 offset:9344
  v_mfma_f32_16x16x32_bf16 v[28:31], v[240:243], v[92:95], v[28:31]
  ds_read_b64_tr_b16 v[194:195], v3 offset:13952
  v_mfma_f32_16x16x32_bf16 v[32:35], v[244:247], v[88:91], v[32:35]
  ds_read_b64_tr_b16 v[196:197], v3 offset:9360
  v_mfma_f32_16x16x32_bf16 v[36:39], v[244:247], v[92:95], v[36:39]
  ds_read_b64_tr_b16 v[198:199], v3 offset:13968
  v_mfma_f32_16x16x32_bf16 v[40:43], v[248:251], v[88:91], v[40:43]
  ds_read_b128 v[104:107], v127 offset:17408
  v_mfma_f32_16x16x32_bf16 v[44:47], v[248:251], v[92:95], v[44:47]
  ds_read_b128 v[108:111], v127 offset:19456
  v_mfma_f32_16x16x32_bf16 v[48:51], v[252:255], v[88:91], v[48:51]
  ds_read_b64_tr_b16 v[200:201], v3 offset:9392
  v_mfma_f32_16x16x32_bf16 v[52:55], v[252:255], v[92:95], v[52:55]
  ds_read_b64_tr_b16 v[202:203], v3 offset:14000
  s_waitcnt lgkmcnt(12)
  v_mfma_f32_16x16x32_bf16 v[16:19], v[136:139], v[96:99], v[16:19]
  ds_read_b64_tr_b16 v[204:205], v3 offset:9424
  s_waitcnt lgkmcnt(12)
  v_mfma_f32_16x16x32_bf16 v[20:23], v[136:139], v[100:103], v[20:23]
  ds_read_b64_tr_b16 v[206:207], v3 offset:14032
  v_mfma_f32_16x16x32_bf16 v[24:27], v[140:143], v[96:99], v[24:27]
  ds_read_b64_tr_b16 v[208:209], v3 offset:9456
  v_mfma_f32_16x16x32_bf16 v[28:31], v[140:143], v[100:103], v[28:31]
  ds_read_b64_tr_b16 v[210:211], v3 offset:14064
  v_mfma_f32_16x16x32_bf16 v[32:35], v[144:147], v[96:99], v[32:35]
  ds_read_b64_tr_b16 v[212:213], v3 offset:9488
  v_mfma_f32_16x16x32_bf16 v[36:39], v[144:147], v[100:103], v[36:39]
  ds_read_b64_tr_b16 v[214:215], v3 offset:14096
  v_mfma_f32_16x16x32_bf16 v[40:43], v[148:151], v[96:99], v[40:43]
  s_waitcnt lgkmcnt(8)
  s_barrier
  v_mfma_f32_16x16x32_bf16 v[44:47], v[148:151], v[100:103], v[44:47]
  ds_read_b128 v[80:83], v126 offset:0
  v_mfma_f32_16x16x32_bf16 v[48:51], v[152:155], v[96:99], v[48:51]
  ds_read_b64_tr_b16 v[216:217], v3 offset:18432
  v_mfma_f32_16x16x32_bf16 v[52:55], v[152:155], v[100:103], v[52:55]
  ds_read_b64_tr_b16 v[218:219], v3 offset:23040
  v_mfma_f32_16x16x32_bf16 v[16:19], v[156:159], v[104:107], v[16:19]
  ds_read_b64_tr_b16 v[220:221], v3 offset:18464
  v_mfma_f32_16x16x32_bf16 v[20:23], v[156:159], v[108:111], v[20:23]
  ds_read_b128 v[84:87], v126 offset:1024
  v_mfma_f32_16x16x32_bf16 v[24:27], v[160:163], v[104:107], v[24:27]
  ds_read_b64_tr_b16 v[222:223], v3 offset:23072
  v_mfma_f32_16x16x32_bf16 v[28:31], v[160:163], v[108:111], v[28:31]
  ds_read_b64_tr_b16 v[224:225], v3 offset:18496
  v_mfma_f32_16x16x32_bf16 v[32:35], v[164:167], v[104:107], v[32:35]
  ds_read_b64_tr_b16 v[226:227], v3 offset:23104
  v_mfma_f32_16x16x32_bf16 v[36:39], v[164:167], v[108:111], v[36:39]
  ds_read_b64_tr_b16 v[228:229], v3 offset:18528
  v_mfma_f32_16x16x32_bf16 v[40:43], v[168:171], v[104:107], v[40:43]
  s_waitcnt lgkmcnt(4)
  s_barrier
  v_mfma_f32_16x16x32_bf16 v[44:47], v[168:171], v[108:111], v[44:47]
  ds_read_b128 v[88:91], v126 offset:16384
  v_mfma_f32_16x16x32_bf16 v[48:51], v[172:175], v[104:107], v[48:51]
  ds_read_b64_tr_b16 v[230:231], v3 offset:23136
  v_mfma_f32_16x16x32_bf16 v[52:55], v[172:175], v[108:111], v[52:55]
  ds_read_b64_tr_b16 v[232:233], v3 offset:18560
  v_mfma_f32_16x16x32_bf16 v[16:19], v[176:179], v[80:83], v[16:19]
  ds_read_b64_tr_b16 v[234:235], v3 offset:23168
  v_mfma_f32_16x16x32_bf16 v[24:27], v[180:183], v[80:83], v[24:27]
  ds_read_b128 v[92:95], v126 offset:17408
  v_mfma_f32_16x16x32_bf16 v[32:35], v[184:187], v[80:83], v[32:35]
  ds_read_b64_tr_b16 v[236:237], v3 offset:18576
  v_mfma_f32_16x16x32_bf16 v[40:43], v[188:191], v[80:83], v[40:43]
  ds_read_b64_tr_b16 v[238:239], v3 offset:23184
  v_mfma_f32_16x16x32_bf16 v[48:51], v[192:195], v[80:83], v[48:51]
  ds_read_b64_tr_b16 v[240:241], v3 offset:18608
  v_mfma_f32_16x16x32_bf16 v[16:19], v[196:199], v[84:87], v[16:19]
  ds_read_b64_tr_b16 v[242:243], v3 offset:23216
  v_mfma_f32_16x16x32_bf16 v[24:27], v[200:203], v[84:87], v[24:27]
  ds_read_b128 v[96:99], v126 offset:2048
  v_mfma_f32_16x16x32_bf16 v[32:35], v[204:207], v[84:87], v[32:35]
  ds_read_b64_tr_b16 v[244:245], v3 offset:18640
  v_mfma_f32_16x16x32_bf16 v[40:43], v[208:211], v[84:87], v[40:43]
  ds_read_b64_tr_b16 v[246:247], v3 offset:23248
  v_mfma_f32_16x16x32_bf16 v[48:51], v[212:215], v[84:87], v[48:51]
  ds_read_b64_tr_b16 v[248:249], v3 offset:18672
  s_waitcnt lgkmcnt(12)
  v_mfma_f32_16x16x32_bf16 v[16:19], v[216:219], v[88:91], v[16:19]
  ds_read_b64_tr_b16 v[250:251], v3 offset:23280
  v_mfma_f32_16x16x32_bf16 v[24:27], v[220:223], v[88:91], v[24:27]
  ds_read_b128 v[100:103], v126 offset:3072
  v_mfma_f32_16x16x32_bf16 v[32:35], v[224:227], v[88:91], v[32:35]
  ds_read_b64_tr_b16 v[252:253], v3 offset:18704
  s_waitcnt lgkmcnt(14)
  v_mfma_f32_16x16x32_bf16 v[40:43], v[228:231], v[88:91], v[40:43]
  ds_read_b64_tr_b16 v[254:255], v3 offset:23312
  s_waitcnt lgkmcnt(13)
  v_mfma_f32_16x16x32_bf16 v[48:51], v[232:235], v[88:91], v[48:51]
  s_waitcnt lgkmcnt(10)
  v_mfma_f32_16x16x32_bf16 v[16:19], v[236:239], v[92:95], v[16:19]
  s_waitcnt lgkmcnt(8)
  v_mfma_f32_16x16x32_bf16 v[24:27], v[240:243], v[92:95], v[24:27]
  ds_read_b128 v[104:107], v126 offset:18432
  s_waitcnt lgkmcnt(6)
  v_mfma_f32_16x16x32_bf16 v[32:35], v[244:247], v[92:95], v[32:35]
  s_waitcnt lgkmcnt(4)
  v_mfma_f32_16x16x32_bf16 v[40:43], v[248:251], v[92:95], v[40:43]
  s_waitcnt lgkmcnt(1)
  v_mfma_f32_16x16x32_bf16 v[48:51], v[252:255], v[92:95], v[48:51]
  v_mfma_f32_16x16x32_bf16 v[20:23], v[176:179], v[96:99], v[20:23]
  v_mfma_f32_16x16x32_bf16 v[28:31], v[180:183], v[96:99], v[28:31]
  ds_read_b128 v[108:111], v126 offset:19456
  v_mfma_f32_16x16x32_bf16 v[36:39], v[184:187], v[96:99], v[36:39]
  v_mfma_f32_16x16x32_bf16 v[44:47], v[188:191], v[96:99], v[44:47]
  v_mfma_f32_16x16x32_bf16 v[52:55], v[192:195], v[96:99], v[52:55]
  v_cvt_pk_bf16_f32 v16, v16, v17
  v_cvt_pk_bf16_f32 v17, v18, v19
  v_mfma_f32_16x16x32_bf16 v[20:23], v[196:199], v[100:103], v[20:23]
  ds_write_b64 v118, v[16:17] offset:0
  v_cvt_pk_bf16_f32 v24, v24, v25
  v_mfma_f32_16x16x32_bf16 v[28:31], v[200:203], v[100:103], v[28:31]
  v_cvt_pk_bf16_f32 v25, v26, v27
  ds_write_b64 v118, v[24:25] offset:32
  v_mfma_f32_16x16x32_bf16 v[36:39], v[204:207], v[100:103], v[36:39]
  v_cvt_pk_bf16_f32 v32, v32, v33
  v_cvt_pk_bf16_f32 v33, v34, v35
  v_mfma_f32_16x16x32_bf16 v[44:47], v[208:211], v[100:103], v[44:47]
  ds_write_b64 v118, v[32:33] offset:64
  v_cvt_pk_bf16_f32 v40, v40, v41
  v_mfma_f32_16x16x32_bf16 v[52:55], v[212:215], v[100:103], v[52:55]
  v_cvt_pk_bf16_f32 v41, v42, v43
  ds_write_b64 v118, v[40:41] offset:96
  s_waitcnt lgkmcnt(5)
  v_mfma_f32_16x16x32_bf16 v[20:23], v[216:219], v[104:107], v[20:23]
  v_cvt_pk_bf16_f32 v48, v48, v49
  v_cvt_pk_bf16_f32 v49, v50, v51
  v_mfma_f32_16x16x32_bf16 v[28:31], v[220:223], v[104:107], v[28:31]
  s_mov_b32 exec_hi, 0
  ds_write_b64 v118, v[48:49] offset:128
  s_mov_b32 exec_hi, -1
  s_waitcnt lgkmcnt(0)
  v_mfma_f32_16x16x32_bf16 v[36:39], v[224:227], v[104:107], v[36:39]
  ds_read_b128 v[56:59], v125 offset:0
  ds_read_b128 v[60:63], v125 offset:1024
  v_mfma_f32_16x16x32_bf16 v[44:47], v[228:231], v[104:107], v[44:47]
  v_mfma_f32_16x16x32_bf16 v[52:55], v[232:235], v[104:107], v[52:55]
  v_mfma_f32_16x16x32_bf16 v[20:23], v[236:239], v[108:111], v[20:23]
  v_mfma_f32_16x16x32_bf16 v[28:31], v[240:243], v[108:111], v[28:31]
  v_mfma_f32_16x16x32_bf16 v[36:39], v[244:247], v[108:111], v[36:39]
  v_mfma_f32_16x16x32_bf16 v[44:47], v[248:251], v[108:111], v[44:47]
  v_mfma_f32_16x16x32_bf16 v[52:55], v[252:255], v[108:111], v[52:55]
  s_barrier
  s_waitcnt lgkmcnt(1)
  buffer_store_dwordx4 v[56:59], v119, s[48:51], s11 offen
  s_waitcnt lgkmcnt(0)
  buffer_store_dwordx4 v[60:63], v120, s[48:51], s11 offen
  v_cvt_pk_bf16_f32 v20, v20, v21
  v_cvt_pk_bf16_f32 v21, v22, v23
  ds_write_b64 v118, v[20:21] offset:2304
  v_cvt_pk_bf16_f32 v28, v28, v29
  v_cvt_pk_bf16_f32 v29, v30, v31
  ds_write_b64 v118, v[28:29] offset:2336
  v_cvt_pk_bf16_f32 v36, v36, v37
  v_cvt_pk_bf16_f32 v37, v38, v39
  ds_write_b64 v118, v[36:37] offset:2368
  v_cvt_pk_bf16_f32 v44, v44, v45
  v_cvt_pk_bf16_f32 v45, v46, v47
  ds_write_b64 v118, v[44:45] offset:2400
  v_cvt_pk_bf16_f32 v52, v52, v53
  v_cvt_pk_bf16_f32 v53, v54, v55
  s_mov_b32 exec_hi, 0
  ds_write_b64 v118, v[52:53] offset:2432
  s_mov_b32 exec_hi, -1
  s_waitcnt lgkmcnt(0)
  ds_read_b128 v[64:67], v125 offset:2048
  ds_read_b128 v[68:71], v125 offset:3072
  ds_read_b128 v[72:75], v125 offset:4096
  s_waitcnt lgkmcnt(2)
  buffer_store_dwordx4 v[64:67], v121, s[48:51], s11 offen
  s_waitcnt lgkmcnt(1)
  buffer_store_dwordx4 v[68:71], v122, s[48:51], s11 offen
  s_mov_b32 exec_hi, 0
  s_waitcnt lgkmcnt(0)
  buffer_store_dwordx4 v[72:75], v123, s[48:51], s11 offen
  s_endpgm
  s_nop 0
L_HA:
  s_mov_b64 s[0:1], s[30:31]
  s_mov_b32 s52, s34
  s_mov_b32 s53, s35
  s_mov_b32 s54, 0x2000000
  s_mov_b32 s55, 0x20000
  s_mov_b32 s60, s32
  s_mov_b32 s61, s33
  s_mov_b32 s62, 256
  s_mov_b32 s63, 0x20000
  s_lshl_b32 s14, s4, 3
  s_add_u32 s14, s14, s6
  s_mul_i32 s26, s14, 90112
  s_mul_i32 s27, s5, 5632
  s_add_u32 s27, s27, s26
  s_lshl2_add_u32 s13, s5, s8
  s_mul_i32 s28, s13, 73728
  s_mul_i32 s13, s4, 1152
  s_add_u32 s28, s28, s13
  s_mov_b64 s[70:71], 0xffff
  s_mov_b32 s76, 1069066811
  s_mov_b32 s77, 1069066811
  s_mov_b32 s78, 897988541
  s_lshl_b32 s29, s6, 7
  s_add_u32 s29, s29, s28
  s_mul_i32 s30, s6, 4608
  s_add_u32 s30, s30, s28
  s_add_u32 s30, s30, 1024
  s_mov_b32 s31, 0
  s_mov_b32 s46, 663552
  s_mov_b32 s47, 0x20000
  v_mov_b32 v48, -1
  v_mov_b32 v49, -1
  v_mov_b32 v50, -1
  v_mov_b32 v51, -1
  s_setprio 2
  v_lshrrev_b32 v16, 4, v0
  v_and_b32 v17, 15, v0
  v_mov_b32 v46, 2147483392
  v_mul_u32_u24 v41, 3641, v0
  v_lshrrev_b32 v41, 16, v41
  v_mul_u32_u24 v42, 18, v41
  v_sub_u32 v42, v0, v42
  v_cmp_le_u32 s[72:73], 9, v42
  v_lshlrev_b32 v42, 4, v42
  v_and_b32 v43, 4, v41
  v_add_u32 v43, v43, v41
  v_mul_u32_u24 v44, 3456, v43
  v_add_u32 v44, v44, v42
  v_add_u32 v45, 110448, v44
  v_cndmask_b32 v7, v44, v45, s[72:73]
  v_mul_u32_u24 v44, 1152, v43
  v_add_u32 v44, v44, v42
  v_add_u32 v45, 41328, v44
  v_cndmask_b32 v10, v44, v45, s[72:73]
  v_lshrrev_b32 v43, 2, v41
  v_mul_u32_u24 v43, 72, v43
  v_bfe_u32 v44, v41, 1, 1
  v_mul_u32_u24 v44, 18, v44
  v_and_b32 v45, 1, v41
  v_add3_u32 v43, v43, v44, v45
  v_mul_u32_u24 v44, 1152, v43
  v_add_u32 v44, v44, v42
  v_add_u32 v45, 331632, v44
  v_cndmask_b32 v13, v44, v45, s[72:73]
  v_add_u32 v40, 64, v0
  v_mul_u32_u24 v41, 3641, v40
  v_lshrrev_b32 v41, 16, v41
  v_mul_u32_u24 v42, 18, v41
  v_sub_u32 v42, v40, v42
  v_cmp_le_u32 s[72:73], 9, v42
  v_lshlrev_b32 v42, 4, v42
  v_subrev_u32 v42, 1024, v42
  v_and_b32 v43, 4, v41
  v_add_u32 v43, v43, v41
  v_mul_u32_u24 v44, 3456, v43
  v_add_u32 v44, v44, v42
  v_add_u32 v45, 110448, v44
  v_cndmask_b32 v8, v44, v45, s[72:73]
  v_mul_u32_u24 v44, 1152, v43
  v_add_u32 v44, v44, v42
  v_add_u32 v45, 41328, v44
  v_cndmask_b32 v11, v44, v45, s[72:73]
  v_lshrrev_b32 v43, 2, v41
  v_mul_u32_u24 v43, 72, v43
  v_bfe_u32 v44, v41, 1, 1
  v_mul_u32_u24 v44, 18, v44
  v_and_b32 v45, 1, v41
  v_add3_u32 v43, v43, v44, v45
  v_mul_u32_u24 v44, 1152, v43
  v_add_u32 v44, v44, v42
  v_add_u32 v45, 331632, v44
  v_cndmask_b32 v14, v44, v45, s[72:73]
  v_add_u32 v40, 128, v0
  v_mul_u32_u24 v41, 3641, v40
  v_lshrrev_b32 v41, 16, v41
  s_add_u32 m0, s64, 0
  s_nop 0
  buffer_load_dwordx4 v1, s[36:39], s10 offen offset:0  lds
  v_mul_u32_u24 v42, 18, v41
  v_sub_u32 v42, v40, v42
  v_cmp_le_u32 s[72:73], 9, v42
  v_lshlrev_b32 v42, 4, v42
  v_subrev_u32 v42, 2048, v42
  v_and_b32 v43, 4, v41
  v_add_u32 v43, v43, v41
  v_mul_u32_u24 v44, 3456, v43
  v_add_u32 v44, v44, v42
  v_add_u32 v45, 110448, v44
  v_cndmask_b32 v9, v44, v45, s[72:73]
  v_mul_u32_u24 v44, 1152, v43
  v_add_u32 v44, v44, v42
  v_add_u32 v45, 41328, v44
  v_cndmask_b32 v12, v44, v45, s[72:73]
  v_lshrrev_b32 v43, 2, v41
  v_mul_u32_u24 v43, 72, v43
  v_bfe_u32 v44, v41, 1, 1
  v_mul_u32_u24 v44, 18, v44
  v_and_b32 v45, 1, v41
  v_add3_u32 v43, v43, v44, v45
  v_mul_u32_u24 v44, 1152, v43
  v_add_u32 v44, v44, v42
  v_add_u32 v45, 331632, v44
  v_cndmask_b32 v15, v44, v45, s[72:73]
  s_and_b32 s69, s8, 1
  s_lshl_b32 s66, s69, 4
  s_mul_i32 s67, s69, 18
  s_and_b32 s69, s8, 2
  s_lshl_b32 s69, s69, 1
  s_add_u32 s66, s66, s69
  s_add_u32 s67, s67, s69
  s_mul_i32 s66, s66, 3456
  s_mul_i32 s69, s6, 72
  s_add_u32 s67, s67, s69
  s_add_u32 s13, s10, 8192
  buffer_load_dwordx4 v1, s[36:39], s13 offen offset:1024  lds
  s_mul_i32 s67, s67, 1152
  s_lshl_b32 s69, s69, 1
  s_add_u32 s51, s66, s69
  s_add_u32 s67, s67, s69
  s_mul_i32 s69, s9, 221184
  s_add_u32 s66, s51, s69
  s_mul_i32 s68, s8, 2304
  v_and_b32 v40, 28, v0
  v_and_b32 v41, 2, v16
  v_add_u32 v40, v40, v41
  v_mul_u32_u24 v40, 296, v40
  v_add_u32 v40, 82944, v40
  v_and_b32 v41, 3, v0
  v_and_b32 v42, 1, v0
  s_mul_i32 s69, s8, 36
  s_and_b32 s3, s8, 1
  s_lshl_b32 s3, s3, 2
  s_sub_u32 s69, s69, s3
  s_add_u32 s69, s69, 144
  v_lshlrev_b32 v43, 3, v41
  v_add3_u32 v20, v40, v43, s69
  s_add_u32 s69, s69, 32
  v_mov_b32 v44, s69
  v_cmp_ne_u32 s[72:73], 0, v41
  v_mov_b32 v45, 288
  s_nop 0
  v_cndmask_b32 v44, v44, v45, s[72:73]
  v_add_u32 v21, v40, v44
  s_lshr_b32 s69, s8, 1
  s_mul_i32 s69, s69, 72
  s_lshl_b32 s3, s3, 3
  s_add_u32 s69, s69, s3
  v_add3_u32 v19, v40, v43, s69
  s_bitcmp1_b32 s8, 0
  s_cselect_b64 s[34:35], s[70:71], 0
  s_cselect_b64 s[32:33], 0, -1
  s_add_u32 s13, s10, 16384
  buffer_load_dwordx4 v1, s[36:39], s13 offen offset:2048  lds
  s_and_b32 s3, s8, 1
  s_lshl_b32 s3, s3, 1
  v_subrev_u32 v40, s3, v17
  v_add_u32 v41, 16, v40
  v_cmp_gt_u32 s[72:73], 18, v41
  v_cmp_gt_u32 s[74:75], 4, v17
  s_nop 0
  s_and_b64 s[72:73], s[72:73], s[74:75]
  v_cndmask_b32 v41, -1, v41, s[72:73]
  v_cmp_eq_u32 s[72:73], 4, v17
  v_mul_u32_u24 v43, 19, v16
  s_nop 0
  v_cndmask_b32 v41, v41, 18, s[72:73]
  v_cmp_gt_u32 s[72:73], 19, v40
  s_mul_i32 s69, s8, 760
  v_add_u32 v44, v43, v40
  v_lshl_add_u32 v44, v44, 3, s69
  v_cndmask_b32 v23, v46, v44, s[72:73]
  s_and_b64 s[72:73], s[72:73], s[70:71]
  s_mul_i32 s69, s8, 760
  s_add_u32 s69, s69, 608
  v_lshl_add_u32 v44, v40, 3, s69
  v_cndmask_b32 v24, v46, v44, s[72:73]
  v_cmp_gt_u32 s[72:73], 19, v41
  s_mul_i32 s69, s8, 760
  v_add_u32 v44, v43, v41
  v_lshl_add_u32 v44, v44, 3, s69
  v_cndmask_b32 v25, v46, v44, s[72:73]
  s_and_b64 s[72:73], s[72:73], s[70:71]
  s_mul_i32 s69, s8, 760
  s_add_u32 s69, s69, 608
  v_lshl_add_u32 v44, v41, 3, s69
  v_cndmask_b32 v26, v46, v44, s[72:73]
  s_and_b32 s3, s5, 1
  s_lshl_b32 s3, s3, 3
  v_xor_b32 v23, s3, v23
  v_xor_b32 v24, s3, v24
  s_add_u32 s13, s10, 24576
  buffer_load_dwordx4 v1, s[36:39], s13 offen offset:3072  lds
  v_xor_b32 v25, s3, v25
  v_xor_b32 v26, s3, v26
  s_mul_i32 s69, s8, 768
  v_add_u32 v44, s69, v18
  v_add_u32 v29, 157440, v44
  s_add_u32 s69, s69, 768
  s_min_u32 s69, s69, 3040
  v_cmp_gt_u32 s[16:17], s69, v44
  s_nop 1
  v_cndmask_b32 v27, v46, v44, s[16:17]
  v_and_b32 v32, 31, v0
  s_lshl_b32 s69, s8, 5
  v_add_u32 v44, s69, v32
  v_mul_u32_u24 v44, 296, v44
  v_add_u32 v33, 83232, v44
  v_lshlrev_b32 v32, 2, v32
  v_mov_b32 v34, 0x3f803f80
  v_mov_b32 v35, 0x3f803f80
  v_bfe_u32 v41, v0, 2, 2
  v_cmp_eq_u32 s[72:73], v16, v41
  v_lshlrev_b32 v40, 4, v42
  v_mov_b32 v41, 0x3f80
  v_lshlrev_b32 v40, v40, v41
  v_cndmask_b32 v40, 0, v40, s[72:73]
  v_and_b32 v41, 2, v0
  v_cmp_eq_u32 s[72:73], 0, v41
  s_nop 1
  v_cndmask_b32 v36, 0, v40, s[72:73]
  v_cndmask_b32 v37, v40, 0, s[72:73]
  v_mov_b32 v38, v36
  v_mov_b32 v39, v37
  s_lshr_b32 s3, s2, 3
  s_lshl_b32 s3, s3, 2
  s_add_u32 s3, s3, s8
  s_mul_i32 s3, s3, 41
  v_add_u32 v40, s3, v0
  v_lshlrev_b32 v40, 7, v40
  s_add_u32 m0, s65, 0
  s_nop 0
  buffer_load_dwordx4 v2, s[40:43], s11 offen offset:0 lds
  v_cmp_gt_u32 s[72:73], 41, v0
  s_nop 1
  v_cndmask_b32 v254, v46, v40, s[72:73]
  v_lshrrev_b32 v40, 3, v0
  v_mul_u32_u24 v40, 2176, v40
  v_add_u32 v255, v40, v18
  buffer_load_dwordx4 v3, s[40:43], s11 offen offset:1024 lds
  s_waitcnt vmcnt(6)
  s_barrier
  buffer_load_dwordx4 v4, s[40:43], s11 offen offset:2048 lds
  buffer_load_dwordx4 v5, s[40:43], s11 offen offset:3072 lds
  s_add_u32 m0, s65, 4096
  s_mov_b32 exec_hi, 0
  buffer_load_dwordx4 v6, s[40:43], s11 offen lds
  s_mov_b32 exec_hi, -1
  s_bfe_u32 s14, s48, 262148
  s_mul_i32 s15, s14, 128
  s_add_u32 s10, s49, s15
  s_mul_i32 s15, s14, 221184
  s_add_u32 s11, s50, s15
  s_add_u32 m0, s64, 34816
  s_nop 0
  buffer_load_dwordx4 v1, s[36:39], s10 offen offset:0  lds
  s_add_u32 s13, s10, 8192
  buffer_load_dwordx4 v1, s[36:39], s13 offen offset:1024  lds
  s_add_u32 s13, s10, 16384
  buffer_load_dwordx4 v1, s[36:39], s13 offen offset:2048  lds
  s_add_u32 s13, s10, 24576
  buffer_load_dwordx4 v1, s[36:39], s13 offen offset:3072  lds
  s_add_u32 m0, s65, 34816
  s_nop 0
  buffer_load_dwordx4 v2, s[40:43], s11 offen offset:0 lds
  buffer_load_dwordx4 v3, s[40:43], s11 offen offset:1024 lds
  s_waitcnt vmcnt(6)
  s_barrier
  buffer_load_dwordx4 v4, s[40:43], s11 offen offset:2048 lds
  buffer_load_dwordx4 v5, s[40:43], s11 offen offset:3072 lds
  s_add_u32 m0, s65, 38912
  s_mov_b32 exec_hi, 0
  buffer_load_dwordx4 v6, s[40:43], s11 offen lds
  s_mov_b32 exec_hi, -1
  s_bfe_u32 s14, s48, 262152
  s_mul_i32 s15, s14, 128
  s_add_u32 s10, s49, s15
  s_mul_i32 s15, s14, 221184
  s_add_u32 s11, s50, s15
  s_add_u32 m0, s64, 69632
  s_nop 0
  buffer_load_dwordx4 v1, s[36:39], s10 offen offset:0  lds
  s_add_u32 s13, s10, 8192
  buffer_load_dwordx4 v1, s[36:39], s13 offen offset:1024  lds
  s_add_u32 s13, s10, 16384
  buffer_load_dwordx4 v1, s[36:39], s13 offen offset:2048  lds
  s_add_u32 s13, s10, 24576
  buffer_load_dwordx4 v1, s[36:39], s13 offen offset:3072  lds
  s_add_u32 m0, s65, 69632
  s_nop 0
  buffer_load_dwordx4 v2, s[40:43], s11 offen offset:0 lds
  buffer_load_dwordx4 v3, s[40:43], s11 offen offset:1024 lds
  s_waitcnt vmcnt(6)
  s_barrier
  buffer_load_dwordx4 v4, s[40:43], s11 offen offset:2048 lds
  buffer_load_dwordx4 v5, s[40:43], s11 offen offset:3072 lds
  s_add_u32 m0, s65, 73728
  s_mov_b32 exec_hi, 0
  buffer_load_dwordx4 v6, s[40:43], s11 offen lds
  s_mov_b32 exec_hi, -1
  s_bfe_u32 s14, s48, 262156
  s_mul_i32 s15, s14, 128
  s_add_u32 s10, s49, s15
  s_mul_i32 s15, s14, 221184
  s_add_u32 s11, s50, s15
  s_add_u32 m0, s64, 104448
  s_nop 0
  buffer_load_dwordx4 v1, s[36:39], s10 offen offset:0  lds
  s_add_u32 s13, s10, 8192
  buffer_load_dwordx4 v1, s[36:39], s13 offen offset:1024  lds
  s_add_u32 s13, s10, 16384
  buffer_load_dwordx4 v1, s[36:39], s13 offen offset:2048  lds
  s_add_u32 s13, s10, 24576
  buffer_load_dwordx4 v1, s[36:39], s13 offen offset:3072  lds
  s_add_u32 m0, s65, 104448
  s_nop 0
  buffer_load_dwordx4 v2, s[40:43], s11 offen offset:0 lds
  buffer_load_dwordx4 v3, s[40:43], s11 offen offset:1024 lds
  s_waitcnt vmcnt(6)
  s_barrier
  buffer_load_dwordx4 v4, s[40:43], s11 offen offset:2048 lds
  buffer_load_dwordx4 v5, s[40:43], s11 offen offset:3072 lds
  s_add_u32 m0, s65, 108544
  s_mov_b32 exec_hi, 0
  buffer_load_dwordx4 v6, s[40:43], s11 offen lds
  s_mov_b32 exec_hi, -1
  s_bfe_u32 s14, s48, 262160
  s_mul_i32 s15, s14, 128
  s_add_u32 s10, s49, s15
  s_mul_i32 s15, s14, 221184
  s_add_u32 s11, s50, s15
  s_add_u32 m0, s64, 0
  s_nop 0
  buffer_load_dwordx4 v1, s[36:39], s10 offen offset:0  lds
  s_add_u32 s13, s10, 8192
  buffer_load_dwordx4 v1, s[36:39], s13 offen offset:1024  lds
  s_add_u32 s13, s10, 16384
  buffer_load_dwordx4 v1, s[36:39], s13 offen offset:2048  lds
  s_add_u32 s13, s10, 24576
  buffer_load_dwordx4 v1, s[36:39], s13 offen offset:3072  lds
  s_add_u32 m0, s65, 0
  s_nop 0
  buffer_load_dwordx4 v2, s[40:43], s11 offen offset:0 lds
  buffer_load_dwordx4 v3, s[40:43], s11 offen offset:1024 lds
  s_waitcnt vmcnt(6)
  s_barrier
  buffer_load_dwordx4 v4, s[40:43], s11 offen offset:2048 lds
  buffer_load_dwordx4 v5, s[40:43], s11 offen offset:3072 lds
  s_add_u32 m0, s65, 4096
  s_mov_b32 exec_hi, 0
  buffer_load_dwordx4 v6, s[40:43], s11 offen lds
  s_mov_b32 exec_hi, -1
  s_bfe_u32 s14, s48, 262164
  s_mul_i32 s15, s14, 128
  s_add_u32 s10, s49, s15
  s_mul_i32 s15, s14, 221184
  s_add_u32 s11, s50, s15
  s_add_u32 m0, s64, 34816
  s_nop 0
  buffer_load_dwordx4 v1, s[36:39], s10 offen offset:0  lds
  s_add_u32 s13, s10, 8192
  buffer_load_dwordx4 v1, s[36:39], s13 offen offset:1024  lds
  s_add_u32 s13, s10, 16384
  buffer_load_dwordx4 v1, s[36:39], s13 offen offset:2048  lds
  s_add_u32 s13, s10, 24576
  buffer_load_dwordx4 v1, s[36:39], s13 offen offset:3072  lds
  s_add_u32 m0, s65, 34816
  s_nop 0
  buffer_load_dwordx4 v2, s[40:43], s11 offen offset:0 lds
  buffer_load_dwordx4 v3, s[40:43], s11 offen offset:1024 lds
  s_waitcnt vmcnt(6)
  s_barrier
  buffer_load_dwordx4 v4, s[40:43], s11 offen offset:2048 lds
  buffer_load_dwordx4 v5, s[40:43], s11 offen offset:3072 lds
  s_add_u32 m0, s65, 38912
  s_mov_b32 exec_hi, 0
  buffer_load_dwordx4 v6, s[40:43], s11 offen lds
  s_mov_b32 exec_hi, -1
  s_bfe_u32 s14, s48, 262168
  s_mul_i32 s15, s14, 128
  s_add_u32 s10, s49, s15
  s_mul_i32 s15, s14, 221184
  s_add_u32 s11, s50, s15
  s_add_u32 m0, s64, 69632
  s_nop 0
  buffer_load_dwordx4 v1, s[36:39], s10 offen offset:0  lds
  s_add_u32 s13, s10, 8192
  buffer_load_dwordx4 v1, s[36:39], s13 offen offset:1024  lds
  s_add_u32 s13, s10, 16384
  buffer_load_dwordx4 v1, s[36:39], s13 offen offset:2048  lds
  s_add_u32 s13, s10, 24576
  buffer_load_dwordx4 v1, s[36:39], s13 offen offset:3072  lds
  s_add_u32 m0, s65, 69632
  s_nop 0
  buffer_load_dwordx4 v2, s[40:43], s11 offen offset:0 lds
  buffer_load_dwordx4 v3, s[40:43], s11 offen offset:1024 lds
  s_waitcnt vmcnt(6)
  s_barrier
  buffer_load_dwordx4 v4, s[40:43], s11 offen offset:2048 lds
  buffer_load_dwordx4 v5, s[40:43], s11 offen offset:3072 lds
  s_add_u32 m0, s65, 73728
  s_mov_b32 exec_hi, 0
  buffer_load_dwordx4 v6, s[40:43], s11 offen lds
  s_mov_b32 exec_hi, -1
  s_bfe_u32 s14, s48, 262172
  s_mul_i32 s15, s14, 128
  s_add_u32 s10, s49, s15
  s_mul_i32 s15, s14, 221184
  s_add_u32 s11, s50, s15
  s_add_u32 m0, s64, 104448
  s_nop 0
  buffer_load_dwordx4 v1, s[36:39], s10 offen offset:0  lds
  s_add_u32 s13, s10, 8192
  buffer_load_dwordx4 v1, s[36:39], s13 offen offset:1024  lds
  s_add_u32 s13, s10, 16384
  buffer_load_dwordx4 v1, s[36:39], s13 offen offset:2048  lds
  s_add_u32 s13, s10, 24576
  buffer_load_dwordx4 v1, s[36:39], s13 offen offset:3072  lds
  s_add_u32 m0, s65, 104448
  s_nop 0
  buffer_load_dwordx4 v2, s[40:43], s11 offen offset:0 lds
  buffer_load_dwordx4 v3, s[40:43], s11 offen offset:1024 lds
  s_waitcnt vmcnt(6)
  s_barrier
  buffer_load_dwordx4 v4, s[40:43], s11 offen offset:2048 lds
  buffer_load_dwordx4 v5, s[40:43], s11 offen offset:3072 lds
  s_add_u32 m0, s65, 108544
  s_mov_b32 exec_hi, 0
  buffer_load_dwordx4 v6, s[40:43], s11 offen lds
  s_mov_b32 exec_hi, -1
  s_add_u32 m0, s68, 0
  s_nop 0
  buffer_load_dwordx4 v7, s[40:43], s66 offen offset:0 lds
  buffer_load_dwordx4 v8, s[40:43], s66 offen offset:1024 lds
  s_mov_b64 exec, 0xffff
  buffer_load_dwordx4 v9, s[40:43], s66 offen offset:2048 lds
  s_mov_b64 exec, -1
  s_bfe_u32 s14, s48, 262160
  s_mul_i32 s15, s14, 221184
  s_add_u32 s66, s51, s15
  s_add_u32 m0, s68, 9216
  s_nop 0
  buffer_load_dwordx4 v7, s[40:43], s66 offen offset:0 lds
  buffer_load_dwordx4 v8, s[40:43], s66 offen offset:1024 lds
  s_mov_b64 exec, 0xffff
  buffer_load_dwordx4 v9, s[40:43], s66 offen offset:2048 lds
  s_mov_b64 exec, -1
  s_bfe_u32 s14, s48, 262172
  s_mul_i32 s15, s14, 221184
  s_add_u32 s66, s51, s15
  s_waitcnt vmcnt(6)
  s_barrier
  s_add_u32 m0, s68, 18432
  s_nop 0
  buffer_load_dwordx4 v7, s[40:43], s66 offen offset:0 lds
  buffer_load_dwordx4 v8, s[40:43], s66 offen offset:1024 lds
  s_mov_b64 exec, 0xffff
  buffer_load_dwordx4 v9, s[40:43], s66 offen offset:2048 lds
  s_mov_b64 exec, -1
  s_bfe_u32 s14, s48, 262144
  s_mul_i32 s15, s14, 221184
  s_add_u32 s66, s51, s15
  s_waitcnt lgkmcnt(0)
  s_waitcnt vmcnt(6)
  s_barrier
  s_mov_b32 exec_hi, 0
  ds_write_b64 v33, v[34:35]
  s_mov_b32 exec_hi, -1
  buffer_load_dword v31, v32, s[60:63], 0 offen offset:0 sc1
  s_add_u32 m0, s68, 27648
  s_nop 0
  buffer_load_dwordx4 v7, s[40:43], s66 offen offset:0 lds
  buffer_load_dwordx4 v8, s[40:43], s66 offen offset:1024 lds
  s_mov_b64 exec, 0xffff
  buffer_load_dwordx4 v9, s[40:43], s66 offen offset:2048 lds
  s_mov_b64 exec, -1
  s_bfe_u32 s14, s48, 262148
  s_mul_i32 s15, s14, 221184
  s_add_u32 s66, s51, s15
  s_add_u32 m0, s68, 36864
  s_nop 0
  buffer_load_dwordx4 v7, s[40:43], s66 offen offset:0 lds
  buffer_load_dwordx4 v8, s[40:43], s66 offen offset:1024 lds
  s_mov_b64 exec, 0xffff
  buffer_load_dwordx4 v9, s[40:43], s66 offen offset:2048 lds
  s_mov_b64 exec, -1
  s_bfe_u32 s14, s48, 262152
  s_mul_i32 s15, s14, 221184
  s_add_u32 s66, s51, s15
  s_add_u32 m0, s68, 46080
  s_nop 0
  buffer_load_dwordx4 v7, s[40:43], s66 offen offset:0 lds
  buffer_load_dwordx4 v8, s[40:43], s66 offen offset:1024 lds
  s_mov_b64 exec, 0xffff
  buffer_load_dwordx4 v9, s[40:43], s66 offen offset:2048 lds
  s_mov_b64 exec, -1
  s_bfe_u32 s14, s48, 262156
  s_mul_i32 s15, s14, 221184
  s_add_u32 s66, s51, s15
  s_add_u32 m0, s68, 55296
  s_nop 0
  buffer_load_dwordx4 v7, s[40:43], s66 offen offset:0 lds
  buffer_load_dwordx4 v8, s[40:43], s66 offen offset:1024 lds
  s_mov_b64 exec, 0xffff
  buffer_load_dwordx4 v9, s[40:43], s66 offen offset:2048 lds
  s_mov_b64 exec, -1
  s_bfe_u32 s14, s48, 262164
  s_mul_i32 s15, s14, 221184
  s_add_u32 s66, s51, s15
  s_add_u32 m0, s68, 64512
  s_nop 0
  buffer_load_dwordx4 v7, s[40:43], s66 offen offset:0 lds
  buffer_load_dwordx4 v8, s[40:43], s66 offen offset:1024 lds
  s_mov_b64 exec, 0xffff
  buffer_load_dwordx4 v9, s[40:43], s66 offen offset:2048 lds
  s_mov_b64 exec, -1
  s_bfe_u32 s14, s48, 262168
  s_mul_i32 s15, s14, 221184
  s_add_u32 s66, s51, s15
  s_add_u32 m0, s68, 73728
  s_nop 0
  buffer_load_dwordx4 v7, s[40:43], s66 offen offset:0 lds
  buffer_load_dwordx4 v8, s[40:43], s66 offen offset:1024 lds
  s_mov_b64 exec, 0xffff
  buffer_load_dwordx4 v9, s[40:43], s66 offen offset:2048 lds
  s_mov_b64 exec, -1
  s_waitcnt vmcnt(18)
  v_and_b32 v47, 0x80808080, v31
  v_cmp_ne_u32 vcc, 0x80808080, v47
  s_nop 0
  s_cbranch_vccnz L_ic1A
L_ic_ok1A:
  s_getreg_b32 s13, hwreg(HW_REG_XCC_ID, 0, 4)
  s_or_b32 s13, s13, 0x80
  s_mul_i32 s13, s13, 0x01010101
  v_cmp_eq_u32 vcc, s13, v31
  s_lshl_b32 s14, s5, 1
  s_lshr_b32 s15, vcc_lo, s14
  s_and_b32 s15, s15, 3
  s_cmp_eq_u32 s15, 3
  s_cselect_b32 s79, 1, 0
  v_mov_b32 v47, s79
  v_mov_b32 v46, 163832
  ds_write_b32 v46, v47
  s_add_u32 s13, s52, 2097152
  s_addc_u32 s14, s53, 0
  s_cmp_eq_u32 s79, 0
  s_cselect_b32 s56, s13, s0
  s_cselect_b32 s57, s14, s1
  s_mov_b32 s58, 4718592
  s_mov_b32 s59, 0x20000
  s_waitcnt vmcnt(0)
  s_waitcnt lgkmcnt(0)
  s_barrier
  buffer_load_dword v254, v254, s[44:47], 0 offen
  s_setprio 3
  ds_read_b64_tr_b16 v[64:65], v20 offset:0
  ds_read_b64_tr_b16 v[66:67], v20 offset:296
  ds_read_b64_tr_b16 v[72:73], v19 offset:0
  ds_read_b64_tr_b16 v[74:75], v19 offset:296
  ds_read_b64_tr_b16 v[68:69], v21 offset:0
  ds_read_b64_tr_b16 v[70:71], v21 offset:296
  ds_read_b64_tr_b16 v[76:77], v19 offset:32
  ds_read_b64_tr_b16 v[78:79], v19 offset:328
  ds_read_b64_tr_b16 v[84:85], v20 offset:9472
  ds_read_b64_tr_b16 v[86:87], v20 offset:9768
  ds_read_b64_tr_b16 v[92:93], v19 offset:9472
  ds_read_b64_tr_b16 v[94:95], v19 offset:9768
  ds_read_b64_tr_b16 v[88:89], v21 offset:9472
  ds_read_b64_tr_b16 v[90:91], v21 offset:9768
  ds_read_b64_tr_b16 v[96:97], v19 offset:9504
  ds_read_b64_tr_b16 v[98:99], v19 offset:9800
  s_waitcnt lgkmcnt(12)
  v_mfma_f32_16x16x32_bf16 v[144:147], v[72:75], v[64:67], 0
  ds_read_b64_tr_b16 v[104:105], v20 offset:18944
  ds_read_b64_tr_b16 v[106:107], v20 offset:19240
  s_waitcnt lgkmcnt(12)
  v_mfma_f32_16x16x32_bf16 v[156:159], v[72:75], v[68:71], 0
  ds_read_b64_tr_b16 v[112:113], v19 offset:18944
  ds_read_b64_tr_b16 v[114:115], v19 offset:19240
  s_waitcnt lgkmcnt(12)
  v_mfma_f32_16x16x32_bf16 v[148:151], v[76:79], v[64:67], 0
  ds_read_b64_tr_b16 v[108:109], v21 offset:18944
  ds_read_b64_tr_b16 v[110:111], v21 offset:19240
  v_mfma_f32_16x16x32_bf16 v[160:163], v[76:79], v[68:71], 0
  ds_read_b64_tr_b16 v[116:117], v19 offset:18976
  ds_read_b64_tr_b16 v[118:119], v19 offset:19272
  s_waitcnt lgkmcnt(12)
  v_mfma_f32_16x16x32_bf16 v[144:147], v[92:95], v[84:87], v[144:147]
  ds_read_b64_tr_b16 v[124:125], v20 offset:28416
  ds_read_b64_tr_b16 v[126:127], v20 offset:28712
  s_waitcnt lgkmcnt(12)
  v_mfma_f32_16x16x32_bf16 v[156:159], v[92:95], v[88:91], v[156:159]
  ds_read_b64_tr_b16 v[132:133], v19 offset:28416
  ds_read_b64_tr_b16 v[134:135], v19 offset:28712
  s_waitcnt lgkmcnt(12)
  v_mfma_f32_16x16x32_bf16 v[148:151], v[96:99], v[84:87], v[148:151]
  ds_read_b64_tr_b16 v[128:129], v21 offset:28416
  ds_read_b64_tr_b16 v[130:131], v21 offset:28712
  v_mfma_f32_16x16x32_bf16 v[160:163], v[96:99], v[88:91], v[160:163]
  ds_read_b64_tr_b16 v[136:137], v19 offset:28448
  ds_read_b64_tr_b16 v[138:139], v19 offset:28744
  s_waitcnt lgkmcnt(12)
  v_mfma_f32_16x16x32_bf16 v[144:147], v[112:115], v[104:107], v[144:147]
  s_waitcnt lgkmcnt(10)
  v_mfma_f32_16x16x32_bf16 v[156:159], v[112:115], v[108:111], v[156:159]
  s_waitcnt lgkmcnt(8)
  v_mfma_f32_16x16x32_bf16 v[148:151], v[116:119], v[104:107], v[148:151]
  v_mfma_f32_16x16x32_bf16 v[160:163], v[116:119], v[108:111], v[160:163]
  s_waitcnt lgkmcnt(4)
  v_mfma_f32_16x16x32_bf16 v[144:147], v[132:135], v[124:127], v[144:147]
  s_waitcnt lgkmcnt(2)
  v_mfma_f32_16x16x32_bf16 v[156:159], v[132:135], v[128:131], v[156:159]
  s_waitcnt lgkmcnt(0)
  v_mfma_f32_16x16x32_bf16 v[148:151], v[136:139], v[124:127], v[148:151]
  v_mfma_f32_16x16x32_bf16 v[160:163], v[136:139], v[128:131], v[160:163]
  s_nop 2
  v_cvt_pk_bf16_f32 v168, v144, v145
  v_cvt_pk_bf16_f32 v169, v146, v147
  s_nop 1
  v_cvt_pk_bf16_f32 v170, v148, v149
  v_cvt_pk_bf16_f32 v171, v150, v151
  v_cndmask_b32 v168, v168, 0, s[34:35]
  v_cndmask_b32 v171, v171, 0, s[32:33]
  buffer_store_dwordx2 v[168:169], v23, s[52:55], s27 offen sc1
  buffer_store_dwordx2 v[170:171], v24, s[52:55], s27 offen sc1
  v_cvt_pk_bf16_f32 v174, v156, v157
  v_cvt_pk_bf16_f32 v175, v158, v159
  v_cvt_pk_bf16_f32 v176, v160, v161
  v_cvt_pk_bf16_f32 v177, v162, v163
  v_cndmask_b32 v174, v174, 0, s[34:35]
  v_cndmask_b32 v177, v177, 0, s[32:33]
  buffer_store_dwordx2 v[174:175], v25, s[52:55], s27 offen sc1
  buffer_store_dwordx2 v[176:177], v26, s[52:55], s27 offen sc1
  s_setprio 0
  s_mov_b32 s12, s6
  v_mov_b32 v64, 0
  v_mov_b32 v65, 0
  v_mov_b32 v130, 0
  v_mov_b32 v131, 0
  s_add_u32 s13, s29, 18432
  s_add_u32 s14, s29, 36864
  s_add_u32 s15, s29, 55296
  s_add_u32 s3, s30, 36864
  s_cmp_eq_u32 s79, 0
  s_cbranch_scc1 L_dpfA
  buffer_store_dwordx4 v[48:51], v255, s[56:59], s29 offen
  buffer_store_dwordx4 v[48:51], v255, s[56:59], s13 offen
  buffer_store_dwordx4 v[48:51], v255, s[56:59], s14 offen
  buffer_store_dwordx4 v[48:51], v255, s[56:59], s15 offen
  s_mov_b64 exec, 0xffff
  buffer_store_dwordx4 v[48:51], v255, s[56:59], s30 offen
  buffer_store_dwordx4 v[48:51], v255, s[56:59], s3 offen
  s_mov_b64 exec, -1
L_d_okpfA:
  s_barrier
  s_add_u32 m0, s68, 82944
  s_nop 0
  buffer_load_dwordx4 v10, s[44:47], s67 offen offset:0 lds
  buffer_load_dwordx4 v11, s[44:47], s67 offen offset:1024 lds
  s_mov_b64 exec, 0xffff
  buffer_load_dwordx4 v12, s[44:47], s67 offen offset:2048 lds
  s_mov_b64 exec, -1
  s_add_u32 s12, s12, 1
  s_cmp_eq_u32 s12, 8
  s_cselect_b32 s14, 663552, 0
  s_add_u32 s67, s67, 82944
  s_sub_u32 s67, s67, s14
  s_add_u32 m0, s68, 92160
  s_nop 0
  buffer_load_dwordx4 v10, s[44:47], s67 offen offset:0 lds
  buffer_load_dwordx4 v11, s[44:47], s67 offen offset:1024 lds
  s_mov_b64 exec, 0xffff
  buffer_load_dwordx4 v12, s[44:47], s67 offen offset:2048 lds
  s_mov_b64 exec, -1
  s_add_u32 s12, s12, 1
  s_cmp_eq_u32 s12, 8
  s_cselect_b32 s14, 663552, 0
  s_add_u32 s67, s67, 82944
  s_sub_u32 s67, s67, s14
  s_add_u32 m0, s68, 101376
  s_nop 0
  buffer_load_dwordx4 v10, s[44:47], s67 offen offset:0 lds
  buffer_load_dwordx4 v11, s[44:47], s67 offen offset:1024 lds
  s_mov_b64 exec, 0xffff
  buffer_load_dwordx4 v12, s[44:47], s67 offen offset:2048 lds
  s_mov_b64 exec, -1
  s_add_u32 s12, s12, 1
  s_cmp_eq_u32 s12, 8
  s_cselect_b32 s14, 663552, 0
  s_add_u32 s67, s67, 82944
  s_sub_u32 s67, s67, s14
  s_add_u32 m0, s68, 110592
  s_nop 0
  buffer_load_dwordx4 v10, s[44:47], s67 offen offset:0 lds
  buffer_load_dwordx4 v11, s[44:47], s67 offen offset:1024 lds
  s_mov_b64 exec, 0xffff
  buffer_load_dwordx4 v12, s[44:47], s67 offen offset:2048 lds
  s_mov_b64 exec, -1
  s_add_u32 s12, s12, 1
  s_cmp_eq_u32 s12, 8
  s_cselect_b32 s14, 663552, 0
  s_add_u32 s67, s67, 82944
  s_sub_u32 s67, s67, s14
  s_lshl_b32 s14, s8, 2
  s_add_u32 s66, s27, 5504
  s_add_u32 s66, s66, s14
  s_mul_i32 s11, s5, 5632
  s_add_u32 s11, s11, 5504
  s_add_u32 s11, s11, s14
  v_mov_b32 v1, 1
  v_and_b32 v32, 7, v0
  s_mov_b32 s14, 90112
  v_mul_lo_u32 v32, v32, s14
  s_waitcnt vmcnt(12)
  s_cmp_eq_u32 s79, 0
  s_cbranch_scc1 L_df2A
  s_mov_b64 exec, 1
  buffer_store_dword v1, v18, s[52:55], s66 offen
  s_mov_b64 exec, -1
L_d_okf2A:
  v_and_b32 v19, 1, v0
  v_and_b32 v26, 2, v0
  v_lshl_add_u32 v19, v26, 3, v19
  v_mul_u32_u24 v19, 2304, v19
  s_mov_b64 exec, 15
  buffer_load_dword v19, v19, s[56:59], s30 offen
  s_mov_b64 exec, -1
  s_and_b32 s69, s5, 3
  s_lshl_b32 s69, s69, 2
  s_mul_i32 s10, s69, 5632
  s_add_u32 s10, s10, s26
  buffer_load_dwordx4 v[66:69], v27, s[52:55], s10 offen sc1
  s_add_u32 s10, s10, 5632
  buffer_load_dwordx4 v[70:73], v27, s[52:55], s10 offen sc1
  s_add_u32 s10, s10, 5632
  buffer_load_dwordx4 v[74:77], v27, s[52:55], s10 offen sc1
  s_add_u32 s10, s10, 5632
  buffer_load_dwordx4 v[78:81], v27, s[52:55], s10 offen sc1
  s_add_u32 s69, s69, 4
  s_and_b32 s69, s69, 15
  s_mul_i32 s10, s69, 5632
  s_add_u32 s10, s10, s26
  buffer_load_dwordx4 v[82:85], v27, s[52:55], s10 offen sc1
  s_add_u32 s10, s10, 5632
  buffer_load_dwordx4 v[86:89], v27, s[52:55], s10 offen sc1
  s_add_u32 s10, s10, 5632
  buffer_load_dwordx4 v[90:93], v27, s[52:55], s10 offen sc1
  s_add_u32 s10, s10, 5632
  buffer_load_dwordx4 v[94:97], v27, s[52:55], s10 offen sc1
  s_add_u32 s69, s69, 4
  s_and_b32 s69, s69, 15
  s_mul_i32 s10, s69, 5632
  s_add_u32 s10, s10, s26
  buffer_load_dwordx4 v[98:101], v27, s[52:55], s10 offen sc1
  s_add_u32 s10, s10, 5632
  buffer_load_dwordx4 v[102:105], v27, s[52:55], s10 offen sc1
  s_add_u32 s10, s10, 5632
  buffer_load_dwordx4 v[106:109], v27, s[52:55], s10 offen sc1
  s_add_u32 s10, s10, 5632
  buffer_load_dwordx4 v[110:113], v27, s[52:55], s10 offen sc1
  s_add_u32 s69, s69, 4
  s_and_b32 s69, s69, 15
  s_mul_i32 s10, s69, 5632
  s_add_u32 s10, s10, s26
  buffer_load_dwordx4 v[114:117], v27, s[52:55], s10 offen sc1
  s_add_u32 s10, s10, 5632
  buffer_load_dwordx4 v[118:121], v27, s[52:55], s10 offen sc1
  s_add_u32 s10, s10, 5632
  buffer_load_dwordx4 v[122:125], v27, s[52:55], s10 offen sc1
  s_add_u32 s10, s10, 5632
  buffer_load_dwordx4 v[126:129], v27, s[52:55], s10 offen sc1
  s_add_u32 m0, s68, 119808
  s_nop 0
  buffer_load_dwordx4 v10, s[44:47], s67 offen offset:0 lds
  buffer_load_dwordx4 v11, s[44:47], s67 offen offset:1024 lds
  s_mov_b64 exec, 0xffff
  buffer_load_dwordx4 v12, s[44:47], s67 offen offset:2048 lds
  s_mov_b64 exec, -1
  s_add_u32 s12, s12, 1
  s_cmp_eq_u32 s12, 8
  s_cselect_b32 s14, 663552, 0
  s_add_u32 s67, s67, 82944
  s_sub_u32 s67, s67, s14
  s_add_u32 m0, s68, 129024
  s_nop 0
  buffer_load_dwordx4 v10, s[44:47], s67 offen offset:0 lds
  buffer_load_dwordx4 v11, s[44:47], s67 offen offset:1024 lds
  s_mov_b64 exec, 0xffff
  buffer_load_dwordx4 v12, s[44:47], s67 offen offset:2048 lds
  s_mov_b64 exec, -1
  s_add_u32 s12, s12, 1
  s_cmp_eq_u32 s12, 8
  s_cselect_b32 s14, 663552, 0
  s_add_u32 s67, s67, 82944
  s_sub_u32 s67, s67, s14
  s_waitcnt vmcnt(21)
  v_mfma_f32_16x16x32_bf16 v[240:243], v[36:39], v[64:67], 0
  s_waitcnt vmcnt(20)
  v_mfma_f32_16x16x32_bf16 v[244:247], v[36:39], v[68:71], 0
  s_waitcnt vmcnt(19)
  v_mfma_f32_16x16x32_bf16 v[240:243], v[36:39], v[72:75], v[240:243]
  s_waitcnt vmcnt(18)
  v_mfma_f32_16x16x32_bf16 v[244:247], v[36:39], v[76:79], v[244:247]
  s_waitcnt vmcnt(17)
  v_mfma_f32_16x16x32_bf16 v[240:243], v[36:39], v[80:83], v[240:243]
  s_waitcnt vmcnt(16)
  v_mfma_f32_16x16x32_bf16 v[244:247], v[36:39], v[84:87], v[244:247]
  s_waitcnt vmcnt(15)
  v_mfma_f32_16x16x32_bf16 v[240:243], v[36:39], v[88:91], v[240:243]
  s_waitcnt vmcnt(14)
  v_mfma_f32_16x16x32_bf16 v[244:247], v[36:39], v[92:95], v[244:247]
  s_waitcnt vmcnt(13)
  v_mfma_f32_16x16x32_bf16 v[240:243], v[36:39], v[96:99], v[240:243]
  s_waitcnt vmcnt(12)
  v_mfma_f32_16x16x32_bf16 v[244:247], v[36:39], v[100:103], v[244:247]
  s_waitcnt vmcnt(11)
  v_mfma_f32_16x16x32_bf16 v[240:243], v[36:39], v[104:107], v[240:243]
  s_waitcnt vmcnt(10)
  v_mfma_f32_16x16x32_bf16 v[244:247], v[36:39], v[108:111], v[244:247]
  s_waitcnt vmcnt(9)
  v_mfma_f32_16x16x32_bf16 v[240:243], v[36:39], v[112:115], v[240:243]
  s_waitcnt vmcnt(8)
  v_mfma_f32_16x16x32_bf16 v[244:247], v[36:39], v[116:119], v[244:247]
  s_waitcnt vmcnt(7)
  v_mfma_f32_16x16x32_bf16 v[240:243], v[36:39], v[120:123], v[240:243]
  s_waitcnt vmcnt(6)
  v_mfma_f32_16x16x32_bf16 v[244:247], v[36:39], v[124:127], v[244:247]
  v_mfma_f32_16x16x32_bf16 v[240:243], v[36:39], v[128:131], v[240:243]
  s_nop 7
  v_cmp_u_f32 vcc, v240, v244
  s_nop 0
  s_cbranch_vccnz L_gA
L_g_okA:
  v_cvt_pk_bf16_f32 v64, v240, v241
  v_cvt_pk_bf16_f32 v65, v242, v243
  v_cvt_pk_bf16_f32 v66, v244, v245
  v_cvt_pk_bf16_f32 v67, v246, v247
  s_mov_b64 exec, s[16:17]
  ds_write_b128 v29, v[64:67] offset:0
  s_mov_b64 exec, -1
  buffer_load_dword v31, v32, s[52:55], s11 offen sc1
  s_waitcnt lgkmcnt(0)
  s_barrier
  s_add_u32 m0, s68, 0
  s_nop 0
  buffer_load_dwordx4 v10, s[44:47], s67 offen offset:0 lds
  buffer_load_dwordx4 v11, s[44:47], s67 offen offset:1024 lds
  s_mov_b64 exec, 0xffff
  buffer_load_dwordx4 v12, s[44:47], s67 offen offset:2048 lds
  s_mov_b64 exec, -1
  s_add_u32 s12, s12, 1
  s_cmp_eq_u32 s12, 8
  s_cselect_b32 s14, 663552, 0
  s_add_u32 s67, s67, 82944
  s_sub_u32 s67, s67, s14
  s_add_u32 m0, s68, 9216
  s_nop 0
  buffer_load_dwordx4 v10, s[44:47], s67 offen offset:0 lds
  buffer_load_dwordx4 v11, s[44:47], s67 offen offset:1024 lds
  s_mov_b64 exec, 0xffff
  buffer_load_dwordx4 v12, s[44:47], s67 offen offset:2048 lds
  s_mov_b64 exec, -1
  s_add_u32 s12, s12, 1
  s_cmp_eq_u32 s12, 8
  s_cselect_b32 s14, 663552, 0
  s_add_u32 s67, s67, 82944
  s_sub_u32 s67, s67, s14
  s_and_b32 s14, s8, 1
  s_mul_i32 s67, s14, 144
  s_and_b32 s14, s8, 2
  s_mul_i32 s14, s14, 18
  s_add_u32 s67, s67, s14
  s_add_u32 s67, s67, 16
  s_mul_i32 s67, s67, 1152
  s_mul_i32 s14, s6, 144
  s_add_u32 s67, s67, s14
  s_add_u32 m0, s68, 18432
  s_nop 0
  buffer_load_dwordx4 v13, s[44:47], s67 offen offset:0 lds
  buffer_load_dwordx4 v14, s[44:47], s67 offen offset:1024 lds
  s_mov_b64 exec, 0xffff
  buffer_load_dwordx4 v15, s[44:47], s67 offen offset:2048 lds
  s_mov_b64 exec, -1
  s_add_u32 s3, s6, 1
  s_and_b32 s3, s3, 7
  s_lshl_b32 s3, s3, 7
  s_add_u32 s37, s3, s28
  s_add_u32 s3, s6, 2
  s_and_b32 s3, s3, 7
  s_lshl_b32 s3, s3, 7
  s_add_u32 s38, s3, s28
  s_add_u32 s3, s6, 3
  s_and_b32 s3, s3, 7
  s_lshl_b32 s3, s3, 7
  s_add_u32 s39, s3, s28
  s_add_u32 s3, s6, 4
  s_and_b32 s3, s3, 7
  s_lshl_b32 s3, s3, 7
  s_add_u32 s40, s3, s28
  s_add_u32 s3, s6, 5
  s_and_b32 s3, s3, 7
  s_lshl_b32 s3, s3, 7
  s_add_u32 s41, s3, s28
  s_add_u32 s3, s6, 6
  s_and_b32 s3, s3, 7
  s_lshl_b32 s3, s3, 7
  s_add_u32 s42, s3, s28
  s_add_u32 s3, s6, 7
  s_and_b32 s3, s3, 7
  s_lshl_b32 s3, s3, 7
  s_add_u32 s43, s3, s28
  s_add_u32 s36, s28, 1024
  s_add_u32 s3, s64, 28672
  v_bfe_u32 v3, v0, 3, 2
  v_lshl_add_u32 v3, v3, 2, v18
  v_add_u32 v2, s3, v3
  v_add_u32 v3, 54272, v2
  s_setprio 2
  s_waitcnt vmcnt(9)
  v_cmp_ne_u32 vcc, 1, v31
  s_nop 0
  s_cbranch_vccnz L_ic2A
L_ic_ok2A:
  s_barrier
  s_add_u32 m0, s64, 28672
  s_add_u32 s13, s37, 17408
  buffer_load_dwordx4 v255, s[56:59], s37 offen sc1 lds
  buffer_load_dwordx4 v255, s[56:59], s13 offen offset:1024 sc1 lds
  s_add_u32 s13, s13, 17408
  buffer_load_dwordx4 v255, s[56:59], s13 offen offset:2048 sc1 lds
  s_add_u32 s13, s13, 17408
  buffer_load_dwordx4 v255, s[56:59], s13 offen offset:3072 sc1 lds
  s_add_u32 m0, s64, 45056
  s_add_u32 s13, s38, 17408
  buffer_load_dwordx4 v255, s[56:59], s38 offen sc1 lds
  buffer_load_dwordx4 v255, s[56:59], s13 offen offset:1024 sc1 lds
  s_add_u32 s13, s13, 17408
  buffer_load_dwordx4 v255, s[56:59], s13 offen offset:2048 sc1 lds
  s_add_u32 s13, s13, 17408
  buffer_load_dwordx4 v255, s[56:59], s13 offen offset:3072 sc1 lds
  s_waitcnt vmcnt(4)
  ds_read2st64_b32 v[64:65], v2 offset0:0 offset1:4
  ds_read2st64_b32 v[66:67], v2 offset0:8 offset1:12
  s_waitcnt lgkmcnt(0)
  v_max3_u32 v60, v64, v65, v66
  v_max_u32 v60, v60, v67
  v_cmp_eq_u32 vcc, -1, v60
  s_nop 0
  s_cbranch_vccnz L_o1A
L_o_ok1A:
  s_barrier
  s_add_u32 m0, s64, 61440
  s_add_u32 s13, s39, 17408
  buffer_load_dwordx4 v255, s[56:59], s39 offen sc1 lds
  buffer_load_dwordx4 v255, s[56:59], s13 offen offset:1024 sc1 lds
  s_add_u32 s13, s13, 17408
  buffer_load_dwordx4 v255, s[56:59], s13 offen offset:2048 sc1 lds
  s_add_u32 s13, s13, 17408
  buffer_load_dwordx4 v255, s[56:59], s13 offen offset:3072 sc1 lds
  s_waitcnt vmcnt(4)
  ds_read2st64_b32 v[64:65], v2 offset0:64 offset1:68
  ds_read2st64_b32 v[66:67], v2 offset0:72 offset1:76
  s_add_u32 m0, s64, 139264
  s_add_u32 s13, s40, 17408
  buffer_load_dwordx4 v255, s[56:59], s40 offen sc1 lds
  buffer_load_dwordx4 v255, s[56:59], s13 offen offset:1024 sc1 lds
  s_add_u32 s13, s13, 17408
  buffer_load_dwordx4 v255, s[56:59], s13 offen offset:2048 sc1 lds
  s_add_u32 s13, s13, 17408
  buffer_load_dwordx4 v255, s[56:59], s13 offen offset:3072 sc1 lds
  s_waitcnt lgkmcnt(0)
  v_max3_u32 v60, v64, v65, v66
  v_max_u32 v60, v60, v67
  v_cmp_eq_u32 vcc, -1, v60
  s_nop 0
  s_cbranch_vccnz L_o2A
L_o_ok2A:
  s_barrier
  s_waitcnt vmcnt(4)
  ds_read2st64_b32 v[64:65], v2 offset0:128 offset1:132
  ds_read2st64_b32 v[66:67], v2 offset0:136 offset1:140
  s_add_u32 m0, s64, 82944
  s_add_u32 s13, s41, 17408
  buffer_load_dwordx4 v255, s[56:59], s41 offen sc1 lds
  buffer_load_dwordx4 v255, s[56:59], s13 offen offset:1024 sc1 lds
  s_add_u32 s13, s13, 17408
  buffer_load_dwordx4 v255, s[56:59], s13 offen offset:2048 sc1 lds
  s_add_u32 s13, s13, 17408
  buffer_load_dwordx4 v255, s[56:59], s13 offen offset:3072 sc1 lds
  s_waitcnt lgkmcnt(0)
  v_max3_u32 v60, v64, v65, v66
  v_max_u32 v60, v60, v67
  v_cmp_eq_u32 vcc, -1, v60
  s_nop 0
  s_cbranch_vccnz L_o3A
L_o_ok3A:
  s_barrier
  s_waitcnt vmcnt(4)
  ds_read2st64_b32 v[64:65], v3 offset0:220 offset1:224
  ds_read2st64_b32 v[66:67], v3 offset0:228 offset1:232
  s_add_u32 m0, s64, 99328
  s_add_u32 s13, s42, 17408
  buffer_load_dwordx4 v255, s[56:59], s42 offen sc1 lds
  buffer_load_dwordx4 v255, s[56:59], s13 offen offset:1024 sc1 lds
  s_add_u32 s13, s13, 17408
  buffer_load_dwordx4 v255, s[56:59], s13 offen offset:2048 sc1 lds
  s_add_u32 s13, s13, 17408
  buffer_load_dwordx4 v255, s[56:59], s13 offen offset:3072 sc1 lds
  s_waitcnt lgkmcnt(0)
  v_max3_u32 v60, v64, v65, v66
  v_max_u32 v60, v60, v67
  v_cmp_eq_u32 vcc, -1, v60
  s_nop 0
  s_cbranch_vccnz L_o4A
L_o_ok4A:
  s_barrier
  s_waitcnt vmcnt(4)
  ds_read2st64_b32 v[64:65], v3 offset0:0 offset1:4
  ds_read2st64_b32 v[66:67], v3 offset0:8 offset1:12
  s_add_u32 m0, s64, 28672
  s_add_u32 s13, s43, 17408
  buffer_load_dwordx4 v255, s[56:59], s43 offen sc1 lds
  buffer_load_dwordx4 v255, s[56:59], s13 offen offset:1024 sc1 lds
  s_add_u32 s13, s13, 17408
  buffer_load_dwordx4 v255, s[56:59], s13 offen offset:2048 sc1 lds
  s_add_u32 s13, s13, 17408
  buffer_load_dwordx4 v255, s[56:59], s13 offen offset:3072 sc1 lds
  s_waitcnt lgkmcnt(0)
  v_max3_u32 v60, v64, v65, v66
  v_max_u32 v60, v60, v67
  v_cmp_eq_u32 vcc, -1, v60
  s_nop 0
  s_cbranch_vccnz L_o5A
L_o_ok5A:
  s_barrier
  s_waitcnt vmcnt(4)
  ds_read2st64_b32 v[64:65], v3 offset0:64 offset1:68
  ds_read2st64_b32 v[66:67], v3 offset0:72 offset1:76
  s_add_u32 m0, s64, 45056
  s_add_u32 s13, s36, 17408
  buffer_load_dwordx4 v255, s[56:59], s36 offen sc1 lds
  buffer_load_dwordx4 v255, s[56:59], s13 offen offset:1024 sc1 lds
  s_add_u32 s13, s13, 17408
  buffer_load_dwordx4 v255, s[56:59], s13 offen offset:2048 sc1 lds
  s_add_u32 s13, s13, 17408
  buffer_load_dwordx4 v255, s[56:59], s13 offen offset:3072 sc1 lds
  s_waitcnt lgkmcnt(0)
  v_max3_u32 v60, v64, v65, v66
  v_max_u32 v60, v60, v67
  v_cmp_eq_u32 vcc, -1, v60
  s_nop 0
  s_cbranch_vccnz L_o6A
L_o_ok6A:
  s_barrier
  s_waitcnt vmcnt(4)
  ds_read2st64_b32 v[64:65], v2 offset0:0 offset1:4
  ds_read2st64_b32 v[66:67], v2 offset0:8 offset1:12
  s_waitcnt lgkmcnt(0)
  v_max3_u32 v60, v64, v65, v66
  v_max_u32 v60, v60, v67
  v_cmp_eq_u32 vcc, -1, v60
  s_nop 0
  s_cbranch_vccnz L_o7A
L_o_ok7A:
  s_barrier
  s_waitcnt vmcnt(0)
  ds_read2st64_b32 v[64:65], v2 offset0:64 offset1:68
  ds_read2st64_b32 v[66:67], v2 offset0:72 offset1:76
  s_waitcnt lgkmcnt(0)
  v_max3_u32 v60, v64, v65, v66
  v_max_u32 v60, v60, v67
  v_cmp_eq_u32 vcc, -1, v60
  s_nop 0
  s_cbranch_vccnz L_o8A
L_o_ok8A:
  v_mov_b32 v1, 1
  s_cmp_eq_u32 s79, 0
  s_cbranch_scc1 L_df3A
  s_mov_b64 exec, 1
  buffer_store_dword v1, v18, s[52:55], s66 offen offset:16
  s_mov_b64 exec, -1
L_d_okf3A:
  s_barrier
  s_waitcnt vmcnt(0)
  buffer_load_dword v31, v32, s[52:55], s11 offen offset:16 sc1
  s_waitcnt vmcnt(0)
  v_cmp_ne_u32 vcc, 1, v31
  s_nop 0
  s_cbranch_vccnz L_ic3A
L_ic_ok3A:
  s_barrier
  s_endpgm
  s_nop 0
L_end:
  s_endpgm
L_do0B:
  s_nop 4
  buffer_store_dwordx4 v[64:67], v7, s[56:59], s29 offen sc1
  s_nop 1
  s_branch L_d_oko0B
L_do1B:
  s_nop 4
  buffer_store_dwordx4 v[68:71], v7, s[56:59], s14 offen sc1
  s_nop 1
  s_branch L_d_oko1B
L_dorB:
  s_nop 4
  s_mov_b64 exec, 0xffff
  buffer_store_dwordx4 v[56:59], v7, s[56:59], s30 offen sc1
  buffer_store_dwordx4 v[60:63], v7, s[56:59], s15 offen sc1
  s_mov_b64 exec, -1
  s_nop 1
  s_branch L_d_okorB
L_ic1B:
  s_sleep 8
  buffer_load_dword v31, v32, s[60:63], 0 offen offset:128 sc1
  s_waitcnt vmcnt(0)
  v_and_b32 v47, 0x80808080, v31
  v_cmp_ne_u32 vcc, 0x80808080, v47
  s_add_u32 s31, s31, 0x1100
  s_bitcmp1_b32 s31, 30
  s_cbranch_scc1 L_ic_ok1B
  s_nop 4
  s_cbranch_vccnz L_ic1B
  s_branch L_ic_ok1B
L_dpfB:
  s_nop 4
  buffer_store_dwordx4 v[48:51], v255, s[56:59], s29 offen sc1
  buffer_store_dwordx4 v[48:51], v255, s[56:59], s13 offen sc1
  buffer_store_dwordx4 v[48:51], v255, s[56:59], s14 offen sc1
  buffer_store_dwordx4 v[48:51], v255, s[56:59], s15 offen sc1
  s_mov_b64 exec, 0xffff
  buffer_store_dwordx4 v[48:51], v255, s[56:59], s30 offen sc1
  buffer_store_dwordx4 v[48:51], v255, s[56:59], s3 offen sc1
  s_mov_b64 exec, -1
  s_nop 1
  s_branch L_d_okpfB
L_df2B:
  s_nop 4
  s_mov_b64 exec, 1
  buffer_store_dword v1, v18, s[52:55], s66 offen sc1
  s_mov_b64 exec, -1
  s_nop 1
  s_branch L_d_okf2B
L_gB:
  v_max3_u32 v1, v64, v65, v66
  v_max3_u32 v1, v67, v68, v1
  v_max3_u32 v1, v69, v70, v1
  v_max3_u32 v1, v71, v72, v1
  v_max3_u32 v1, v73, v74, v1
  v_max3_u32 v1, v75, v76, v1
  v_max3_u32 v1, v77, v78, v1
  v_max3_u32 v1, v79, v80, v1
  v_max3_u32 v1, v81, v82, v1
  v_max3_u32 v1, v83, v84, v1
  v_max3_u32 v1, v85, v86, v1
  v_max3_u32 v1, v87, v88, v1
  v_max3_u32 v1, v89, v90, v1
  v_max3_u32 v1, v91, v92, v1
  v_max3_u32 v1, v93, v94, v1
  v_max3_u32 v1, v95, v96, v1
  v_max3_u32 v1, v97, v98, v1
  v_max3_u32 v1, v99, v100, v1
  v_max3_u32 v1, v101, v102, v1
  v_max3_u32 v1, v103, v104, v1
  v_max3_u32 v1, v105, v106, v1
  v_max3_u32 v1, v107, v108, v1
  v_max3_u32 v1, v109, v110, v1
  v_max3_u32 v1, v111, v112, v1
  v_max3_u32 v1, v113, v114, v1
  v_max3_u32 v1, v115, v116, v1
  v_max3_u32 v1, v117, v118, v1
  v_max3_u32 v1, v119, v120, v1
  v_max3_u32 v1, v121, v122, v1
  v_max3_u32 v1, v123, v124, v1
  v_max3_u32 v1, v125, v126, v1
  v_max3_u32 v1, v127, v128, v1
  v_max3_u32 v1, v129, v130, v1
  v_max3_u32 v1, v131, v132, v1
  v_max3_u32 v1, v133, v134, v1
  v_max3_u32 v1, v135, v136, v1
  v_max3_u32 v1, v137, v138, v1
  v_max3_u32 v1, v139, v140, v1
  v_max3_u32 v1, v141, v142, v1
  v_max3_u32 v1, v143, v144, v1
  v_max3_u32 v1, v145, v146, v1
  v_max3_u32 v1, v147, v148, v1
  v_max3_u32 v1, v149, v150, v1
  v_max3_u32 v1, v151, v152, v1
  v_max3_u32 v1, v153, v154, v1
  v_max3_u32 v1, v155, v156, v1
  v_max3_u32 v1, v157, v158, v1
  v_max3_u32 v1, v159, v160, v1
  v_max3_u32 v1, v161, v162, v1
  v_max3_u32 v1, v163, v164, v1
  v_max3_u32 v1, v165, v166, v1
  v_max3_u32 v1, v167, v168, v1
  v_max3_u32 v1, v169, v170, v1
  v_max3_u32 v1, v171, v172, v1
  v_max3_u32 v1, v173, v174, v1
  v_max3_u32 v1, v175, v176, v1
  v_max3_u32 v1, v177, v178, v1
  v_max3_u32 v1, v179, v180, v1
  v_max3_u32 v1, v181, v182, v1
  v_max3_u32 v1, v183, v184, v1
  v_max3_u32 v1, v185, v186, v1
  v_max3_u32 v1, v187, v188, v1
  v_max3_u32 v1, v189, v190, v1
  v_max3_u32 v1, v191, v192, v1
  v_max3_u32 v1, v193, v194, v1
  v_max3_u32 v1, v195, v196, v1
  v_max3_u32 v1, v197, v198, v1
  v_cmp_eq_u32 vcc, -1, v1
  s_add_u32 s31, s31, 0x2010
  s_bitcmp1_b32 s31, 30
  s_cbranch_scc1 L_g_sumB
  s_nop 4
  s_cbranch_vccz L_g_sumB
  s_waitcnt vmcnt(0)
s_and_b32 s69, s5, 3
s_lshl_b32 s69, s69, 2
s_mul_i32 s10, s69, 5632
s_add_u32 s10, s10, s26
buffer_load_dwordx4 v[66:69], v27, s[52:55], s10 offen sc1
buffer_load_dwordx4 v[134:137], v28, s[52:55], s10 offen sc1
s_add_u32 s10, s10, 5632
buffer_load_dwordx4 v[70:73], v27, s[52:55], s10 offen sc1
buffer_load_dwordx4 v[138:141], v28, s[52:55], s10 offen sc1
s_add_u32 s10, s10, 5632
buffer_load_dwordx4 v[74:77], v27, s[52:55], s10 offen sc1
buffer_load_dwordx4 v[142:145], v28, s[52:55], s10 offen sc1
s_add_u32 s10, s10, 5632
buffer_load_dwordx4 v[78:81], v27, s[52:55], s10 offen sc1
buffer_load_dwordx4 v[146:149], v28, s[52:55], s10 offen sc1
s_add_u32 s69, s69, 4
s_and_b32 s69, s69, 15
s_mul_i32 s10, s69, 5632
s_add_u32 s10, s10, s26
buffer_load_dwordx4 v[82:85], v27, s[52:55], s10 offen sc1
buffer_load_dwordx4 v[150:153], v28, s[52:55], s10 offen sc1
s_add_u32 s10, s10, 5632
buffer_load_dwordx4 v[86:89], v27, s[52:55], s10 offen sc1
buffer_load_dwordx4 v[154:157], v28, s[52:55], s10 offen sc1
s_add_u32 s10, s10, 5632
buffer_load_dwordx4 v[90:93], v27, s[52:55], s10 offen sc1
buffer_load_dwordx4 v[158:161], v28, s[52:55], s10 offen sc1
s_add_u32 s10, s10, 5632
buffer_load_dwordx4 v[94:97], v27, s[52:55], s10 offen sc1
buffer_load_dwordx4 v[162:165], v28, s[52:55], s10 offen sc1
s_add_u32 s69, s69, 4
s_and_b32 s69, s69, 15
s_mul_i32 s10, s69, 5632
s_add_u32 s10, s10, s26
buffer_load_dwordx4 v[98:101], v27, s[52:55], s10 offen sc1
buffer_load_dwordx4 v[166:169], v28, s[52:55], s10 offen sc1
s_add_u32 s10, s10, 5632
buffer_load_dwordx4 v[102:105], v27, s[52:55], s10 offen sc1
buffer_load_dwordx4 v[170:173], v28, s[52:55], s10 offen sc1
s_add_u32 s10, s10, 5632
buffer_load_dwordx4 v[106:109], v27, s[52:55], s10 offen sc1
buffer_load_dwordx4 v[174:177], v28, s[52:55], s10 offen sc1
s_add_u32 s10, s10, 5632
buffer_load_dwordx4 v[110:113], v27, s[52:55], s10 offen sc1
buffer_load_dwordx4 v[178:181], v28, s[52:55], s10 offen sc1
s_add_u32 s69, s69, 4
s_and_b32 s69, s69, 15
s_mul_i32 s10, s69, 5632
s_add_u32 s10, s10, s26
buffer_load_dwordx4 v[114:117], v27, s[52:55], s10 offen sc1
buffer_load_dwordx4 v[182:185], v28, s[52:55], s10 offen sc1
s_add_u32 s10, s10, 5632
buffer_load_dwordx4 v[118:121], v27, s[52:55], s10 offen sc1
buffer_load_dwordx4 v[186:189], v28, s[52:55], s10 offen sc1
s_add_u32 s10, s10, 5632
buffer_load_dwordx4 v[122:125], v27, s[52:55], s10 offen sc1
buffer_load_dwordx4 v[190:193], v28, s[52:55], s10 offen sc1
s_add_u32 s10, s10, 5632
buffer_load_dwordx4 v[126:129], v27, s[52:55], s10 offen sc1
buffer_load_dwordx4 v[194:197], v28, s[52:55], s10 offen sc1
  s_waitcnt vmcnt(0)
  s_branch L_gB
L_g_sumB:
  v_mfma_f32_16x16x32_bf16 v[240:243], v[36:39], v[64:67], 0
  v_mfma_f32_16x16x32_bf16 v[50:53], v[36:39], v[132:135], 0
  v_mfma_f32_16x16x32_bf16 v[244:247], v[36:39], v[68:71], 0
  v_mfma_f32_16x16x32_bf16 v[54:57], v[36:39], v[136:139], 0
  v_mfma_f32_16x16x32_bf16 v[240:243], v[36:39], v[72:75], v[240:243]
  v_mfma_f32_16x16x32_bf16 v[50:53], v[36:39], v[140:143], v[50:53]
  v_mfma_f32_16x16x32_bf16 v[244:247], v[36:39], v[76:79], v[244:247]
  v_mfma_f32_16x16x32_bf16 v[54:57], v[36:39], v[144:147], v[54:57]
  v_mfma_f32_16x16x32_bf16 v[240:243], v[36:39], v[80:83], v[240:243]
  v_mfma_f32_16x16x32_bf16 v[50:53], v[36:39], v[148:151], v[50:53]
  v_mfma_f32_16x16x32_bf16 v[244:247], v[36:39], v[84:87], v[244:247]
  v_mfma_f32_16x16x32_bf16 v[54:57], v[36:39], v[152:155], v[54:57]
  v_mfma_f32_16x16x32_bf16 v[240:243], v[36:39], v[88:91], v[240:243]
  v_mfma_f32_16x16x32_bf16 v[50:53], v[36:39], v[156:159], v[50:53]
  v_mfma_f32_16x16x32_bf16 v[244:247], v[36:39], v[92:95], v[244:247]
  v_mfma_f32_16x16x32_bf16 v[54:57], v[36:39], v[160:163], v[54:57]
  v_mfma_f32_16x16x32_bf16 v[240:243], v[36:39], v[96:99], v[240:243]
  v_mfma_f32_16x16x32_bf16 v[50:53], v[36:39], v[164:167], v[50:53]
  v_mfma_f32_16x16x32_bf16 v[244:247], v[36:39], v[100:103], v[244:247]
  v_mfma_f32_16x16x32_bf16 v[54:57], v[36:39], v[168:171], v[54:57]
  v_mfma_f32_16x16x32_bf16 v[240:243], v[36:39], v[104:107], v[240:243]
  v_mfma_f32_16x16x32_bf16 v[50:53], v[36:39], v[172:175], v[50:53]
  v_mfma_f32_16x16x32_bf16 v[244:247], v[36:39], v[108:111], v[244:247]
  v_mfma_f32_16x16x32_bf16 v[54:57], v[36:39], v[176:179], v[54:57]
  v_mfma_f32_16x16x32_bf16 v[240:243], v[36:39], v[112:115], v[240:243]
  v_mfma_f32_16x16x32_bf16 v[50:53], v[36:39], v[180:183], v[50:53]
  v_mfma_f32_16x16x32_bf16 v[244:247], v[36:39], v[116:119], v[244:247]
  v_mfma_f32_16x16x32_bf16 v[54:57], v[36:39], v[184:187], v[54:57]
  v_mfma_f32_16x16x32_bf16 v[240:243], v[36:39], v[120:123], v[240:243]
  v_mfma_f32_16x16x32_bf16 v[50:53], v[36:39], v[188:191], v[50:53]
  v_mfma_f32_16x16x32_bf16 v[244:247], v[36:39], v[124:127], v[244:247]
  v_mfma_f32_16x16x32_bf16 v[54:57], v[36:39], v[192:195], v[54:57]
  v_mfma_f32_16x16x32_bf16 v[240:243], v[36:39], v[128:131], v[240:243]
  v_mfma_f32_16x16x32_bf16 v[50:53], v[36:39], v[196:199], v[50:53]
  s_nop 15
  s_branch L_g_okB
L_dho0:
  s_nop 4
  buffer_store_dwordx4 v[96:99], v255, s[56:59], s29 offen sc1
  s_nop 1
  s_branch L_d_okho0
L_dho1:
  s_nop 4
  buffer_store_dwordx4 v[100:103], v255, s[56:59], s69 offen sc1
  s_nop 1
  s_branch L_d_okho1
L_ic2B:
  s_sleep 8
  buffer_load_dword v31, v32, s[52:55], s11 offen sc1
  s_waitcnt vmcnt(0)
  v_cmp_ne_u32 vcc, 1, v31
  s_add_u32 s31, s31, 0x1100
  s_bitcmp1_b32 s31, 30
  s_cbranch_scc1 L_ic_ok2B
  s_nop 4
  s_cbranch_vccnz L_ic2B
  s_branch L_ic_ok2B
L_o1B:
  s_add_u32 m0, s64, 28672
  s_add_u32 s13, s37, 17408
  buffer_load_dwordx4 v255, s[56:59], s37 offen sc1 lds
  buffer_load_dwordx4 v255, s[56:59], s13 offen offset:1024 sc1 lds
  s_add_u32 s13, s13, 17408
  buffer_load_dwordx4 v255, s[56:59], s13 offen offset:2048 sc1 lds
  s_add_u32 s13, s13, 17408
  buffer_load_dwordx4 v255, s[56:59], s13 offen offset:3072 sc1 lds
  s_waitcnt vmcnt(0)
  ds_read2st64_b32 v[64:65], v2 offset0:0 offset1:4
  ds_read2st64_b32 v[66:67], v2 offset0:8 offset1:12
  s_waitcnt lgkmcnt(0)
  v_max3_u32 v60, v64, v65, v66
  v_max_u32 v60, v60, v67
  v_cmp_eq_u32 vcc, -1, v60
  s_add_u32 s31, s31, 0x1001
  s_bitcmp1_b32 s31, 30
  s_cbranch_scc1 L_o_ok1B
  s_nop 4
  s_cbranch_vccnz L_o1B
  s_branch L_o_ok1B
L_o2B:
  s_add_u32 m0, s64, 45056
  s_add_u32 s13, s38, 17408
  buffer_load_dwordx4 v255, s[56:59], s38 offen sc1 lds
  buffer_load_dwordx4 v255, s[56:59], s13 offen offset:1024 sc1 lds
  s_add_u32 s13, s13, 17408
  buffer_load_dwordx4 v255, s[56:59], s13 offen offset:2048 sc1 lds
  s_add_u32 s13, s13, 17408
  buffer_load_dwordx4 v255, s[56:59], s13 offen offset:3072 sc1 lds
  s_waitcnt vmcnt(0)
  ds_read2st64_b32 v[64:65], v2 offset0:64 offset1:68
  ds_read2st64_b32 v[66:67], v2 offset0:72 offset1:76
  s_waitcnt lgkmcnt(0)
  v_max3_u32 v60, v64, v65, v66
  v_max_u32 v60, v60, v67
  v_cmp_eq_u32 vcc, -1, v60
  s_add_u32 s31, s31, 0x1001
  s_bitcmp1_b32 s31, 30
  s_cbranch_scc1 L_o_ok2B
  s_nop 4
  s_cbranch_vccnz L_o2B
  s_branch L_o_ok2B
L_o3B:
  s_add_u32 m0, s64, 61440
  s_add_u32 s13, s39, 17408
  buffer_load_dwordx4 v255, s[56:59], s39 offen sc1 lds
  buffer_load_dwordx4 v255, s[56:59], s13 offen offset:1024 sc1 lds
  s_add_u32 s13, s13, 17408
  buffer_load_dwordx4 v255, s[56:59], s13 offen offset:2048 sc1 lds
  s_add_u32 s13, s13, 17408
  buffer_load_dwordx4 v255, s[56:59], s13 offen offset:3072 sc1 lds
  s_waitcnt vmcnt(0)
  ds_read2st64_b32 v[64:65], v2 offset0:128 offset1:132
  ds_read2st64_b32 v[66:67], v2 offset0:136 offset1:140
  s_waitcnt lgkmcnt(0)
  v_max3_u32 v60, v64, v65, v66
  v_max_u32 v60, v60, v67
  v_cmp_eq_u32 vcc, -1, v60
  s_add_u32 s31, s31, 0x1001
  s_bitcmp1_b32 s31, 30
  s_cbranch_scc1 L_o_ok3B
  s_nop 4
  s_cbranch_vccnz L_o3B
  s_branch L_o_ok3B
L_o4B:
  s_add_u32 m0, s64, 139264
  s_add_u32 s13, s40, 17408
  buffer_load_dwordx4 v255, s[56:59], s40 offen sc1 lds
  buffer_load_dwordx4 v255, s[56:59], s13 offen offset:1024 sc1 lds
  s_add_u32 s13, s13, 17408
  buffer_load_dwordx4 v255, s[56:59], s13 offen offset:2048 sc1 lds
  s_add_u32 s13, s13, 17408
  buffer_load_dwordx4 v255, s[56:59], s13 offen offset:3072 sc1 lds
  s_waitcnt vmcnt(0)
  ds_read2st64_b32 v[64:65], v3 offset0:220 offset1:224
  ds_read2st64_b32 v[66:67], v3 offset0:228 offset1:232
  s_waitcnt lgkmcnt(0)
  v_max3_u32 v60, v64, v65, v66
  v_max_u32 v60, v60, v67
  v_cmp_eq_u32 vcc, -1, v60
  s_add_u32 s31, s31, 0x1001
  s_bitcmp1_b32 s31, 30
  s_cbranch_scc1 L_o_ok4B
  s_nop 4
  s_cbranch_vccnz L_o4B
  s_branch L_o_ok4B
L_o5B:
  s_add_u32 m0, s64, 82944
  s_add_u32 s13, s41, 17408
  buffer_load_dwordx4 v255, s[56:59], s41 offen sc1 lds
  buffer_load_dwordx4 v255, s[56:59], s13 offen offset:1024 sc1 lds
  s_add_u32 s13, s13, 17408
  buffer_load_dwordx4 v255, s[56:59], s13 offen offset:2048 sc1 lds
  s_add_u32 s13, s13, 17408
  buffer_load_dwordx4 v255, s[56:59], s13 offen offset:3072 sc1 lds
  s_waitcnt vmcnt(0)
  ds_read2st64_b32 v[64:65], v3 offset0:0 offset1:4
  ds_read2st64_b32 v[66:67], v3 offset0:8 offset1:12
  s_waitcnt lgkmcnt(0)
  v_max3_u32 v60, v64, v65, v66
  v_max_u32 v60, v60, v67
  v_cmp_eq_u32 vcc, -1, v60
  s_add_u32 s31, s31, 0x1001
  s_bitcmp1_b32 s31, 30
  s_cbranch_scc1 L_o_ok5B
  s_nop 4
  s_cbranch_vccnz L_o5B
  s_branch L_o_ok5B
L_o6B:
  s_add_u32 m0, s64, 99328
  s_add_u32 s13, s42, 17408
  buffer_load_dwordx4 v255, s[56:59], s42 offen sc1 lds
  buffer_load_dwordx4 v255, s[56:59], s13 offen offset:1024 sc1 lds
  s_add_u32 s13, s13, 17408
  buffer_load_dwordx4 v255, s[56:59], s13 offen offset:2048 sc1 lds
  s_add_u32 s13, s13, 17408
  buffer_load_dwordx4 v255, s[56:59], s13 offen offset:3072 sc1 lds
  s_waitcnt vmcnt(0)
  ds_read2st64_b32 v[64:65], v3 offset0:64 offset1:68
  ds_read2st64_b32 v[66:67], v3 offset0:72 offset1:76
  s_waitcnt lgkmcnt(0)
  v_max3_u32 v60, v64, v65, v66
  v_max_u32 v60, v60, v67
  v_cmp_eq_u32 vcc, -1, v60
  s_add_u32 s31, s31, 0x1001
  s_bitcmp1_b32 s31, 30
  s_cbranch_scc1 L_o_ok6B
  s_nop 4
  s_cbranch_vccnz L_o6B
  s_branch L_o_ok6B
L_o7B:
  s_add_u32 m0, s64, 28672
  s_add_u32 s13, s43, 17408
  buffer_load_dwordx4 v255, s[56:59], s43 offen sc1 lds
  buffer_load_dwordx4 v255, s[56:59], s13 offen offset:1024 sc1 lds
  s_add_u32 s13, s13, 17408
  buffer_load_dwordx4 v255, s[56:59], s13 offen offset:2048 sc1 lds
  s_add_u32 s13, s13, 17408
  buffer_load_dwordx4 v255, s[56:59], s13 offen offset:3072 sc1 lds
  s_waitcnt vmcnt(0)
  ds_read2st64_b32 v[64:65], v2 offset0:0 offset1:4
  ds_read2st64_b32 v[66:67], v2 offset0:8 offset1:12
  s_waitcnt lgkmcnt(0)
  v_max3_u32 v60, v64, v65, v66
  v_max_u32 v60, v60, v67
  v_cmp_eq_u32 vcc, -1, v60
  s_add_u32 s31, s31, 0x1001
  s_bitcmp1_b32 s31, 30
  s_cbranch_scc1 L_o_ok7B
  s_nop 4
  s_cbranch_vccnz L_o7B
  s_branch L_o_ok7B
L_o8B:
  s_add_u32 m0, s64, 45056
  s_add_u32 s13, s36, 17408
  buffer_load_dwordx4 v255, s[56:59], s36 offen sc1 lds
  buffer_load_dwordx4 v255, s[56:59], s13 offen offset:1024 sc1 lds
  s_add_u32 s13, s13, 17408
  buffer_load_dwordx4 v255, s[56:59], s13 offen offset:2048 sc1 lds
  s_add_u32 s13, s13, 17408
  buffer_load_dwordx4 v255, s[56:59], s13 offen offset:3072 sc1 lds
  s_waitcnt vmcnt(0)
  ds_read2st64_b32 v[64:65], v2 offset0:64 offset1:68
  ds_read2st64_b32 v[66:67], v2 offset0:72 offset1:76
  s_waitcnt lgkmcnt(0)
  v_max3_u32 v60, v64, v65, v66
  v_max_u32 v60, v60, v67
  v_cmp_eq_u32 vcc, -1, v60
  s_add_u32 s31, s31, 0x1001
  s_bitcmp1_b32 s31, 30
  s_cbranch_scc1 L_o_ok8B
  s_nop 4
  s_cbranch_vccnz L_o8B
  s_branch L_o_ok8B
L_df3B:
  s_nop 4
  s_mov_b64 exec, 1
  buffer_store_dword v1, v18, s[52:55], s66 offen offset:16 sc1
  s_mov_b64 exec, -1
  s_nop 1
  s_branch L_d_okf3B
L_ic3B:
  s_sleep 1
  buffer_load_dword v31, v32, s[52:55], s11 offen offset:16 sc1
  s_waitcnt vmcnt(0)
  v_cmp_ne_u32 vcc, 1, v31
  s_add_u32 s31, s31, 0x1100
  s_bitcmp1_b32 s31, 30
  s_cbranch_scc1 L_ic_ok3B
  s_nop 4
  s_cbranch_vccnz L_ic3B
  s_branch L_ic_ok3B
L_do0A:
  s_nop 4
  buffer_store_dwordx4 v[64:67], v7, s[56:59], s29 offen sc1
  s_nop 1
  s_branch L_d_oko0A
L_do1A:
  s_nop 4
  buffer_store_dwordx4 v[68:71], v7, s[56:59], s14 offen sc1
  s_nop 1
  s_branch L_d_oko1A
L_do2A:
  s_nop 4
  buffer_store_dwordx4 v[72:75], v7, s[56:59], s13 offen sc1
  s_nop 1
  s_branch L_d_oko2A
L_do3A:
  s_nop 4
  buffer_store_dwordx4 v[76:79], v7, s[56:59], s69 offen sc1
  s_nop 1
  s_branch L_d_oko3A
L_dorA:
  s_nop 4
  s_mov_b64 exec, 0xffff
  buffer_store_dwordx4 v[56:59], v7, s[56:59], s30 offen sc1
  buffer_store_dwordx4 v[60:63], v7, s[56:59], s15 offen sc1
  s_mov_b64 exec, -1
  s_nop 1
  s_branch L_d_okorA
L_ic1A:
  s_sleep 8
  buffer_load_dword v31, v32, s[60:63], 0 offen offset:0 sc1
  s_waitcnt vmcnt(0)
  v_and_b32 v47, 0x80808080, v31
  v_cmp_ne_u32 vcc, 0x80808080, v47
  s_add_u32 s31, s31, 0x1100
  s_bitcmp1_b32 s31, 30
  s_cbranch_scc1 L_ic_ok1A
  s_nop 4
  s_cbranch_vccnz L_ic1A
  s_branch L_ic_ok1A
L_dpfA:
  s_nop 4
  buffer_store_dwordx4 v[48:51], v255, s[56:59], s29 offen sc1
  buffer_store_dwordx4 v[48:51], v255, s[56:59], s13 offen sc1
  buffer_store_dwordx4 v[48:51], v255, s[56:59], s14 offen sc1
  buffer_store_dwordx4 v[48:51], v255, s[56:59], s15 offen sc1
  s_mov_b64 exec, 0xffff
  buffer_store_dwordx4 v[48:51], v255, s[56:59], s30 offen sc1
  buffer_store_dwordx4 v[48:51], v255, s[56:59], s3 offen sc1
  s_mov_b64 exec, -1
  s_nop 1
  s_branch L_d_okpfA
L_df2A:
  s_nop 4
  s_mov_b64 exec, 1
  buffer_store_dword v1, v18, s[52:55], s66 offen sc1
  s_mov_b64 exec, -1
  s_nop 1
  s_branch L_d_okf2A
L_gA:
  v_max3_u32 v1, v64, v65, v66
  v_max3_u32 v1, v67, v68, v1
  v_max3_u32 v1, v69, v70, v1
  v_max3_u32 v1, v71, v72, v1
  v_max3_u32 v1, v73, v74, v1
  v_max3_u32 v1, v75, v76, v1
  v_max3_u32 v1, v77, v78, v1
  v_max3_u32 v1, v79, v80, v1
  v_max3_u32 v1, v81, v82, v1
  v_max3_u32 v1, v83, v84, v1
  v_max3_u32 v1, v85, v86, v1
  v_max3_u32 v1, v87, v88, v1
  v_max3_u32 v1, v89, v90, v1
  v_max3_u32 v1, v91, v92, v1
  v_max3_u32 v1, v93, v94, v1
  v_max3_u32 v1, v95, v96, v1
  v_max3_u32 v1, v97, v98, v1
  v_max3_u32 v1, v99, v100, v1
  v_max3_u32 v1, v101, v102, v1
  v_max3_u32 v1, v103, v104, v1
  v_max3_u32 v1, v105, v106, v1
  v_max3_u32 v1, v107, v108, v1
  v_max3_u32 v1, v109, v110, v1
  v_max3_u32 v1, v111, v112, v1
  v_max3_u32 v1, v113, v114, v1
  v_max3_u32 v1, v115, v116, v1
  v_max3_u32 v1, v117, v118, v1
  v_max3_u32 v1, v119, v120, v1
  v_max3_u32 v1, v121, v122, v1
  v_max3_u32 v1, v123, v124, v1
  v_max3_u32 v1, v125, v126, v1
  v_max3_u32 v1, v127, v128, v1
  v_max3_u32 v1, v129, v130, v1
  v_cmp_eq_u32 vcc, -1, v1
  s_add_u32 s31, s31, 0x2010
  s_bitcmp1_b32 s31, 30
  s_cbranch_scc1 L_g_sumA
  s_nop 4
  s_cbranch_vccz L_g_sumA
  s_waitcnt vmcnt(0)
s_and_b32 s69, s5, 3
s_lshl_b32 s69, s69, 2
s_mul_i32 s10, s69, 5632
s_add_u32 s10, s10, s26
buffer_load_dwordx4 v[66:69], v27, s[52:55], s10 offen sc1
s_add_u32 s10, s10, 5632
buffer_load_dwordx4 v[70:73], v27, s[52:55], s10 offen sc1
s_add_u32 s10, s10, 5632
buffer_load_dwordx4 v[74:77], v27, s[52:55], s10 offen sc1
s_add_u32 s10, s10, 5632
buffer_load_dwordx4 v[78:81], v27, s[52:55], s10 offen sc1
s_add_u32 s69, s69, 4
s_and_b32 s69, s69, 15
s_mul_i32 s10, s69, 5632
s_add_u32 s10, s10, s26
buffer_load_dwordx4 v[82:85], v27, s[52:55], s10 offen sc1
s_add_u32 s10, s10, 5632
buffer_load_dwordx4 v[86:89], v27, s[52:55], s10 offen sc1
s_add_u32 s10, s10, 5632
buffer_load_dwordx4 v[90:93], v27, s[52:55], s10 offen sc1
s_add_u32 s10, s10, 5632
buffer_load_dwordx4 v[94:97], v27, s[52:55], s10 offen sc1
s_add_u32 s69, s69, 4
s_and_b32 s69, s69, 15
s_mul_i32 s10, s69, 5632
s_add_u32 s10, s10, s26
buffer_load_dwordx4 v[98:101], v27, s[52:55], s10 offen sc1
s_add_u32 s10, s10, 5632
buffer_load_dwordx4 v[102:105], v27, s[52:55], s10 offen sc1
s_add_u32 s10, s10, 5632
buffer_load_dwordx4 v[106:109], v27, s[52:55], s10 offen sc1
s_add_u32 s10, s10, 5632
buffer_load_dwordx4 v[110:113], v27, s[52:55], s10 offen sc1
s_add_u32 s69, s69, 4
s_and_b32 s69, s69, 15
s_mul_i32 s10, s69, 5632
s_add_u32 s10, s10, s26
buffer_load_dwordx4 v[114:117], v27, s[52:55], s10 offen sc1
s_add_u32 s10, s10, 5632
buffer_load_dwordx4 v[118:121], v27, s[52:55], s10 offen sc1
s_add_u32 s10, s10, 5632
buffer_load_dwordx4 v[122:125], v27, s[52:55], s10 offen sc1
s_add_u32 s10, s10, 5632
buffer_load_dwordx4 v[126:129], v27, s[52:55], s10 offen sc1
  s_waitcnt vmcnt(0)
  s_branch L_gA
L_g_sumA:
  v_mfma_f32_16x16x32_bf16 v[240:243], v[36:39], v[64:67], 0
  v_mfma_f32_16x16x32_bf16 v[244:247], v[36:39], v[68:71], 0
  v_mfma_f32_16x16x32_bf16 v[240:243], v[36:39], v[72:75], v[240:243]
  v_mfma_f32_16x16x32_bf16 v[244:247], v[36:39], v[76:79], v[244:247]
  v_mfma_f32_16x16x32_bf16 v[240:243], v[36:39], v[80:83], v[240:243]
  v_mfma_f32_16x16x32_bf16 v[244:247], v[36:39], v[84:87], v[244:247]
  v_mfma_f32_16x16x32_bf16 v[240:243], v[36:39], v[88:91], v[240:243]
  v_mfma_f32_16x16x32_bf16 v[244:247], v[36:39], v[92:95], v[244:247]
  v_mfma_f32_16x16x32_bf16 v[240:243], v[36:39], v[96:99], v[240:243]
  v_mfma_f32_16x16x32_bf16 v[244:247], v[36:39], v[100:103], v[244:247]
  v_mfma_f32_16x16x32_bf16 v[240:243], v[36:39], v[104:107], v[240:243]
  v_mfma_f32_16x16x32_bf16 v[244:247], v[36:39], v[108:111], v[244:247]
  v_mfma_f32_16x16x32_bf16 v[240:243], v[36:39], v[112:115], v[240:243]
  v_mfma_f32_16x16x32_bf16 v[244:247], v[36:39], v[116:119], v[244:247]
  v_mfma_f32_16x16x32_bf16 v[240:243], v[36:39], v[120:123], v[240:243]
  v_mfma_f32_16x16x32_bf16 v[244:247], v[36:39], v[124:127], v[244:247]
  v_mfma_f32_16x16x32_bf16 v[240:243], v[36:39], v[128:131], v[240:243]
  s_nop 15
  s_branch L_g_okA
L_ic2A:
  s_sleep 8
  buffer_load_dword v31, v32, s[52:55], s11 offen sc1
  s_waitcnt vmcnt(0)
  v_cmp_ne_u32 vcc, 1, v31
  s_add_u32 s31, s31, 0x1100
  s_bitcmp1_b32 s31, 30
  s_cbranch_scc1 L_ic_ok2A
  s_nop 4
  s_cbranch_vccnz L_ic2A
  s_branch L_ic_ok2A
L_o1A:
  s_add_u32 m0, s64, 28672
  s_add_u32 s13, s37, 17408
  buffer_load_dwordx4 v255, s[56:59], s37 offen sc1 lds
  buffer_load_dwordx4 v255, s[56:59], s13 offen offset:1024 sc1 lds
  s_add_u32 s13, s13, 17408
  buffer_load_dwordx4 v255, s[56:59], s13 offen offset:2048 sc1 lds
  s_add_u32 s13, s13, 17408
  buffer_load_dwordx4 v255, s[56:59], s13 offen offset:3072 sc1 lds
  s_waitcnt vmcnt(0)
  ds_read2st64_b32 v[64:65], v2 offset0:0 offset1:4
  ds_read2st64_b32 v[66:67], v2 offset0:8 offset1:12
  s_waitcnt lgkmcnt(0)
  v_max3_u32 v60, v64, v65, v66
  v_max_u32 v60, v60, v67
  v_cmp_eq_u32 vcc, -1, v60
  s_add_u32 s31, s31, 0x1001
  s_bitcmp1_b32 s31, 30
  s_cbranch_scc1 L_o_ok1A
  s_nop 4
  s_cbranch_vccnz L_o1A
  s_branch L_o_ok1A
L_o2A:
  s_add_u32 m0, s64, 45056
  s_add_u32 s13, s38, 17408
  buffer_load_dwordx4 v255, s[56:59], s38 offen sc1 lds
  buffer_load_dwordx4 v255, s[56:59], s13 offen offset:1024 sc1 lds
  s_add_u32 s13, s13, 17408
  buffer_load_dwordx4 v255, s[56:59], s13 offen offset:2048 sc1 lds
  s_add_u32 s13, s13, 17408
  buffer_load_dwordx4 v255, s[56:59], s13 offen offset:3072 sc1 lds
  s_waitcnt vmcnt(0)
  ds_read2st64_b32 v[64:65], v2 offset0:64 offset1:68
  ds_read2st64_b32 v[66:67], v2 offset0:72 offset1:76
  s_waitcnt lgkmcnt(0)
  v_max3_u32 v60, v64, v65, v66
  v_max_u32 v60, v60, v67
  v_cmp_eq_u32 vcc, -1, v60
  s_add_u32 s31, s31, 0x1001
  s_bitcmp1_b32 s31, 30
  s_cbranch_scc1 L_o_ok2A
  s_nop 4
  s_cbranch_vccnz L_o2A
  s_branch L_o_ok2A
L_o3A:
  s_add_u32 m0, s64, 61440
  s_add_u32 s13, s39, 17408
  buffer_load_dwordx4 v255, s[56:59], s39 offen sc1 lds
  buffer_load_dwordx4 v255, s[56:59], s13 offen offset:1024 sc1 lds
  s_add_u32 s13, s13, 17408
  buffer_load_dwordx4 v255, s[56:59], s13 offen offset:2048 sc1 lds
  s_add_u32 s13, s13, 17408
  buffer_load_dwordx4 v255, s[56:59], s13 offen offset:3072 sc1 lds
  s_waitcnt vmcnt(0)
  ds_read2st64_b32 v[64:65], v2 offset0:128 offset1:132
  ds_read2st64_b32 v[66:67], v2 offset0:136 offset1:140
  s_waitcnt lgkmcnt(0)
  v_max3_u32 v60, v64, v65, v66
  v_max_u32 v60, v60, v67
  v_cmp_eq_u32 vcc, -1, v60
  s_add_u32 s31, s31, 0x1001
  s_bitcmp1_b32 s31, 30
  s_cbranch_scc1 L_o_ok3A
  s_nop 4
  s_cbranch_vccnz L_o3A
  s_branch L_o_ok3A
L_o4A:
  s_add_u32 m0, s64, 139264
  s_add_u32 s13, s40, 17408
  buffer_load_dwordx4 v255, s[56:59], s40 offen sc1 lds
  buffer_load_dwordx4 v255, s[56:59], s13 offen offset:1024 sc1 lds
  s_add_u32 s13, s13, 17408
  buffer_load_dwordx4 v255, s[56:59], s13 offen offset:2048 sc1 lds
  s_add_u32 s13, s13, 17408
  buffer_load_dwordx4 v255, s[56:59], s13 offen offset:3072 sc1 lds
  s_waitcnt vmcnt(0)
  ds_read2st64_b32 v[64:65], v3 offset0:220 offset1:224
  ds_read2st64_b32 v[66:67], v3 offset0:228 offset1:232
  s_waitcnt lgkmcnt(0)
  v_max3_u32 v60, v64, v65, v66
  v_max_u32 v60, v60, v67
  v_cmp_eq_u32 vcc, -1, v60
  s_add_u32 s31, s31, 0x1001
  s_bitcmp1_b32 s31, 30
  s_cbranch_scc1 L_o_ok4A
  s_nop 4
  s_cbranch_vccnz L_o4A
  s_branch L_o_ok4A
L_o5A:
  s_add_u32 m0, s64, 82944
  s_add_u32 s13, s41, 17408
  buffer_load_dwordx4 v255, s[56:59], s41 offen sc1 lds
  buffer_load_dwordx4 v255, s[56:59], s13 offen offset:1024 sc1 lds
  s_add_u32 s13, s13, 17408
  buffer_load_dwordx4 v255, s[56:59], s13 offen offset:2048 sc1 lds
  s_add_u32 s13, s13, 17408
  buffer_load_dwordx4 v255, s[56:59], s13 offen offset:3072 sc1 lds
  s_waitcnt vmcnt(0)
  ds_read2st64_b32 v[64:65], v3 offset0:0 offset1:4
  ds_read2st64_b32 v[66:67], v3 offset0:8 offset1:12
  s_waitcnt lgkmcnt(0)
  v_max3_u32 v60, v64, v65, v66
  v_max_u32 v60, v60, v67
  v_cmp_eq_u32 vcc, -1, v60
  s_add_u32 s31, s31, 0x1001
  s_bitcmp1_b32 s31, 30
  s_cbranch_scc1 L_o_ok5A
  s_nop 4
  s_cbranch_vccnz L_o5A
  s_branch L_o_ok5A
L_o6A:
  s_add_u32 m0, s64, 99328
  s_add_u32 s13, s42, 17408
  buffer_load_dwordx4 v255, s[56:59], s42 offen sc1 lds
  buffer_load_dwordx4 v255, s[56:59], s13 offen offset:1024 sc1 lds
  s_add_u32 s13, s13, 17408
  buffer_load_dwordx4 v255, s[56:59], s13 offen offset:2048 sc1 lds
  s_add_u32 s13, s13, 17408
  buffer_load_dwordx4 v255, s[56:59], s13 offen offset:3072 sc1 lds
  s_waitcnt vmcnt(0)
  ds_read2st64_b32 v[64:65], v3 offset0:64 offset1:68
  ds_read2st64_b32 v[66:67], v3 offset0:72 offset1:76
  s_waitcnt lgkmcnt(0)
  v_max3_u32 v60, v64, v65, v66
  v_max_u32 v60, v60, v67
  v_cmp_eq_u32 vcc, -1, v60
  s_add_u32 s31, s31, 0x1001
  s_bitcmp1_b32 s31, 30
  s_cbranch_scc1 L_o_ok6A
  s_nop 4
  s_cbranch_vccnz L_o6A
  s_branch L_o_ok6A
L_o7A:
  s_add_u32 m0, s64, 28672
  s_add_u32 s13, s43, 17408
  buffer_load_dwordx4 v255, s[56:59], s43 offen sc1 lds
  buffer_load_dwordx4 v255, s[56:59], s13 offen offset:1024 sc1 lds
  s_add_u32 s13, s13, 17408
  buffer_load_dwordx4 v255, s[56:59], s13 offen offset:2048 sc1 lds
  s_add_u32 s13, s13, 17408
  buffer_load_dwordx4 v255, s[56:59], s13 offen offset:3072 sc1 lds
  s_waitcnt vmcnt(0)
  ds_read2st64_b32 v[64:65], v2 offset0:0 offset1:4
  ds_read2st64_b32 v[66:67], v2 offset0:8 offset1:12
  s_waitcnt lgkmcnt(0)
  v_max3_u32 v60, v64, v65, v66
  v_max_u32 v60, v60, v67
  v_cmp_eq_u32 vcc, -1, v60
  s_add_u32 s31, s31, 0x1001
  s_bitcmp1_b32 s31, 30
  s_cbranch_scc1 L_o_ok7A
  s_nop 4
  s_cbranch_vccnz L_o7A
  s_branch L_o_ok7A
L_o8A:
  s_add_u32 m0, s64, 45056
  s_add_u32 s13, s36, 17408
  buffer_load_dwordx4 v255, s[56:59], s36 offen sc1 lds
  buffer_load_dwordx4 v255, s[56:59], s13 offen offset:1024 sc1 lds
  s_add_u32 s13, s13, 17408
  buffer_load_dwordx4 v255, s[56:59], s13 offen offset:2048 sc1 lds
  s_add_u32 s13, s13, 17408
  buffer_load_dwordx4 v255, s[56:59], s13 offen offset:3072 sc1 lds
  s_waitcnt vmcnt(0)
  ds_read2st64_b32 v[64:65], v2 offset0:64 offset1:68
  ds_read2st64_b32 v[66:67], v2 offset0:72 offset1:76
  s_waitcnt lgkmcnt(0)
  v_max3_u32 v60, v64, v65, v66
  v_max_u32 v60, v60, v67
  v_cmp_eq_u32 vcc, -1, v60
  s_add_u32 s31, s31, 0x1001
  s_bitcmp1_b32 s31, 30
  s_cbranch_scc1 L_o_ok8A
  s_nop 4
  s_cbranch_vccnz L_o8A
  s_branch L_o_ok8A
L_df3A:
  s_nop 4
  s_mov_b64 exec, 1
  buffer_store_dword v1, v18, s[52:55], s66 offen offset:16 sc1
  s_mov_b64 exec, -1
  s_nop 1
  s_branch L_d_okf3A
L_ic3A:
  s_sleep 1
  buffer_load_dword v31, v32, s[52:55], s11 offen offset:16 sc1
  s_waitcnt vmcnt(0)
  v_cmp_ne_u32 vcc, 1, v31
  s_add_u32 s31, s31, 0x1100
  s_bitcmp1_b32 s31, 30
  s_cbranch_scc1 L_ic_ok3A
  s_nop 4
  s_cbranch_vccnz L_ic3A
  s_branch L_ic_ok3A
.section .rodata,"a"
.p2align 6
.amdhsa_kernel concat_heads__linear_attn_block__linear_kernel_hedgehog__prompt_kernel
  .amdhsa_next_free_vgpr 256
  .amdhsa_next_free_sgpr 102
  .amdhsa_accum_offset 256
  .amdhsa_group_segment_fixed_size 0
  .amdhsa_kernarg_size 80
  .amdhsa_user_sgpr_count 2
  .amdhsa_user_sgpr_kernarg_segment_ptr 1
  .amdhsa_system_sgpr_workgroup_id_x 1
.end_amdhsa_kernel
```
